```python
import torch

def _softmax(x, axis=-1):
    return torch.softmax(x, dim=axis)
def _gelu(x):
    return torch.nn.functional.gelu(x, approximate="tanh")
def _silu(x):
    return torch.nn.functional.silu(x)
def _sigmoid(x):
    return torch.sigmoid(x)
def _layernorm(x, axis=-1, eps=1e-5):
    m = x.mean(dim=axis, keepdim=True)
    v = x.var(dim=axis, keepdim=True, unbiased=False)
    return (x - m) / torch.sqrt(v + eps)
def _scatter_add(tgt, idx, src, axis=0):
    return tgt.clone().index_add_(axis, idx, src)
def _segment_sum(src, seg, n):
    out = torch.zeros((n,) + src.shape[1:], dtype=src.dtype)
    return out.index_add_(0, seg, src)
def _pad(x, pw):
    flat = tuple(v for pair in reversed(pw) for v in pair)
    return torch.nn.functional.pad(x, flat)

kernel_name = 'parallel_sum__spectral_gfnet__glu_gated_swiglu__prompt'

def setup_inputs():

    _w = (lambda a: (lambda t: t.to(torch.bfloat16) if t.is_floating_point() else t)(torch.as_tensor(a)))
    def _A_setup():
        B, S, D = 1, 2048, 512
        Df = D // 2 + 1
        return {
            "x": _w((lambda *s: torch.randn(*s, dtype=torch.bfloat16) * 0.05)(B, S, D)),
            "w_r": _w((lambda *s: torch.randn(*s, dtype=torch.bfloat16) * 0.4)(S, Df) * 0.02),
            "w_i": _w((lambda *s: torch.randn(*s, dtype=torch.bfloat16) * 0.4)(S, Df) * 0.02),
        }
    _A_in = _A_setup()

    def _B_setup():
        B, S, D, F = 1, 2048, 512, 1376
        return {
            "x": _w((lambda *s: torch.randn(*s, dtype=torch.bfloat16) * 0.05)(B, S, D)),
            "w1": _w((lambda *s: torch.randn(*s, dtype=torch.bfloat16) * 0.2)(D, F) * (2.0 / D) ** 0.5),
            "w3": _w((lambda *s: torch.randn(*s, dtype=torch.bfloat16) * 0.2)(D, F) * (2.0 / D) ** 0.5),
            "w2": _w((lambda *s: torch.randn(*s, dtype=torch.bfloat16) * 0.2)(F, D) * (2.0 / F) ** 0.5),
        }
    _B_in = _B_setup()

    return {
        "A_x": _A_in["x"],
        "A_w_r": _A_in["w_r"],
        "A_w_i": _A_in["w_i"],
        "B_x": _B_in["x"],
        "B_w1": _B_in["w1"],
        "B_w3": _B_in["w3"],
        "B_w2": _B_in["w2"],
    }

def reference(A_x, A_w_r, A_w_i, B_x, B_w1, B_w3, B_w2):
    def _A_ref(x, w_r, w_i):
        B, S, D = x.shape
        X = (lambda x, axes=(-2,-1): torch.fft.rfft2(x.float(), dim=axes))(x, axes=(-2, -1))
        W = w_r + 1j * w_i
        X = X * W
        y = (lambda x, s, axes=(-2,-1): torch.fft.irfft2(x, s=s, dim=axes).to(torch.bfloat16))(X, (S, D), axes=(-2, -1))
        return y

    def _B_ref(x, w1, w3, w2):
        gate = torch.einsum("bsd,df->bsf", x, w1)
        up = torch.einsum("bsd,df->bsf", x, w3)
        h = _silu(gate) * up
        out = torch.einsum("bsf,fd->bsd", h, w2)
        return out

    x = A_x
    xn = _layernorm(x, axis=-1)
    return x + _A_ref(xn, A_w_r, A_w_i) + _B_ref(xn, B_w1, B_w3, B_w2)
```

```asm
; @launch grid=(256,1,1) block=(512,1,1) lds=163840
.amdgcn_target "amdgcn-amd-amdhsa--gfx950"
.text
.globl parallel_sum__spectral_gfnet__glu_gated_swiglu__prompt_kernel
.p2align 8
.type parallel_sum__spectral_gfnet__glu_gated_swiglu__prompt_kernel,@function
parallel_sum__spectral_gfnet__glu_gated_swiglu__prompt_kernel:
    s_cmp_ge_u32 s2, 0x100
    s_cbranch_scc1 k_end
    s_nop 0
    s_load_dwordx2 s[8:9], s[0:1], 0
    s_load_dwordx2 s[12:13], s[0:1], 8
    s_load_dwordx2 s[16:17], s[0:1], 16
    s_load_dwordx8 s[72:79], s[0:1], 32
    s_load_dwordx2 s[36:37], s[0:1], 72
    s_load_dwordx2 s[66:67], s[0:1], 64
    s_getpc_b64 s[40:41]
pc_1:
    s_sub_u32 s40, s40, pc_1-parallel_sum__spectral_gfnet__glu_gated_swiglu__prompt_kernel
    s_subb_u32 s41, s41, 0
    s_lshr_b32 s42, s2, 3
    s_mul_i32 s42, s42, 16
    v_lshrrev_b32 v2, 6, v0
    v_mul_u32_u24 v2, 2, v2
    v_and_b32_e64 v3, 63, v0
    v_add3_u32 v2, v2, v3, s42
    v_min_u32 v2, (k_end-parallel_sum__spectral_gfnet__glu_gated_swiglu__prompt_kernel)>>7, v2
    v_lshlrev_b32 v2, 7, v2
    v_mov_b32 v3, s41
    v_add_co_u32 v2, vcc, s40, v2
    s_nop 1
    v_addc_co_u32 v3, vcc, 0, v3, vcc
    s_mov_b64 exec, 3
    global_load_dword v255, v[2:3], off
    s_mov_b64 exec, -1
    v_lshrrev_b32 v2, 6, v0
    v_and_b32 v1, 63, v0
    v_readfirstlane_b32 s3, v2
    s_mov_b32 s10, 0x200000
    s_mov_b32 s11, 0x20000
    s_bfe_u32 s40, s2, 0x20003
    s_and_b32 s41, s2, 3
    s_lshl2_add_u32 s84, s41, s40
    s_bfe_u32 s40, s2, 0x10002
    s_lshr_b32 s41, s2, 5
    s_lshl3_add_u32 s85, s40, s41
    s_add_u32 s88, s2, s85
    s_and_b32 s88, s88, 3
    s_cmp_ge_u32 s3, 4
    s_cbranch_scc1 k_helper
    s_and_b32 s40, s3, 1
    s_lshl1_add_u32 s50, s84, s40
    s_lshr_b32 s41, s3, 1
    s_lshl_b32 s41, s41, 5
    s_add_u32 s50, s50, s41
    s_lshl_b32 s51, s3, 15
    s_lshr_b32 s41, s50, 3
    s_lshl_b32 s41, s41, 18
    s_and_b32 s42, s50, 7
    s_lshl_b32 s42, s42, 12
    s_add_u32 s56, s41, s42
    s_lshl_b32 s40, s88, 8
    s_add_u32 s52, s56, s40
    s_and_b32 s63, s85, 4
    s_lshr_b32 s40, s85, 2
    s_and_b32 s40, s40, 2
    s_or_b32 s63, s63, s40
    v_lshrrev_b32 v20, 4, v1
    v_and_b32 v21, 15, v1
    v_xor_b32 v21, v21, v20
    v_lshlrev_b32 v21, 4, v21
    v_lshl_add_u32 v20, v20, 10, v21
    s_and_b32 s40, s63, 2
    s_lshl_b32 s40, s40, 6
    v_xor_b32 v16, s40, v20
    v_xor_b32_e64 v17, 64, v16
    v_xor_b32 v18, 0x80, v16
    v_xor_b32 v19, 0x80, v17
    s_lshl_b32 s63, s63, 10
    s_add_u32 s40, s88, 1
    s_and_b32 s40, s40, 3
    s_lshl_b32 s40, s40, 8
    s_add_u32 s53, s56, s40
    s_add_u32 s40, s88, 2
    s_and_b32 s40, s40, 3
    s_lshl_b32 s40, s40, 8
    s_add_u32 s54, s56, s40
    s_add_u32 s40, s88, 3
    s_and_b32 s40, s40, 3
    s_lshl_b32 s40, s40, 8
    s_add_u32 s55, s56, s40
    s_waitcnt lgkmcnt(0)
    s_barrier
    s_mov_b32 s41, s51
    s_mov_b32 s42, s63
    s_add_u32 m0, s41, s42
    s_lshl_b32 s42, s42, 5
    s_add_u32 s40, s42, s52
    buffer_load_dwordx4 v16, s[8:11], s40 offen lds
    s_xor_b32 s42, s63, 1024
    s_add_u32 m0, s41, s42
    s_lshl_b32 s42, s42, 5
    s_add_u32 s40, s42, s52
    buffer_load_dwordx4 v17, s[8:11], s40 offen lds
    s_xor_b32 s42, s63, 2048
    s_add_u32 m0, s41, s42
    s_lshl_b32 s42, s42, 5
    s_add_u32 s40, s42, s52
    buffer_load_dwordx4 v18, s[8:11], s40 offen lds
    s_xor_b32 s42, s63, 3072
    s_add_u32 m0, s41, s42
    s_lshl_b32 s42, s42, 5
    s_add_u32 s40, s42, s52
    buffer_load_dwordx4 v19, s[8:11], s40 offen lds
    s_xor_b32 s42, s63, 4096
    s_add_u32 m0, s41, s42
    s_lshl_b32 s42, s42, 5
    s_add_u32 s40, s42, s52
    buffer_load_dwordx4 v16, s[8:11], s40 offen lds
    s_xor_b32 s42, s63, 5120
    s_add_u32 m0, s41, s42
    s_lshl_b32 s42, s42, 5
    s_add_u32 s40, s42, s52
    buffer_load_dwordx4 v17, s[8:11], s40 offen lds
    s_xor_b32 s42, s63, 6144
    s_add_u32 m0, s41, s42
    s_lshl_b32 s42, s42, 5
    s_add_u32 s40, s42, s52
    buffer_load_dwordx4 v18, s[8:11], s40 offen lds
    s_xor_b32 s42, s63, 7168
    s_add_u32 m0, s41, s42
    s_lshl_b32 s42, s42, 5
    s_add_u32 s40, s42, s52
    buffer_load_dwordx4 v19, s[8:11], s40 offen lds
    s_branch k_main
k_helper:
    s_setprio 3
    s_sub_u32 s4, s3, 4
    v_lshlrev_b32 v4, 2, v1
    v_add_u32 v4, 155648, v4
    v_mov_b32 v5, 0
    ds_write_b32 v4, v5
    s_mov_b32 s14, 1052672
    s_mov_b32 s15, s11
    s_mov_b64 s[18:19], s[14:15]
    s_lshr_b32 s40, s2, 3
    s_and_b32 s41, s2, 3
    s_bfe_u32 s42, s2, 0x10002
    s_lshl1_add_u32 s41, s41, s42
    s_lshl_b32 s62, s41, 5
    s_add_u32 s62, s62, s40
    s_lshl2_add_u32 s42, s41, s4
    s_lshl_b32 s42, s42, 5
    s_add_u32 s42, s42, s40
    s_lshl_b32 s42, s42, 10
    s_lshl_b32 s44, s4, 11
    s_add_u32 s44, s44, 147456
    s_mov_b32 m0, s44
    v_lshlrev_b32 v2, 4, v1
    s_add_u32 s43, s42, 0x100000
    s_bfe_u32 s45, s2, 0x20003
    s_and_b32 s46, s2, 3
    s_bfe_u32 s47, s2, 0x10002
    s_bfe_u32 s48, s2, 0x20005
    s_lshr_b32 s49, s2, 7
    s_lshl2_add_u32 s50, s47, s46
    s_lshl_b32 s50, s50, 2
    s_lshl3_add_u32 s50, s50, s48
    s_lshl3_add_u32 s50, s50, s49
    s_mulk_i32 s50, 514
    s_lshl_b32 s51, s45, 7
    s_add_u32 s50, s50, s51
    s_add_u32 s50, s50, 2
    v_lshrrev_b32_e64 v3, 5, v1
    v_bfe_u32 v4, v1, 3, 2
    v_lshl_add_u32 v3, v3, 4, v4
    v_mul_u32_u24 v3, 1028, v3
    v_and_b32 v4, 7, v1
    v_lshl_add_u32 v3, v4, 4, v3
    s_waitcnt lgkmcnt(0)
    s_barrier
    buffer_load_dwordx4 v2, s[8:11], s42 offen lds
    s_add_u32 m0, s44, 1024
    s_nop 0
    buffer_load_dwordx4 v2, s[8:11], s43 offen lds
    s_cmp_lg_u32 s4, 3
    s_cbranch_scc1 k_now
    s_mov_b32 m0, 139264
    s_nop 0
    buffer_load_dwordx4 v3, s[12:15], s50 offen lds
    s_mov_b32 m0, 143360
    s_nop 0
    buffer_load_dwordx4 v3, s[16:19], s50 offen lds
    s_mov_b32 m0, 140288
    s_add_u32 s50, s50, 32896
    buffer_load_dwordx4 v3, s[12:15], s50 offen lds
    s_mov_b32 m0, 144384
    s_nop 0
    buffer_load_dwordx4 v3, s[16:19], s50 offen lds
    s_mov_b32 m0, 141312
    s_add_u32 s50, s50, 32896
    buffer_load_dwordx4 v3, s[12:15], s50 offen lds
    s_mov_b32 m0, 145408
    s_nop 0
    buffer_load_dwordx4 v3, s[16:19], s50 offen lds
    s_mov_b32 m0, 142336
    s_add_u32 s50, s50, 32896
    buffer_load_dwordx4 v3, s[12:15], s50 offen lds
    s_mov_b32 m0, 146432
    s_nop 0
    buffer_load_dwordx4 v3, s[16:19], s50 offen lds
k_now:
    s_mul_i32 s86, s85, 43
    s_add_u32 s87, s86, 43
    s_lshr_b32 s86, s86, 4
    s_lshr_b32 s87, s87, 4
    s_sub_u32 s87, s87, s86
    s_and_b32 s40, s2, 3
    s_bfe_u32 s41, s2, 0x10002
    s_lshl1_add_u32 s40, s40, s41
    s_bfe_u32 s41, s2, 0x20003
    s_lshl2_add_u32 s89, s40, s41
    s_lshr_b32 s90, s2, 5
    s_lshl_b32 s83, s90, 5
    s_add_u32 s83, s83, s89
    s_mov_b64 s[20:21], s[72:73]
    s_mov_b32 s22, 1409024
    s_mov_b32 s23, 0x20000
    s_mov_b64 s[24:25], s[74:75]
    s_mov_b32 s26, 1409024
    s_mov_b32 s27, 0x20000
    s_mov_b64 s[28:29], s[76:77]
    s_mov_b32 s30, 1409024
    s_mov_b32 s31, 0x20000
    s_mov_b64 s[32:33], s[78:79]
    s_mov_b32 s34, 2097152
    s_mov_b32 s35, 0x20000
    s_mov_b32 s38, 0x10000000
    s_mov_b32 s39, 0x20000
    s_add_u32 s80, s36, 12582912
    s_addc_u32 s81, s37, 0
    s_lshl_b32 s40, s2, 8
    s_add_u32 s40, s40, 12648448
    s_add_u32 s64, s36, s40
    s_addc_u32 s65, s37, 0
    s_load_dword s5, s[80:81], 0
    s_sub_u32 s6, s4, 1
    v_and_b32 v4, 15, v1
    v_lshrrev_b32 v5, 4, v1
    v_lshlrev_b32 v5, 2, v5
    v_cvt_f32_u32 v5, v5
    v_add_u32 v6, 1, v4
    v_cvt_f32_u32 v6, v6
    v_mul_f32 v8, 0x3d000000, v6
    v_mul_f32 v7, v5, v8
    v_cos_f32 v52, v7
    v_sin_f32 v60, v7
    v_add_f32 v7, v7, v8
    v_cos_f32 v53, v7
    v_sin_f32 v61, v7
    v_add_f32 v7, v7, v8
    v_cos_f32 v54, v7
    v_sin_f32 v62, v7
    v_add_f32 v7, v7, v8
    v_cos_f32 v55, v7
    v_sin_f32 v63, v7
    v_mul_f32 v10, 0x41500000, v8
    v_add_f32 v7, v7, v10
    v_cos_f32 v56, v7
    v_sin_f32 v64, v7
    v_add_f32 v7, v7, v8
    v_cos_f32 v57, v7
    v_sin_f32 v65, v7
    v_add_f32 v7, v7, v8
    v_cos_f32 v58, v7
    v_sin_f32 v66, v7
    v_add_f32 v7, v7, v8
    v_cos_f32 v59, v7
    v_sin_f32_e64 v67, v7
    v_cvt_pk_bf16_f32 v16, v52, v53
    v_cvt_pk_bf16_f32 v20, -v60, -v61
    v_cvt_pk_bf16_f32 v17, v54, v55
    v_cvt_pk_bf16_f32 v21, -v62, -v63
    v_cvt_pk_bf16_f32 v18, v56, v57
    v_cvt_pk_bf16_f32 v22, -v64, -v65
    v_cvt_pk_bf16_f32 v19, v58, v59
    v_cvt_pk_bf16_f32 v23, -v66, -v67
    v_xor_b32 v24, 0x80000000, v16
    v_xor_b32 v25, 0x80000000, v17
    v_xor_b32 v26, 0x80000000, v18
    v_xor_b32 v27, 0x80000000, v19
    v_xor_b32 v28, 0x80000000, v20
    v_xor_b32 v29, 0x80000000, v21
    v_xor_b32 v30, 0x80000000, v22
    v_xor_b32 v31, 0x80000000, v23
    v_mul_f32 v8, 0x3b000000, v6
    v_mul_f32 v7, v5, v8
    v_cos_f32 v32, v7
    v_sin_f32 v40, v7
    v_add_f32 v7, v7, v8
    v_cos_f32 v33, v7
    v_sin_f32 v41, v7
    v_add_f32 v7, v7, v8
    v_cos_f32 v34, v7
    v_sin_f32 v42, v7
    v_add_f32 v7, v7, v8
    v_cos_f32 v35, v7
    v_sin_f32 v43, v7
    v_add_f32 v6, 0x41800000, v6
    v_mul_f32 v8, 0x3b000000, v6
    v_mul_f32 v7, v5, v8
    v_cos_f32 v36, v7
    v_sin_f32 v44, v7
    v_add_f32 v7, v7, v8
    v_cos_f32 v37, v7
    v_sin_f32 v45, v7
    v_add_f32 v7, v7, v8
    v_cos_f32 v38, v7
    v_sin_f32 v46, v7
    v_add_f32 v7, v7, v8
    v_cos_f32 v39, v7
    v_sin_f32 v47, v7
    v_lshrrev_b32 v8, 1, v4
    v_cvt_f32_u32 v8, v8
    v_mul_f32 v8, 0x3d800000, v8
    v_and_b32 v7, 1, v4
    v_cvt_f32_u32 v7, v7
    v_mul_f32 v7, 0x3e800000, v7
    v_fma_f32 v7, v5, v8, v7
    v_cos_f32 v52, v7
    v_sin_f32 v60, v7
    v_add_f32 v7, v7, v8
    v_cos_f32 v53, v7
    v_sin_f32 v61, v7
    v_add_f32 v7, v7, v8
    v_cos_f32 v54, v7
    v_sin_f32 v62, v7
    v_add_f32 v7, v7, v8
    v_cos_f32 v55, v7
    v_sin_f32_e64 v63, v7
    v_cvt_pk_bf16_f32 v48, v52, v53
    v_cvt_pk_bf16_f32 v50, v60, v61
    v_cvt_pk_bf16_f32 v49, v54, v55
    v_cvt_pk_bf16_f32 v51, v62, v63
    v_cmp_eq_u32 vcc, 15, v4
    v_mov_b32 v9, 0x42000000
    s_nop 0
    v_cndmask_b32 v9, 0, v9, vcc
    s_mov_b32 s53, 0x3f803f80
    v_lshlrev_b32 v10, 3, v1
    v_add_u32 v10, s44, v10
    v_lshrrev_b32 v11, 4, v1
    v_lshlrev_b32 v11, 6, v11
    v_add_u32 v11, v11, v4
    v_lshlrev_b32 v11, 2, v11
    v_add_u32 v11, s44, v11
    s_waitcnt vmcnt(8)
    s_cmp_eq_u32 s4, 3
    s_cbranch_scc1 k_rows
    s_waitcnt vmcnt(0)
k_rows:
    ds_read_b64_tr_b16 v[52:53], v10 offset:0
    ds_read_b64_tr_b16 v[54:55], v10 offset:512
    ds_read_b64_tr_b16 v[56:57], v10 offset:1024
    ds_read_b64_tr_b16 v[58:59], v10 offset:1536
    s_waitcnt lgkmcnt(0)
    s_nop 0
    v_dot2_f32_bf16 v12, v52, s53, 0
    v_dot2_f32_bf16 v13, v52, v52, 0
    v_dot2_f32_bf16 v14, v56, s53, 0
    v_dot2_f32_bf16 v15, v56, v56, 0
    v_dot2_f32_bf16 v12, v53, s53, v12
    v_dot2_f32_bf16 v13, v53, v53, v13
    v_dot2_f32_bf16 v14, v57, s53, v14
    v_dot2_f32_bf16 v15, v57, v57, v15
    v_dot2_f32_bf16 v12, v54, s53, v12
    v_dot2_f32_bf16 v13, v54, v54, v13
    v_dot2_f32_bf16 v14, v58, s53, v14
    v_dot2_f32_bf16 v15, v58, v58, v15
    v_dot2_f32_bf16 v12, v55, s53, v12
    v_dot2_f32_bf16 v13, v55, v55, v13
    v_dot2_f32_bf16 v14, v59, s53, v14
    v_dot2_f32_bf16 v15, v59, v59, v15
    v_mfma_f32_16x16x32_bf16 v[92:95], v[52:55], v[16:19], 0
    v_add_f32_dpp v12, v12, v12 row_ror:8 row_mask:0xf bank_mask:0xf
    v_add_f32_dpp v13, v13, v13 row_ror:8 row_mask:0xf bank_mask:0xf
    v_add_f32_dpp v14, v14, v14 row_ror:8 row_mask:0xf bank_mask:0xf
    v_add_f32_dpp v15, v15, v15 row_ror:8 row_mask:0xf bank_mask:0xf
    v_mfma_f32_16x16x32_bf16 v[96:99], v[52:55], v[20:23], 0
    v_add_f32_dpp v12, v12, v12 row_ror:4 row_mask:0xf bank_mask:0xf
    v_add_f32_dpp v13, v13, v13 row_ror:4 row_mask:0xf bank_mask:0xf
    v_add_f32_dpp v14, v14, v14 row_ror:4 row_mask:0xf bank_mask:0xf
    v_add_f32_dpp v15, v15, v15 row_ror:4 row_mask:0xf bank_mask:0xf
    v_mfma_f32_16x16x32_bf16 v[100:103], v[52:55], v[24:27], 0
    v_add_f32_dpp v12, v12, v12 row_ror:2 row_mask:0xf bank_mask:0xf
    v_add_f32_dpp v13, v13, v13 row_ror:2 row_mask:0xf bank_mask:0xf
    v_add_f32_dpp v14, v14, v14 row_ror:2 row_mask:0xf bank_mask:0xf
    v_add_f32_dpp v15, v15, v15 row_ror:2 row_mask:0xf bank_mask:0xf
    v_mfma_f32_16x16x32_bf16 v[104:107], v[52:55], v[28:31], 0
    v_add_f32_dpp v12, v12, v12 row_ror:1 row_mask:0xf bank_mask:0xf
    v_add_f32_dpp v13, v13, v13 row_ror:1 row_mask:0xf bank_mask:0xf
    v_add_f32_dpp v14, v14, v14 row_ror:1 row_mask:0xf bank_mask:0xf
    v_add_f32_dpp v15, v15, v15 row_ror:1 row_mask:0xf bank_mask:0xf
    v_mfma_f32_16x16x32_bf16 v[108:111], v[56:59], v[16:19], 0
    v_add_f32_dpp v12, v12, v12 row_bcast:15 row_mask:0xa bank_mask:0xf
    v_add_f32_dpp v13, v13, v13 row_bcast:15 row_mask:0xa bank_mask:0xf
    v_add_f32_dpp v14, v14, v14 row_bcast:15 row_mask:0xa bank_mask:0xf
    v_add_f32_dpp v15, v15, v15 row_bcast:15 row_mask:0xa bank_mask:0xf
    v_mfma_f32_16x16x32_bf16 v[112:115], v[56:59], v[20:23], 0
    v_add_f32_dpp v12, v12, v12 row_bcast:31 row_mask:0xc bank_mask:0xf
    v_add_f32_dpp v13, v13, v13 row_bcast:31 row_mask:0xc bank_mask:0xf
    v_add_f32_dpp v14, v14, v14 row_bcast:31 row_mask:0xc bank_mask:0xf
    v_add_f32_dpp v15, v15, v15 row_bcast:31 row_mask:0xc bank_mask:0xf
    v_mfma_f32_16x16x32_bf16 v[116:119], v[56:59], v[24:27], 0
    v_mfma_f32_16x16x32_bf16 v[120:123], v[56:59], v[28:31], 0
    v_mul_f32 v12, 0x3b000000, v12
    v_mul_f32 v14, 0x3b000000, v14
    v_mul_f32 v13, 0x3b000000, v13
    v_mul_f32 v15, 0x3b000000, v15
    v_fma_f32 v13, -v12, v12, v13
    v_fma_f32 v15, -v14, v14, v15
    v_max_f32 v13, 0, v13
    v_max_f32 v15, 0, v15
    v_cvt_pk_bf16_f32 v13, v13, v13
    v_cvt_pk_bf16_f32 v15, v15, v15
    v_and_b32 v13, 0xffff0000, v13
    v_and_b32 v15, 0xffff0000, v15
    v_add_f32 v13, 0x3727c5ac, v13
    v_add_f32 v15, 0x3727c5ac, v15
    v_cvt_pk_bf16_f32 v13, v13, v13
    v_cvt_pk_bf16_f32 v15, v15, v15
    v_and_b32 v13, 0xffff0000, v13
    v_and_b32 v15, 0xffff0000, v15
    v_sqrt_f32 v13, v13
    v_sqrt_f32 v15, v15
    v_cvt_pk_bf16_f32 v13, v13, v13
    v_cvt_pk_bf16_f32 v15, v15, v15
    v_and_b32 v13, 0xffff0000, v13
    v_and_b32 v15, 0xffff0000, v15
    v_rcp_f32 v13, v13
    v_rcp_f32 v15, v15
    v_readlane_b32 s54, v12, 63
    v_readlane_b32 s56, v13, 63
    v_readlane_b32 s55, v14, 63
    v_readlane_b32 s58, v15, 63
    v_fma_f32 v100, -v9, s54, v100
    v_fma_f32 v101, -v9, s54, v101
    v_fma_f32 v102, -v9, s54, v102
    v_fma_f32 v103, -v9, s54, v103
    v_fma_f32 v116, -v9, s55, v116
    v_fma_f32 v117, -v9, s55, v117
    v_fma_f32 v118, -v9, s55, v118
    v_fma_f32 v119, -v9, s55, v119
    v_mul_f32 v76, v92, v32
    v_mul_f32 v78, v96, v32
    v_mul_f32 v77, v93, v33
    v_mul_f32 v79, v97, v33
    v_fma_f32 v76, v96, v40, v76
    v_fma_f32 v78, -v92, v40, v78
    v_fma_f32 v77, v97, v41, v77
    v_fma_f32 v79, -v93, v41, v79
    v_mul_f32 v80, v94, v34
    v_mul_f32 v82, v98, v34
    v_mul_f32 v81, v95, v35
    v_mul_f32 v83, v99, v35
    v_fma_f32 v80, v98, v42, v80
    v_fma_f32 v82, -v94, v42, v82
    v_fma_f32 v81, v99, v43, v81
    v_fma_f32 v83, -v95, v43, v83
    v_cvt_pk_bf16_f32 v60, v76, v77
    v_cvt_pk_bf16_f32 v62, v78, v79
    v_cvt_pk_bf16_f32 v61, v80, v81
    v_cvt_pk_bf16_f32 v63, v82, v83
    v_mul_f32 v76, v100, v36
    v_mul_f32 v78, v104, v36
    v_mul_f32 v77, v101, v37
    v_mul_f32 v79, v105, v37
    v_fma_f32 v76, v104, v44, v76
    v_fma_f32 v78, -v100, v44, v78
    v_fma_f32 v77, v105, v45, v77
    v_fma_f32 v79, -v101, v45, v79
    v_mul_f32 v80, v102, v38
    v_mul_f32 v82, v106, v38
    v_mul_f32 v81, v103, v39
    v_mul_f32 v83, v107, v39
    v_fma_f32 v80, v106, v46, v80
    v_fma_f32 v82, -v102, v46, v82
    v_fma_f32 v81, v107, v47, v81
    v_fma_f32 v83, -v103, v47, v83
    v_cvt_pk_bf16_f32 v64, v76, v77
    v_cvt_pk_bf16_f32 v66, v78, v79
    v_cvt_pk_bf16_f32 v65, v80, v81
    v_cvt_pk_bf16_f32 v67, v82, v83
    v_mul_f32 v76, v108, v32
    v_mul_f32 v78, v112, v32
    v_mul_f32 v77, v109, v33
    v_mul_f32 v79, v113, v33
    v_fma_f32 v76, v112, v40, v76
    v_fma_f32 v78, -v108, v40, v78
    v_fma_f32 v77, v113, v41, v77
    v_fma_f32 v79, -v109, v41, v79
    v_mul_f32 v80, v110, v34
    v_mul_f32 v82, v114, v34
    v_mul_f32 v81, v111, v35
    v_mul_f32 v83, v115, v35
    v_fma_f32 v80, v114, v42, v80
    v_fma_f32 v82, -v110, v42, v82
    v_fma_f32 v81, v115, v43, v81
    v_fma_f32 v83, -v111, v43, v83
    v_cvt_pk_bf16_f32 v68, v76, v77
    v_cvt_pk_bf16_f32 v70, v78, v79
    v_cvt_pk_bf16_f32 v69, v80, v81
    v_cvt_pk_bf16_f32 v71, v82, v83
    v_mul_f32 v76, v116, v36
    v_mul_f32 v78, v120, v36
    v_mul_f32 v77, v117, v37
    v_mul_f32 v79, v121, v37
    v_fma_f32 v76, v120, v44, v76
    v_fma_f32 v78, -v116, v44, v78
    v_fma_f32 v77, v121, v45, v77
    v_fma_f32 v79, -v117, v45, v79
    v_mul_f32 v80, v118, v38
    v_mul_f32 v82, v122, v38
    v_mul_f32 v81, v119, v39
    v_mul_f32 v83, v123, v39
    v_fma_f32 v80, v122, v46, v80
    v_fma_f32 v82, -v118, v46, v82
    v_fma_f32 v81, v123, v47, v81
    v_fma_f32 v83, -v119, v47, v83
    v_cvt_pk_bf16_f32 v72, v76, v77
    v_cvt_pk_bf16_f32 v74, v78, v79
    v_cvt_pk_bf16_f32 v73, v80, v81
    v_cvt_pk_bf16_f32 v75, v82, v83
    v_mfma_f32_16x16x32_bf16 v[92:95], v[48:51], v[60:63], 0
    v_mfma_f32_16x16x32_bf16 v[108:111], v[48:51], v[68:71], 0
    v_mfma_f32_16x16x32_bf16 v[100:103], v[48:51], v[64:67], 0
    v_mfma_f32_16x16x32_bf16 v[116:119], v[48:51], v[72:75], 0
    v_mov_b32 v12, 155648
    v_mov_b32 v13, 1
    s_nop 2
    v_mul_f32 v92, s56, v92
    v_mul_f32 v93, s56, v93
    v_fma_f32 v76, v108, s58, v92
    v_fma_f32 v78, -v108, s58, v92
    v_fma_f32 v77, v109, s58, v93
    v_fma_f32 v79, -v109, s58, v93
    v_cvt_pk_bf16_f32 v80, v76, v77
    v_cvt_pk_bf16_f32 v81, v78, v79
    ds_write_b32 v11, v80 offset:0
    ds_write_b32 v11, v81 offset:1024
    v_mul_f32 v94, s56, v94
    v_mul_f32 v95, s56, v95
    v_fma_f32 v84, v110, s58, v94
    v_fma_f32 v86, -v110, s58, v94
    v_fma_f32 v85, v111, s58, v95
    v_fma_f32 v87, -v111, s58, v95
    v_cvt_pk_bf16_f32 v88, v84, v85
    v_cvt_pk_bf16_f32 v89, v86, v87
    ds_write_b32 v11, v88 offset:128
    ds_write_b32 v11, v89 offset:1152
    v_mul_f32 v100, s56, v100
    v_mul_f32 v101, s56, v101
    v_fma_f32 v76, v116, s58, v100
    v_fma_f32 v78, -v116, s58, v100
    v_fma_f32 v77, v117, s58, v101
    v_fma_f32 v79, -v117, s58, v101
    v_cvt_pk_bf16_f32 v80, v76, v77
    v_cvt_pk_bf16_f32 v81, v78, v79
    ds_write_b32 v11, v80 offset:64
    ds_write_b32 v11, v81 offset:1088
    v_mul_f32 v102, s56, v102
    v_mul_f32 v103, s56, v103
    v_fma_f32 v84, v118, s58, v102
    v_fma_f32 v86, -v118, s58, v102
    v_fma_f32 v85, v119, s58, v103
    v_fma_f32 v87, -v119, s58, v103
    v_cvt_pk_bf16_f32 v88, v84, v85
    v_cvt_pk_bf16_f32 v89, v86, v87
    ds_write_b32 v11, v88 offset:192
    ds_write_b32 v11, v89 offset:1216
    s_mov_b64 exec, 1
    ds_add_u32 v12, v13 offset:32
    s_mov_b64 exec, -1
    s_mul_i32 s5, s5, 0x9E3779B1
    s_add_u32 s5, s5, 0x7F4A7C15
    s_cmp_eq_u32 s4, 0
    s_cbranch_scc1 k_loader
    s_cmp_lg_u32 s4, 3
    s_cbranch_scc1 k_h12
    v_and_b32 v4, 1, v1
    v_lshrrev_b32 v5, 1, v1
    v_lshlrev_b32_e64 v4, 10, v4
    v_lshl_add_u32 v4, v5, 2, v4
    v_add_u32 v4, 147456, v4
    v_add_u32 v5, 128, v4
    s_lshl_b32 s52, s62, 13
    s_add_u32 s52, s52, 0
    s_add_u32 s53, s52, 4096
    s_mov_b32 s63, 2097152
lw_2:
    ds_read_b32 v18, v12 offset:32
    s_waitcnt lgkmcnt(0)
    v_readfirstlane_b32 s61, v18
    s_nop 0
    s_cmp_ge_u32 s61, 4
    s_cbranch_scc1 lwd_3
    s_sub_u32 s63, s63, 1
    s_cbranch_scc0 lw_2
lwd_3:
    s_nop 0
    ds_read2st64_b32 v[32:33], v4 offset0:0 offset1:8
    ds_read2st64_b32 v[34:35], v4 offset0:16 offset1:24
    ds_read2st64_b32 v[36:37], v5 offset0:0 offset1:8
    ds_read2st64_b32 v[38:39], v5 offset0:16 offset1:24
    ds_read2st64_b32 v[40:41], v4 offset0:1 offset1:9
    ds_read2st64_b32 v[42:43], v4 offset0:17 offset1:25
    ds_read2st64_b32 v[44:45], v5 offset0:1 offset1:9
    ds_read2st64_b32 v[46:47], v5 offset0:17 offset1:25
    ds_read2st64_b32 v[48:49], v4 offset0:2 offset1:10
    ds_read2st64_b32 v[50:51], v4 offset0:18 offset1:26
    ds_read2st64_b32 v[52:53], v5 offset0:2 offset1:10
    ds_read2st64_b32 v[54:55], v5 offset0:18 offset1:26
    ds_read2st64_b32 v[56:57], v4 offset0:3 offset1:11
    ds_read2st64_b32 v[58:59], v4 offset0:19 offset1:27
    s_waitcnt lgkmcnt(12)
    ds_read2st64_b32 v[60:61], v5 offset0:3 offset1:11
    ds_read2st64_b32 v[62:63], v5 offset0:19 offset1:27
    s_waitcnt lgkmcnt(14)
    buffer_store_dwordx4 v[32:35], v2, s[36:39], s52 offen offset:0 sc0 sc1
    s_waitcnt lgkmcnt(12)
    buffer_store_dwordx4 v[36:39], v2, s[36:39], s52 offen offset:1024 sc0 sc1
    s_waitcnt lgkmcnt(10)
    buffer_store_dwordx4 v[40:43], v2, s[36:39], s52 offen offset:2048 sc0 sc1
    s_waitcnt lgkmcnt(8)
    buffer_store_dwordx4 v[44:47], v2, s[36:39], s52 offen offset:3072 sc0 sc1
    s_waitcnt lgkmcnt(6)
    buffer_store_dwordx4 v[48:51], v2, s[36:39], s53 offen offset:0 sc0 sc1
    s_waitcnt lgkmcnt(4)
    buffer_store_dwordx4 v[52:55], v2, s[36:39], s53 offen offset:1024 sc0 sc1
    s_waitcnt lgkmcnt(2)
    buffer_store_dwordx4 v[56:59], v2, s[36:39], s53 offen offset:2048 sc0 sc1
    s_waitcnt lgkmcnt(0)
    buffer_store_dwordx4 v[60:63], v2, s[36:39], s53 offen offset:3072 sc0 sc1
    s_mov_b64 exec, 1
    ds_add_u32 v12, v13 offset:36
    s_mov_b64 exec, -1
    s_lshl_b32 s42, s2, 8
    s_add_u32 s42, s42, 12648576
    v_mov_b32 v14, 0
    v_mov_b32 v15, 0
    s_mov_b64 exec, 1
    buffer_store_dwordx2 v[14:15], off, s[36:39], s42 sc0 sc1
    s_cmp_ge_u32 s2, 8
    s_cbranch_scc1 k_nocz
    s_lshl_b32 s42, s2, 7
    s_add_u32 s42, s42, 12587008
    buffer_store_dword v14, off, s[36:39], s42 sc0 sc1
k_nocz:
    s_mov_b64 exec, -1
    v_lshrrev_b32 v5, 3, v1
    v_and_b32 v3, 7, v1
    v_lshlrev_b32 v4, 7, v3
    v_lshl_add_u32 v4, v5, 1, v4
    v_add_u32 v4, 139264, v4
    v_lshlrev_b32 v5, 13, v5
    v_lshl_add_u32 v5, v3, 4, v5
    s_lshl_b32 s60, s45, 19
    s_lshl_b32 s61, s49, 12
    s_add_u32 s60, s60, s61
    s_lshl_b32 s61, s46, 10
    s_add_u32 s60, s60, s61
    s_lshl_b32 s61, s47, 9
    s_add_u32 s60, s60, s61
    s_lshl_b32 s61, s48, 7
    s_add_u32 s60, s60, s61
    s_add_u32 s50, s60, 2097152
    s_waitcnt vmcnt(9)
    s_nop 0
    ds_read_u16 v128, v4 offset:0
    ds_read_u16 v132, v4 offset:4096
    ds_read_u16 v129, v4 offset:1024
    ds_read_u16 v133, v4 offset:5120
    ds_read_u16 v130, v4 offset:2048
    ds_read_u16 v134, v4 offset:6144
    ds_read_u16 v131, v4 offset:3072
    ds_read_u16 v135, v4 offset:7168
    s_waitcnt lgkmcnt(4)
    s_nop 0
    ds_read_u16 v136, v4 offset:16
    ds_read_u16 v140, v4 offset:4112
    ds_read_u16 v137, v4 offset:1040
    ds_read_u16 v141, v4 offset:5136
    ds_read_u16 v138, v4 offset:2064
    ds_read_u16 v142, v4 offset:6160
    ds_read_u16 v139, v4 offset:3088
    ds_read_u16 v143, v4 offset:7184
    s_waitcnt lgkmcnt(8)
    s_nop 0
    v_lshl_or_b32 v128, v132, 16, v128
    v_lshl_or_b32 v129, v133, 16, v129
    v_lshl_or_b32 v130, v134, 16, v130
    v_lshl_or_b32 v131, v135, 16, v131
    buffer_store_dwordx4 v[128:131], v5, s[36:39], s50 offen sc0 sc1
    s_add_u32 s50, s50, 0x10000
    s_waitcnt lgkmcnt(4)
    s_nop 0
    ds_read_u16 v144, v4 offset:32
    ds_read_u16 v148, v4 offset:4128
    ds_read_u16 v145, v4 offset:1056
    ds_read_u16 v149, v4 offset:5152
    ds_read_u16 v146, v4 offset:2080
    ds_read_u16 v150, v4 offset:6176
    ds_read_u16 v147, v4 offset:3104
    ds_read_u16 v151, v4 offset:7200
    s_waitcnt lgkmcnt(8)
    s_nop 0
    v_lshl_or_b32 v136, v140, 16, v136
    v_lshl_or_b32 v137, v141, 16, v137
    v_lshl_or_b32 v138, v142, 16, v138
    v_lshl_or_b32 v139, v143, 16, v139
    buffer_store_dwordx4 v[136:139], v5, s[36:39], s50 offen sc0 sc1
    s_add_u32 s50, s50, 0x10000
    s_waitcnt lgkmcnt(4)
    s_nop 0
    ds_read_u16 v152, v4 offset:48
    ds_read_u16 v156, v4 offset:4144
    ds_read_u16 v153, v4 offset:1072
    ds_read_u16 v157, v4 offset:5168
    ds_read_u16 v154, v4 offset:2096
    ds_read_u16 v158, v4 offset:6192
    ds_read_u16 v155, v4 offset:3120
    ds_read_u16 v159, v4 offset:7216
    s_waitcnt lgkmcnt(8)
    s_nop 0
    v_lshl_or_b32 v144, v148, 16, v144
    v_lshl_or_b32 v145, v149, 16, v145
    v_lshl_or_b32 v146, v150, 16, v146
    v_lshl_or_b32 v147, v151, 16, v147
    buffer_store_dwordx4 v[144:147], v5, s[36:39], s50 offen sc0 sc1
    s_add_u32 s50, s50, 0x10000
    s_waitcnt lgkmcnt(4)
    s_nop 0
    ds_read_u16 v160, v4 offset:64
    ds_read_u16 v164, v4 offset:4160
    ds_read_u16 v161, v4 offset:1088
    ds_read_u16 v165, v4 offset:5184
    ds_read_u16 v162, v4 offset:2112
    ds_read_u16 v166, v4 offset:6208
    ds_read_u16 v163, v4 offset:3136
    ds_read_u16 v167, v4 offset:7232
    s_waitcnt lgkmcnt(8)
    s_nop 0
    v_lshl_or_b32 v152, v156, 16, v152
    v_lshl_or_b32 v153, v157, 16, v153
    v_lshl_or_b32 v154, v158, 16, v154
    v_lshl_or_b32 v155, v159, 16, v155
    buffer_store_dwordx4 v[152:155], v5, s[36:39], s50 offen sc0 sc1
    s_add_u32 s50, s50, 0x10000
    s_waitcnt lgkmcnt(4)
    s_nop 0
    ds_read_u16 v168, v4 offset:80
    ds_read_u16 v172, v4 offset:4176
    ds_read_u16 v169, v4 offset:1104
    ds_read_u16 v173, v4 offset:5200
    ds_read_u16 v170, v4 offset:2128
    ds_read_u16 v174, v4 offset:6224
    ds_read_u16 v171, v4 offset:3152
    ds_read_u16 v175, v4 offset:7248
    s_waitcnt lgkmcnt(8)
    s_nop 0
    v_lshl_or_b32 v160, v164, 16, v160
    v_lshl_or_b32 v161, v165, 16, v161
    v_lshl_or_b32 v162, v166, 16, v162
    v_lshl_or_b32 v163, v167, 16, v163
    buffer_store_dwordx4 v[160:163], v5, s[36:39], s50 offen sc0 sc1
    s_add_u32 s50, s50, 0x10000
    s_waitcnt lgkmcnt(4)
    s_nop 0
    ds_read_u16 v176, v4 offset:96
    ds_read_u16 v180, v4 offset:4192
    ds_read_u16 v177, v4 offset:1120
    ds_read_u16 v181, v4 offset:5216
    ds_read_u16 v178, v4 offset:2144
    ds_read_u16 v182, v4 offset:6240
    ds_read_u16 v179, v4 offset:3168
    ds_read_u16 v183, v4 offset:7264
    s_waitcnt lgkmcnt(8)
    s_nop 0
    v_lshl_or_b32 v168, v172, 16, v168
    v_lshl_or_b32 v169, v173, 16, v169
    v_lshl_or_b32 v170, v174, 16, v170
    v_lshl_or_b32 v171, v175, 16, v171
    buffer_store_dwordx4 v[168:171], v5, s[36:39], s50 offen sc0 sc1
    s_add_u32 s50, s50, 0x10000
    s_waitcnt lgkmcnt(4)
    s_nop 0
    ds_read_u16 v184, v4 offset:112
    ds_read_u16 v188, v4 offset:4208
    ds_read_u16 v185, v4 offset:1136
    ds_read_u16 v189, v4 offset:5232
    ds_read_u16 v186, v4 offset:2160
    ds_read_u16 v190, v4 offset:6256
    ds_read_u16 v187, v4 offset:3184
    ds_read_u16 v191, v4 offset:7280
    s_waitcnt lgkmcnt(8)
    s_nop 0
    v_lshl_or_b32 v176, v180, 16, v176
    v_lshl_or_b32 v177, v181, 16, v177
    v_lshl_or_b32 v178, v182, 16, v178
    v_lshl_or_b32 v179, v183, 16, v179
    buffer_store_dwordx4 v[176:179], v5, s[36:39], s50 offen sc0 sc1
    s_add_u32 s50, s50, 0x10000
    s_waitcnt lgkmcnt(4)
    s_mov_b64 exec, 1
    ds_add_u32 v12, v13 offset:36
    s_mov_b64 exec, -1
    s_waitcnt lgkmcnt(0)
    v_lshl_or_b32 v184, v188, 16, v184
    v_lshl_or_b32 v185, v189, 16, v185
    v_lshl_or_b32 v186, v190, 16, v186
    v_lshl_or_b32 v187, v191, 16, v187
    buffer_store_dwordx4 v[184:187], v5, s[36:39], s50 offen sc0 sc1
    s_add_u32 s50, s50, 0x10000
    s_waitcnt vmcnt(0)
    s_and_b32 s43, s2, 1
    s_lshl_b32 s41, s43, 7
    s_mov_b32 s40, 1
    s_atomic_add s40, s[66:67], s41 glc
    s_waitcnt lgkmcnt(0)
    s_and_b32 s40, s40, 127
    s_cmp_lg_u32 s40, 127
    s_cbranch_scc1 zf_4
    s_lshl_b32 s43, s43, 2
    s_add_u32 s43, s43, 12648448
    s_add_u32 s40, s5, 1
    v_mov_b32 v14, s40
    v_lshlrev_b32 v15, 8, v1
    buffer_store_dword v14, v15, s[36:39], s43 offen sc0 sc1
    s_add_u32 s43, s43, 0x4000
    buffer_store_dword v14, v15, s[36:39], s43 offen sc0 sc1
    s_add_u32 s43, s43, 0x4000
    buffer_store_dword v14, v15, s[36:39], s43 offen sc0 sc1
    s_add_u32 s43, s43, 0x4000
    buffer_store_dword v14, v15, s[36:39], s43 offen sc0 sc1
    s_add_u32 s43, s43, 0x4000
    s_mov_b64 exec, -1
zf_4:
    s_setprio 0
    s_branch k_h3
k_main:
    s_mul_i32 s86, s85, 43
    s_add_u32 s87, s86, 43
    s_lshr_b32 s86, s86, 4
    s_lshr_b32 s87, s87, 4
    s_sub_u32 s87, s87, s86
    s_and_b32 s40, s2, 3
    s_bfe_u32 s41, s2, 0x10002
    s_lshl1_add_u32 s40, s40, s41
    s_bfe_u32 s41, s2, 0x20003
    s_lshl2_add_u32 s89, s40, s41
    s_lshr_b32 s90, s2, 5
    s_lshl_b32 s83, s90, 5
    s_add_u32 s83, s83, s89
    s_mov_b64 s[20:21], s[72:73]
    s_mov_b32 s22, 1409024
    s_mov_b32 s23, 0x20000
    s_mov_b64 s[24:25], s[74:75]
    s_mov_b32 s26, 1409024
    s_mov_b32 s27, 0x20000
    s_mov_b64 s[28:29], s[76:77]
    s_mov_b32 s30, 1409024
    s_mov_b32 s31, 0x20000
    s_mov_b64 s[32:33], s[78:79]
    s_mov_b32 s34, 2097152
    s_mov_b32 s35, 0x20000
    s_mov_b32 s38, 0x10000000
    s_mov_b32 s39, 0x20000
    s_add_u32 s80, s36, 12582912
    s_addc_u32 s81, s37, 0
    s_lshl_b32 s40, s2, 8
    s_add_u32 s40, s40, 12648448
    s_add_u32 s64, s36, s40
    s_addc_u32 s65, s37, 0
    s_lshl_b32 s40, s3, 2
    s_add_u32 s40, s40, 155648
    v_mov_b32 v9, s40
    v_lshlrev_b32 v3, 4, v1
    v_and_b32 v20, 31, v1
    v_lshrrev_b32 v21, 5, v1
    v_and_b32 v22, 15, v1
    v_xor_b32 v21, v21, v22
    v_lshlrev_b32 v21, 4, v21
    v_lshl_add_u32 v24, v20, 8, v21
    v_add_u32 v24, s51, v24
    v_xor_b32 v25, 32, v24
    v_xor_b32_e64 v26, 64, v24
    v_xor_b32 v27, 96, v24
    v_xor_b32 v28, 128, v24
    v_xor_b32 v29, 160, v24
    v_xor_b32 v30, 192, v24
    v_xor_b32 v31, 224, v24
    v_bfe_u32 v20, v1, 4, 1
    v_lshrrev_b32 v21, 5, v1
    v_bfe_u32 v22, v1, 2, 2
    v_add_u32 v8, s86, v22
    v_and_b32 v8, 1, v8
    v_lshrrev_b32 v22, 1, v22
    v_lshl_add_u32 v22, v21, 2, v22
    v_lshl_add_u32 v22, v8, 1, v22
    v_lshlrev_b32_e64 v22, 6, v22
    v_lshl_add_u32 v22, v20, 12, v22
    v_lshl_add_u32 v22, v20, 5, v22
    v_and_b32_e64 v21, 1, v1
    v_lshl_add_u32 v22, v21, 4, v22
    v_bfe_u32 v21, v1, 1, 1
    v_lshl_add_u32 v4, v21, 3, v22
    v_xor_b32 v5, 128, v4
    v_xor_b32_e64 v6, 32, v4
    v_xor_b32 v7, 160, v4
    s_mul_i32 s62, s50, 86
    s_lshl1_add_u32 s62, s86, s62
    s_lshl_b32 s62, s62, 10
    s_add_u32 s62, s62, 6293504
    s_and_b32 s61, s50, 31
    s_bfe_u32 s40, s61, 0x20003
    s_and_b32 s41, s61, 4
    s_add_u32 s40, s40, s41
    s_and_b32 s41, s61, 3
    s_lshl3_add_u32 s59, s41, s40
    s_lshl_b32 s59, s59, 8
    s_lshr_b32 s40, s61, 5
    s_lshl2_add_u32 s59, s40, s59
    s_add_u32 s59, s59, 12648576
    s_add_u32 s60, s36, s59
    s_addc_u32 s61, s37, 0
    s_mov_b32 s56, 0x3f803f80
    s_mov_b32 s57, 0x00003f80
    s_mov_b32 s58, 0x3f800000
    s_add_u32 s41, s51, 8192
    s_mov_b32 s42, s63
    s_add_u32 m0, s41, s42
    s_lshl_b32 s42, s42, 5
    s_add_u32 s40, s42, s53
    buffer_load_dwordx4 v16, s[8:11], s40 offen lds
    s_xor_b32 s42, s63, 1024
    s_add_u32 m0, s41, s42
    s_lshl_b32 s42, s42, 5
    s_add_u32 s40, s42, s53
    buffer_load_dwordx4 v17, s[8:11], s40 offen lds
    s_xor_b32 s42, s63, 2048
    s_add_u32 m0, s41, s42
    s_lshl_b32 s42, s42, 5
    s_add_u32 s40, s42, s53
    buffer_load_dwordx4 v18, s[8:11], s40 offen lds
    s_xor_b32 s42, s63, 3072
    s_add_u32 m0, s41, s42
    s_lshl_b32 s42, s42, 5
    s_add_u32 s40, s42, s53
    buffer_load_dwordx4 v19, s[8:11], s40 offen lds
    s_xor_b32 s42, s63, 4096
    s_add_u32 m0, s41, s42
    s_lshl_b32 s42, s42, 5
    s_add_u32 s40, s42, s53
    buffer_load_dwordx4 v16, s[8:11], s40 offen lds
    s_xor_b32 s42, s63, 5120
    s_add_u32 m0, s41, s42
    s_lshl_b32 s42, s42, 5
    s_add_u32 s40, s42, s53
    buffer_load_dwordx4 v17, s[8:11], s40 offen lds
    s_xor_b32 s42, s63, 6144
    s_add_u32 m0, s41, s42
    s_lshl_b32 s42, s42, 5
    s_add_u32 s40, s42, s53
    buffer_load_dwordx4 v18, s[8:11], s40 offen lds
    s_xor_b32 s42, s63, 7168
    s_add_u32 m0, s41, s42
    s_lshl_b32 s42, s42, 5
    s_add_u32 s40, s42, s53
    buffer_load_dwordx4 v19, s[8:11], s40 offen lds
    s_waitcnt vmcnt(8)
    s_nop 0
    ds_read_b128 v[128:131], v24 offset:0
    ds_read_b128 v[132:135], v25 offset:0
    ds_read_b128 v[136:139], v26 offset:0
    ds_read_b128 v[140:143], v27 offset:0
    ds_read_b128 v[144:147], v28 offset:0
    ds_read_b128 v[148:151], v29 offset:0
    ds_read_b128 v[152:155], v30 offset:0
    ds_read_b128 v[156:159], v31 offset:0
    v_mov_b32_e64 v14, 1
    ds_write_b32 v9, v14 offset:16
    s_add_u32 s41, s51, 16384
    s_mov_b32 s42, s63
    s_add_u32 m0, s41, s42
    s_lshl_b32 s42, s42, 5
    s_add_u32 s40, s42, s54
    buffer_load_dwordx4 v16, s[8:11], s40 offen lds
    s_waitcnt lgkmcnt(6)
    s_nop 0
    v_dot2_f32_bf16 v10, v128, s56, 0
    v_dot2_f32_bf16 v11, v128, v128, 0
    v_dot2_f32_bf16 v10, v129, s56, v10
    v_dot2_f32_bf16 v11, v129, v129, v11
    v_dot2_f32_bf16 v10, v130, s56, v10
    v_dot2_f32_bf16 v11, v130, v130, v11
    v_dot2_f32_bf16 v10, v131, s56, v10
    v_dot2_f32_bf16 v11, v131, v131, v11
    s_xor_b32 s42, s63, 1024
    s_add_u32 m0, s41, s42
    s_lshl_b32 s42, s42, 5
    s_add_u32 s40, s42, s54
    s_nop 0
    buffer_load_dwordx4 v17, s[8:11], s40 offen lds
    v_dot2_f32_bf16 v10, v132, s56, v10
    v_dot2_f32_bf16 v11, v132, v132, v11
    v_dot2_f32_bf16 v10, v133, s56, v10
    v_dot2_f32_bf16 v11, v133, v133, v11
    v_dot2_f32_bf16 v10, v134, s56, v10
    v_dot2_f32_bf16 v11, v134, v134, v11
    v_dot2_f32_bf16 v10, v135, s56, v10
    v_dot2_f32_bf16 v11, v135, v135, v11
    s_xor_b32 s42, s63, 2048
    s_add_u32 m0, s41, s42
    s_lshl_b32 s42, s42, 5
    s_add_u32 s40, s42, s54
    buffer_load_dwordx4 v18, s[8:11], s40 offen lds
    s_waitcnt lgkmcnt(4)
    v_dot2_f32_bf16 v10, v136, s56, v10
    v_dot2_f32_bf16 v11, v136, v136, v11
    v_dot2_f32_bf16 v10, v137, s56, v10
    v_dot2_f32_bf16 v11, v137, v137, v11
    v_dot2_f32_bf16 v10, v138, s56, v10
    v_dot2_f32_bf16 v11, v138, v138, v11
    v_dot2_f32_bf16 v10, v139, s56, v10
    v_dot2_f32_bf16 v11, v139, v139, v11
    s_xor_b32 s42, s63, 3072
    s_add_u32 m0, s41, s42
    s_lshl_b32 s42, s42, 5
    s_add_u32 s40, s42, s54
    s_nop 0
    buffer_load_dwordx4 v19, s[8:11], s40 offen lds
    v_dot2_f32_bf16 v10, v140, s56, v10
    v_dot2_f32_bf16 v11, v140, v140, v11
    v_dot2_f32_bf16 v10, v141, s56, v10
    v_dot2_f32_bf16 v11, v141, v141, v11
    v_dot2_f32_bf16 v10, v142, s56, v10
    v_dot2_f32_bf16 v11, v142, v142, v11
    v_dot2_f32_bf16 v10, v143, s56, v10
    v_dot2_f32_bf16 v11, v143, v143, v11
    s_xor_b32 s42, s63, 4096
    s_add_u32 m0, s41, s42
    s_lshl_b32 s42, s42, 5
    s_add_u32 s40, s42, s54
    buffer_load_dwordx4 v16, s[8:11], s40 offen lds
    s_waitcnt lgkmcnt(2)
    v_dot2_f32_bf16 v10, v144, s56, v10
    v_dot2_f32_bf16 v11, v144, v144, v11
    v_dot2_f32_bf16 v10, v145, s56, v10
    v_dot2_f32_bf16 v11, v145, v145, v11
    v_dot2_f32_bf16 v10, v146, s56, v10
    v_dot2_f32_bf16 v11, v146, v146, v11
    v_dot2_f32_bf16 v10, v147, s56, v10
    v_dot2_f32_bf16 v11, v147, v147, v11
    s_xor_b32 s42, s63, 5120
    s_add_u32 m0, s41, s42
    s_lshl_b32 s42, s42, 5
    s_add_u32 s40, s42, s54
    s_nop 0
    buffer_load_dwordx4 v17, s[8:11], s40 offen lds
    v_dot2_f32_bf16 v10, v148, s56, v10
    v_dot2_f32_bf16 v11, v148, v148, v11
    v_dot2_f32_bf16 v10, v149, s56, v10
    v_dot2_f32_bf16 v11, v149, v149, v11
    v_dot2_f32_bf16 v10, v150, s56, v10
    v_dot2_f32_bf16 v11, v150, v150, v11
    v_dot2_f32_bf16 v10, v151, s56, v10
    v_dot2_f32_bf16 v11, v151, v151, v11
    s_xor_b32 s42, s63, 6144
    s_add_u32 m0, s41, s42
    s_lshl_b32 s42, s42, 5
    s_add_u32 s40, s42, s54
    buffer_load_dwordx4 v18, s[8:11], s40 offen lds
    s_waitcnt lgkmcnt(0)
    v_dot2_f32_bf16 v10, v152, s56, v10
    v_dot2_f32_bf16 v11, v152, v152, v11
    v_dot2_f32_bf16 v10, v153, s56, v10
    v_dot2_f32_bf16 v11, v153, v153, v11
    v_dot2_f32_bf16 v10, v154, s56, v10
    v_dot2_f32_bf16 v11, v154, v154, v11
    v_dot2_f32_bf16 v10, v155, s56, v10
    v_dot2_f32_bf16 v11, v155, v155, v11
    s_xor_b32 s42, s63, 7168
    s_add_u32 m0, s41, s42
    s_lshl_b32 s42, s42, 5
    s_add_u32 s40, s42, s54
    s_nop 0
    buffer_load_dwordx4 v19, s[8:11], s40 offen lds
    v_dot2_f32_bf16 v10, v156, s56, v10
    v_dot2_f32_bf16 v11, v156, v156, v11
    v_dot2_f32_bf16 v10, v157, s56, v10
    v_dot2_f32_bf16 v11, v157, v157, v11
    v_dot2_f32_bf16 v10, v158, s56, v10
    v_dot2_f32_bf16 v11, v158, v158, v11
    v_dot2_f32_bf16 v10, v159, s56, v10
    v_dot2_f32_bf16 v11, v159, v159, v11
    s_waitcnt vmcnt(8)
    s_nop 0
    ds_read_b128 v[160:163], v24 offset:8192
    ds_read_b128 v[164:167], v25 offset:8192
    ds_read_b128 v[168:171], v26 offset:8192
    ds_read_b128 v[172:175], v27 offset:8192
    ds_read_b128 v[176:179], v28 offset:8192
    ds_read_b128 v[180:183], v29 offset:8192
    ds_read_b128 v[184:187], v30 offset:8192
    ds_read_b128 v[188:191], v31 offset:8192
    v_mov_b32_e64 v14, 2
    ds_write_b32 v9, v14 offset:16
    s_add_u32 s41, s51, 24576
    s_mov_b32 s42, s63
    s_add_u32 m0, s41, s42
    s_lshl_b32 s42, s42, 5
    s_add_u32 s40, s42, s55
    buffer_load_dwordx4 v16, s[8:11], s40 offen lds
    s_waitcnt lgkmcnt(6)
    s_nop 0
    v_dot2_f32_bf16 v10, v160, s56, v10
    v_dot2_f32_bf16 v11, v160, v160, v11
    v_dot2_f32_bf16 v10, v161, s56, v10
    v_dot2_f32_bf16 v11, v161, v161, v11
    v_dot2_f32_bf16 v10, v162, s56, v10
    v_dot2_f32_bf16 v11, v162, v162, v11
    v_dot2_f32_bf16 v10, v163, s56, v10
    v_dot2_f32_bf16 v11, v163, v163, v11
    s_xor_b32 s42, s63, 1024
    s_add_u32 m0, s41, s42
    s_lshl_b32 s42, s42, 5
    s_add_u32 s40, s42, s55
    s_nop 0
    buffer_load_dwordx4 v17, s[8:11], s40 offen lds
    v_dot2_f32_bf16 v10, v164, s56, v10
    v_dot2_f32_bf16 v11, v164, v164, v11
    v_dot2_f32_bf16 v10, v165, s56, v10
    v_dot2_f32_bf16 v11, v165, v165, v11
    v_dot2_f32_bf16 v10, v166, s56, v10
    v_dot2_f32_bf16 v11, v166, v166, v11
    v_dot2_f32_bf16 v10, v167, s56, v10
    v_dot2_f32_bf16 v11, v167, v167, v11
    s_xor_b32 s42, s63, 2048
    s_add_u32 m0, s41, s42
    s_lshl_b32 s42, s42, 5
    s_add_u32 s40, s42, s55
    buffer_load_dwordx4 v18, s[8:11], s40 offen lds
    s_waitcnt lgkmcnt(4)
    v_dot2_f32_bf16 v10, v168, s56, v10
    v_dot2_f32_bf16 v11, v168, v168, v11
    v_dot2_f32_bf16 v10, v169, s56, v10
    v_dot2_f32_bf16 v11, v169, v169, v11
    v_dot2_f32_bf16 v10, v170, s56, v10
    v_dot2_f32_bf16 v11, v170, v170, v11
    v_dot2_f32_bf16 v10, v171, s56, v10
    v_dot2_f32_bf16 v11, v171, v171, v11
    s_xor_b32 s42, s63, 3072
    s_add_u32 m0, s41, s42
    s_lshl_b32 s42, s42, 5
    s_add_u32 s40, s42, s55
    s_nop 0
    buffer_load_dwordx4 v19, s[8:11], s40 offen lds
    v_dot2_f32_bf16 v10, v172, s56, v10
    v_dot2_f32_bf16 v11, v172, v172, v11
    v_dot2_f32_bf16 v10, v173, s56, v10
    v_dot2_f32_bf16 v11, v173, v173, v11
    v_dot2_f32_bf16 v10, v174, s56, v10
    v_dot2_f32_bf16 v11, v174, v174, v11
    v_dot2_f32_bf16 v10, v175, s56, v10
    v_dot2_f32_bf16 v11, v175, v175, v11
    s_xor_b32 s42, s63, 4096
    s_add_u32 m0, s41, s42
    s_lshl_b32 s42, s42, 5
    s_add_u32 s40, s42, s55
    buffer_load_dwordx4 v16, s[8:11], s40 offen lds
    s_waitcnt lgkmcnt(2)
    v_dot2_f32_bf16 v10, v176, s56, v10
    v_dot2_f32_bf16 v11, v176, v176, v11
    v_dot2_f32_bf16 v10, v177, s56, v10
    v_dot2_f32_bf16 v11, v177, v177, v11
    v_dot2_f32_bf16 v10, v178, s56, v10
    v_dot2_f32_bf16 v11, v178, v178, v11
    v_dot2_f32_bf16 v10, v179, s56, v10
    v_dot2_f32_bf16 v11, v179, v179, v11
    s_xor_b32 s42, s63, 5120
    s_add_u32 m0, s41, s42
    s_lshl_b32 s42, s42, 5
    s_add_u32 s40, s42, s55
    s_nop 0
    buffer_load_dwordx4 v17, s[8:11], s40 offen lds
    v_dot2_f32_bf16 v10, v180, s56, v10
    v_dot2_f32_bf16 v11, v180, v180, v11
    v_dot2_f32_bf16 v10, v181, s56, v10
    v_dot2_f32_bf16 v11, v181, v181, v11
    v_dot2_f32_bf16 v10, v182, s56, v10
    v_dot2_f32_bf16 v11, v182, v182, v11
    v_dot2_f32_bf16 v10, v183, s56, v10
    v_dot2_f32_bf16 v11, v183, v183, v11
    s_xor_b32 s42, s63, 6144
    s_add_u32 m0, s41, s42
    s_lshl_b32 s42, s42, 5
    s_add_u32 s40, s42, s55
    buffer_load_dwordx4 v18, s[8:11], s40 offen lds
    s_waitcnt lgkmcnt(0)
    v_dot2_f32_bf16 v10, v184, s56, v10
    v_dot2_f32_bf16 v11, v184, v184, v11
    v_dot2_f32_bf16 v10, v185, s56, v10
    v_dot2_f32_bf16 v11, v185, v185, v11
    v_dot2_f32_bf16 v10, v186, s56, v10
    v_dot2_f32_bf16 v11, v186, v186, v11
    v_dot2_f32_bf16 v10, v187, s56, v10
    v_dot2_f32_bf16 v11, v187, v187, v11
    s_xor_b32 s42, s63, 7168
    s_add_u32 m0, s41, s42
    s_lshl_b32 s42, s42, 5
    s_add_u32 s40, s42, s55
    s_nop 0
    buffer_load_dwordx4 v19, s[8:11], s40 offen lds
    v_dot2_f32_bf16 v10, v188, s56, v10
    v_dot2_f32_bf16 v11, v188, v188, v11
    v_dot2_f32_bf16 v10, v189, s56, v10
    v_dot2_f32_bf16 v11, v189, v189, v11
    v_dot2_f32_bf16 v10, v190, s56, v10
    v_dot2_f32_bf16 v11, v190, v190, v11
    v_dot2_f32_bf16 v10, v191, s56, v10
    v_dot2_f32_bf16 v11, v191, v191, v11
    s_waitcnt vmcnt(8)
    s_nop 0
    ds_read_b128 v[192:195], v24 offset:16384
    ds_read_b128 v[196:199], v25 offset:16384
    ds_read_b128 v[200:203], v26 offset:16384
    ds_read_b128 v[204:207], v27 offset:16384
    ds_read_b128 v[208:211], v28 offset:16384
    ds_read_b128 v[212:215], v29 offset:16384
    ds_read_b128 v[216:219], v30 offset:16384
    ds_read_b128 v[220:223], v31 offset:16384
    v_mov_b32 v14, 3
    ds_write_b32 v9, v14 offset:16
    s_waitcnt lgkmcnt(6)
    v_dot2_f32_bf16 v10, v192, s56, v10
    v_dot2_f32_bf16 v11, v192, v192, v11
    v_dot2_f32_bf16 v10, v193, s56, v10
    v_dot2_f32_bf16 v11, v193, v193, v11
    v_dot2_f32_bf16 v10, v194, s56, v10
    v_dot2_f32_bf16 v11, v194, v194, v11
    v_dot2_f32_bf16 v10, v195, s56, v10
    v_dot2_f32_bf16 v11, v195, v195, v11
    v_dot2_f32_bf16 v10, v196, s56, v10
    v_dot2_f32_bf16 v11, v196, v196, v11
    v_dot2_f32_bf16 v10, v197, s56, v10
    v_dot2_f32_bf16 v11, v197, v197, v11
    v_dot2_f32_bf16 v10, v198, s56, v10
    v_dot2_f32_bf16 v11, v198, v198, v11
    v_dot2_f32_bf16 v10, v199, s56, v10
    v_dot2_f32_bf16 v11, v199, v199, v11
    s_waitcnt lgkmcnt(4)
    s_nop 0
    v_dot2_f32_bf16 v10, v200, s56, v10
    v_dot2_f32_bf16 v11, v200, v200, v11
    v_dot2_f32_bf16 v10, v201, s56, v10
    v_dot2_f32_bf16 v11, v201, v201, v11
    v_dot2_f32_bf16 v10, v202, s56, v10
    v_dot2_f32_bf16 v11, v202, v202, v11
    v_dot2_f32_bf16 v10, v203, s56, v10
    v_dot2_f32_bf16 v11, v203, v203, v11
    v_dot2_f32_bf16 v10, v204, s56, v10
    v_dot2_f32_bf16 v11, v204, v204, v11
    v_dot2_f32_bf16 v10, v205, s56, v10
    v_dot2_f32_bf16 v11, v205, v205, v11
    v_dot2_f32_bf16 v10, v206, s56, v10
    v_dot2_f32_bf16 v11, v206, v206, v11
    v_dot2_f32_bf16 v10, v207, s56, v10
    v_dot2_f32_bf16 v11, v207, v207, v11
    s_waitcnt lgkmcnt(2)
    s_nop 0
    v_dot2_f32_bf16 v10, v208, s56, v10
    v_dot2_f32_bf16 v11, v208, v208, v11
    v_dot2_f32_bf16 v10, v209, s56, v10
    v_dot2_f32_bf16 v11, v209, v209, v11
    v_dot2_f32_bf16 v10, v210, s56, v10
    v_dot2_f32_bf16 v11, v210, v210, v11
    v_dot2_f32_bf16 v10, v211, s56, v10
    v_dot2_f32_bf16 v11, v211, v211, v11
    v_dot2_f32_bf16 v10, v212, s56, v10
    v_dot2_f32_bf16 v11, v212, v212, v11
    v_dot2_f32_bf16 v10, v213, s56, v10
    v_dot2_f32_bf16 v11, v213, v213, v11
    v_dot2_f32_bf16 v10, v214, s56, v10
    v_dot2_f32_bf16 v11, v214, v214, v11
    v_dot2_f32_bf16 v10, v215, s56, v10
    v_dot2_f32_bf16 v11, v215, v215, v11
    s_waitcnt lgkmcnt(0)
    s_nop 0
    v_dot2_f32_bf16 v10, v216, s56, v10
    v_dot2_f32_bf16 v11, v216, v216, v11
    v_dot2_f32_bf16 v10, v217, s56, v10
    v_dot2_f32_bf16 v11, v217, v217, v11
    v_dot2_f32_bf16 v10, v218, s56, v10
    v_dot2_f32_bf16 v11, v218, v218, v11
    v_dot2_f32_bf16 v10, v219, s56, v10
    v_dot2_f32_bf16 v11, v219, v219, v11
    v_dot2_f32_bf16 v10, v220, s56, v10
    v_dot2_f32_bf16 v11, v220, v220, v11
    v_dot2_f32_bf16 v10, v221, s56, v10
    v_dot2_f32_bf16 v11, v221, v221, v11
    v_dot2_f32_bf16 v10, v222, s56, v10
    v_dot2_f32_bf16 v11, v222, v222, v11
    v_dot2_f32_bf16 v10, v223, s56, v10
    v_dot2_f32_bf16 v11, v223, v223, v11
    s_waitcnt vmcnt(0)
    s_nop 0
    ds_read_b128 v[224:227], v24 offset:24576
    ds_read_b128 v[228:231], v25 offset:24576
    ds_read_b128 v[232:235], v26 offset:24576
    ds_read_b128 v[236:239], v27 offset:24576
    ds_read_b128 v[240:243], v28 offset:24576
    ds_read_b128 v[244:247], v29 offset:24576
    ds_read_b128 v[248:251], v30 offset:24576
    ds_read_b128 v[252:255], v31 offset:24576
    v_mov_b32 v14, 4
    ds_write_b32 v9, v14 offset:16
    s_waitcnt lgkmcnt(6)
    v_dot2_f32_bf16 v10, v224, s56, v10
    v_dot2_f32_bf16 v11, v224, v224, v11
    v_dot2_f32_bf16 v10, v225, s56, v10
    v_dot2_f32_bf16 v11, v225, v225, v11
    v_dot2_f32_bf16 v10, v226, s56, v10
    v_dot2_f32_bf16 v11, v226, v226, v11
    v_dot2_f32_bf16 v10, v227, s56, v10
    v_dot2_f32_bf16 v11, v227, v227, v11
    v_dot2_f32_bf16 v10, v228, s56, v10
    v_dot2_f32_bf16 v11, v228, v228, v11
    v_dot2_f32_bf16 v10, v229, s56, v10
    v_dot2_f32_bf16 v11, v229, v229, v11
    v_dot2_f32_bf16 v10, v230, s56, v10
    v_dot2_f32_bf16 v11, v230, v230, v11
    v_dot2_f32_bf16 v10, v231, s56, v10
    v_dot2_f32_bf16 v11, v231, v231, v11
    s_waitcnt lgkmcnt(4)
    s_nop 0
    v_dot2_f32_bf16 v10, v232, s56, v10
    v_dot2_f32_bf16 v11, v232, v232, v11
    v_dot2_f32_bf16 v10, v233, s56, v10
    v_dot2_f32_bf16 v11, v233, v233, v11
    v_dot2_f32_bf16 v10, v234, s56, v10
    v_dot2_f32_bf16 v11, v234, v234, v11
    v_dot2_f32_bf16 v10, v235, s56, v10
    v_dot2_f32_bf16 v11, v235, v235, v11
    v_dot2_f32_bf16 v10, v236, s56, v10
    v_dot2_f32_bf16 v11, v236, v236, v11
    v_dot2_f32_bf16 v10, v237, s56, v10
    v_dot2_f32_bf16 v11, v237, v237, v11
    v_dot2_f32_bf16 v10, v238, s56, v10
    v_dot2_f32_bf16 v11, v238, v238, v11
    v_dot2_f32_bf16 v10, v239, s56, v10
    v_dot2_f32_bf16 v11, v239, v239, v11
    s_waitcnt lgkmcnt(2)
    s_nop 0
    v_dot2_f32_bf16 v10, v240, s56, v10
    v_dot2_f32_bf16 v11, v240, v240, v11
    v_dot2_f32_bf16 v10, v241, s56, v10
    v_dot2_f32_bf16 v11, v241, v241, v11
    v_dot2_f32_bf16 v10, v242, s56, v10
    v_dot2_f32_bf16 v11, v242, v242, v11
    v_dot2_f32_bf16 v10, v243, s56, v10
    v_dot2_f32_bf16 v11, v243, v243, v11
    v_dot2_f32_bf16 v10, v244, s56, v10
    v_dot2_f32_bf16 v11, v244, v244, v11
    v_dot2_f32_bf16 v10, v245, s56, v10
    v_dot2_f32_bf16 v11, v245, v245, v11
    v_dot2_f32_bf16 v10, v246, s56, v10
    v_dot2_f32_bf16 v11, v246, v246, v11
    v_dot2_f32_bf16 v10, v247, s56, v10
    v_dot2_f32_bf16 v11, v247, v247, v11
    s_waitcnt lgkmcnt(0)
    s_nop 0
    v_dot2_f32_bf16 v10, v248, s56, v10
    v_dot2_f32_bf16 v11, v248, v248, v11
    v_dot2_f32_bf16 v10, v249, s56, v10
    v_dot2_f32_bf16 v11, v249, v249, v11
    v_dot2_f32_bf16 v10, v250, s56, v10
    v_dot2_f32_bf16 v11, v250, v250, v11
    v_dot2_f32_bf16 v10, v251, s56, v10
    v_dot2_f32_bf16 v11, v251, v251, v11
    v_dot2_f32_bf16 v10, v252, s56, v10
    v_dot2_f32_bf16 v11, v252, v252, v11
    v_dot2_f32_bf16 v10, v253, s56, v10
    v_dot2_f32_bf16 v11, v253, v253, v11
    v_dot2_f32_bf16 v10, v254, s56, v10
    v_dot2_f32_bf16 v11, v254, v254, v11
    v_dot2_f32_bf16 v10, v255, s56, v10
    v_dot2_f32_bf16 v11, v255, v255, v11
    s_nop 1
    v_mov_b32 v12, v10
    v_mov_b32 v13, v11
    s_nop 0
    v_permlane32_swap_b32 v12, v10
    v_permlane32_swap_b32 v13, v11
    v_add_f32 v10, v10, v12
    v_add_f32 v11, v11, v13
    v_mul_f32 v10, 0x3b000000, v10
    v_cvt_pk_bf16_f32 v31, -v10, -v10
    v_and_b32 v31, 0xffff0000, v31
    v_dot2_f32_bf16 v16, v128, s57, v31
    v_dot2_f32_bf16 v17, v128, s58, v31
    v_dot2_f32_bf16 v18, v129, s57, v31
    v_dot2_f32_bf16 v19, v129, s58, v31
    v_dot2_f32_bf16 v20, v130, s57, v31
    v_dot2_f32_bf16 v21, v130, s58, v31
    v_dot2_f32_bf16 v22, v131, s57, v31
    v_dot2_f32_bf16 v23, v131, s58, v31
    v_mul_f32 v11, 0x3b000000, v11
    v_cvt_pk_bf16_f32 v128, v16, v17
    v_cvt_pk_bf16_f32 v129, v18, v19
    v_cvt_pk_bf16_f32 v130, v20, v21
    v_cvt_pk_bf16_f32 v131, v22, v23
    v_dot2_f32_bf16 v16, v132, s57, v31
    v_dot2_f32_bf16 v17, v132, s58, v31
    v_dot2_f32_bf16 v18, v133, s57, v31
    v_dot2_f32_bf16 v19, v133, s58, v31
    v_dot2_f32_bf16 v20, v134, s57, v31
    v_dot2_f32_bf16 v21, v134, s58, v31
    v_dot2_f32_bf16 v22, v135, s57, v31
    v_dot2_f32_bf16 v23, v135, s58, v31
    v_fma_f32 v11, -v10, v10, v11
    v_cvt_pk_bf16_f32 v132, v16, v17
    v_cvt_pk_bf16_f32 v133, v18, v19
    v_cvt_pk_bf16_f32 v134, v20, v21
    v_cvt_pk_bf16_f32 v135, v22, v23
    v_dot2_f32_bf16 v16, v136, s57, v31
    v_dot2_f32_bf16 v17, v136, s58, v31
    v_dot2_f32_bf16 v18, v137, s57, v31
    v_dot2_f32_bf16 v19, v137, s58, v31
    v_dot2_f32_bf16 v20, v138, s57, v31
    v_dot2_f32_bf16 v21, v138, s58, v31
    v_dot2_f32_bf16 v22, v139, s57, v31
    v_dot2_f32_bf16 v23, v139, s58, v31
    v_max_f32_e64 v11, 0, v11
    v_cvt_pk_bf16_f32 v136, v16, v17
    v_cvt_pk_bf16_f32 v137, v18, v19
    v_cvt_pk_bf16_f32 v138, v20, v21
    v_cvt_pk_bf16_f32 v139, v22, v23
    v_dot2_f32_bf16 v16, v140, s57, v31
    v_dot2_f32_bf16 v17, v140, s58, v31
    v_dot2_f32_bf16 v18, v141, s57, v31
    v_dot2_f32_bf16 v19, v141, s58, v31
    v_dot2_f32_bf16 v20, v142, s57, v31
    v_dot2_f32_bf16 v21, v142, s58, v31
    v_dot2_f32_bf16 v22, v143, s57, v31
    v_dot2_f32_bf16 v23, v143, s58, v31
    v_cvt_pk_bf16_f32 v11, v11, v11
    v_cvt_pk_bf16_f32 v140, v16, v17
    v_cvt_pk_bf16_f32 v141, v18, v19
    v_cvt_pk_bf16_f32 v142, v20, v21
    v_cvt_pk_bf16_f32 v143, v22, v23
    v_dot2_f32_bf16 v16, v144, s57, v31
    v_dot2_f32_bf16 v17, v144, s58, v31
    v_dot2_f32_bf16 v18, v145, s57, v31
    v_dot2_f32_bf16 v19, v145, s58, v31
    v_dot2_f32_bf16 v20, v146, s57, v31
    v_dot2_f32_bf16 v21, v146, s58, v31
    v_dot2_f32_bf16 v22, v147, s57, v31
    v_dot2_f32_bf16 v23, v147, s58, v31
    v_and_b32 v11, 0xffff0000, v11
    v_cvt_pk_bf16_f32 v144, v16, v17
    v_cvt_pk_bf16_f32 v145, v18, v19
    v_cvt_pk_bf16_f32 v146, v20, v21
    v_cvt_pk_bf16_f32 v147, v22, v23
    v_dot2_f32_bf16 v16, v148, s57, v31
    v_dot2_f32_bf16 v17, v148, s58, v31
    v_dot2_f32_bf16 v18, v149, s57, v31
    v_dot2_f32_bf16 v19, v149, s58, v31
    v_dot2_f32_bf16 v20, v150, s57, v31
    v_dot2_f32_bf16 v21, v150, s58, v31
    v_dot2_f32_bf16 v22, v151, s57, v31
    v_dot2_f32_bf16 v23, v151, s58, v31
    v_add_f32 v11, 0x3727c5ac, v11
    v_cvt_pk_bf16_f32 v148, v16, v17
    v_cvt_pk_bf16_f32 v149, v18, v19
    v_cvt_pk_bf16_f32 v150, v20, v21
    v_cvt_pk_bf16_f32 v151, v22, v23
    v_dot2_f32_bf16 v16, v152, s57, v31
    v_dot2_f32_bf16 v17, v152, s58, v31
    v_dot2_f32_bf16 v18, v153, s57, v31
    v_dot2_f32_bf16 v19, v153, s58, v31
    v_dot2_f32_bf16 v20, v154, s57, v31
    v_dot2_f32_bf16 v21, v154, s58, v31
    v_dot2_f32_bf16 v22, v155, s57, v31
    v_dot2_f32_bf16 v23, v155, s58, v31
    v_cvt_pk_bf16_f32 v11, v11, v11
    v_cvt_pk_bf16_f32 v152, v16, v17
    v_cvt_pk_bf16_f32 v153, v18, v19
    v_cvt_pk_bf16_f32 v154, v20, v21
    v_cvt_pk_bf16_f32 v155, v22, v23
    v_dot2_f32_bf16 v16, v156, s57, v31
    v_dot2_f32_bf16 v17, v156, s58, v31
    v_dot2_f32_bf16 v18, v157, s57, v31
    v_dot2_f32_bf16 v19, v157, s58, v31
    v_dot2_f32_bf16 v20, v158, s57, v31
    v_dot2_f32_bf16 v21, v158, s58, v31
    v_dot2_f32_bf16 v22, v159, s57, v31
    v_dot2_f32_bf16 v23, v159, s58, v31
    v_and_b32 v11, 0xffff0000, v11
    v_cvt_pk_bf16_f32 v156, v16, v17
    v_cvt_pk_bf16_f32 v157, v18, v19
    v_cvt_pk_bf16_f32 v158, v20, v21
    v_cvt_pk_bf16_f32 v159, v22, v23
    v_dot2_f32_bf16 v16, v160, s57, v31
    v_dot2_f32_bf16 v17, v160, s58, v31
    v_dot2_f32_bf16 v18, v161, s57, v31
    v_dot2_f32_bf16 v19, v161, s58, v31
    v_dot2_f32_bf16 v20, v162, s57, v31
    v_dot2_f32_bf16 v21, v162, s58, v31
    v_dot2_f32_bf16 v22, v163, s57, v31
    v_dot2_f32_bf16 v23, v163, s58, v31
    v_sqrt_f32_e64 v11, v11
    v_cvt_pk_bf16_f32 v160, v16, v17
    v_cvt_pk_bf16_f32 v161, v18, v19
    v_cvt_pk_bf16_f32 v162, v20, v21
    v_cvt_pk_bf16_f32 v163, v22, v23
    v_dot2_f32_bf16 v16, v164, s57, v31
    v_dot2_f32_bf16 v17, v164, s58, v31
    v_dot2_f32_bf16 v18, v165, s57, v31
    v_dot2_f32_bf16 v19, v165, s58, v31
    v_dot2_f32_bf16 v20, v166, s57, v31
    v_dot2_f32_bf16 v21, v166, s58, v31
    v_dot2_f32_bf16 v22, v167, s57, v31
    v_dot2_f32_bf16 v23, v167, s58, v31
    v_cvt_pk_bf16_f32 v11, v11, v11
    v_cvt_pk_bf16_f32 v164, v16, v17
    v_cvt_pk_bf16_f32 v165, v18, v19
    v_cvt_pk_bf16_f32 v166, v20, v21
    v_cvt_pk_bf16_f32 v167, v22, v23
    v_dot2_f32_bf16 v16, v168, s57, v31
    v_dot2_f32_bf16 v17, v168, s58, v31
    v_dot2_f32_bf16 v18, v169, s57, v31
    v_dot2_f32_bf16 v19, v169, s58, v31
    v_dot2_f32_bf16 v20, v170, s57, v31
    v_dot2_f32_bf16 v21, v170, s58, v31
    v_dot2_f32_bf16 v22, v171, s57, v31
    v_dot2_f32_bf16 v23, v171, s58, v31
    v_and_b32 v11, 0xffff0000, v11
    v_cvt_pk_bf16_f32 v168, v16, v17
    v_cvt_pk_bf16_f32 v169, v18, v19
    v_cvt_pk_bf16_f32 v170, v20, v21
    v_cvt_pk_bf16_f32 v171, v22, v23
    v_dot2_f32_bf16 v16, v172, s57, v31
    v_dot2_f32_bf16 v17, v172, s58, v31
    v_dot2_f32_bf16 v18, v173, s57, v31
    v_dot2_f32_bf16 v19, v173, s58, v31
    v_dot2_f32_bf16 v20, v174, s57, v31
    v_dot2_f32_bf16 v21, v174, s58, v31
    v_dot2_f32_bf16 v22, v175, s57, v31
    v_dot2_f32_bf16 v23, v175, s58, v31
    v_rcp_f32_e64 v11, v11
    v_cvt_pk_bf16_f32 v172, v16, v17
    v_cvt_pk_bf16_f32 v173, v18, v19
    v_cvt_pk_bf16_f32 v174, v20, v21
    v_cvt_pk_bf16_f32 v175, v22, v23
    v_dot2_f32_bf16 v16, v176, s57, v31
    v_dot2_f32_bf16 v17, v176, s58, v31
    v_dot2_f32_bf16 v18, v177, s57, v31
    v_dot2_f32_bf16 v19, v177, s58, v31
    v_dot2_f32_bf16 v20, v178, s57, v31
    v_dot2_f32_bf16 v21, v178, s58, v31
    v_dot2_f32_bf16 v22, v179, s57, v31
    v_dot2_f32_bf16 v23, v179, s58, v31
    v_mul_f32 v10, 0xbfb8aa3b, v11
    v_cvt_pk_bf16_f32 v176, v16, v17
    v_cvt_pk_bf16_f32 v177, v18, v19
    v_cvt_pk_bf16_f32 v178, v20, v21
    v_cvt_pk_bf16_f32 v179, v22, v23
    v_dot2_f32_bf16 v16, v180, s57, v31
    v_dot2_f32_bf16 v17, v180, s58, v31
    v_dot2_f32_bf16 v18, v181, s57, v31
    v_dot2_f32_bf16 v19, v181, s58, v31
    v_dot2_f32_bf16 v20, v182, s57, v31
    v_dot2_f32_bf16 v21, v182, s58, v31
    v_dot2_f32_bf16 v22, v183, s57, v31
    v_dot2_f32_bf16 v23, v183, s58, v31
    v_mul_f32_e64 v11, v11, v11
    v_cvt_pk_bf16_f32 v180, v16, v17
    v_cvt_pk_bf16_f32 v181, v18, v19
    v_cvt_pk_bf16_f32 v182, v20, v21
    v_cvt_pk_bf16_f32 v183, v22, v23
    v_dot2_f32_bf16 v16, v184, s57, v31
    v_dot2_f32_bf16 v17, v184, s58, v31
    v_dot2_f32_bf16 v18, v185, s57, v31
    v_dot2_f32_bf16 v19, v185, s58, v31
    v_dot2_f32_bf16 v20, v186, s57, v31
    v_dot2_f32_bf16 v21, v186, s58, v31
    v_dot2_f32_bf16 v22, v187, s57, v31
    v_dot2_f32_bf16 v23, v187, s58, v31
    v_rcp_f32_e64 v11, v11
    v_cvt_pk_bf16_f32 v184, v16, v17
    v_cvt_pk_bf16_f32 v185, v18, v19
    v_cvt_pk_bf16_f32 v186, v20, v21
    v_cvt_pk_bf16_f32 v187, v22, v23
    v_dot2_f32_bf16 v16, v188, s57, v31
    v_dot2_f32_bf16 v17, v188, s58, v31
    v_dot2_f32_bf16 v18, v189, s57, v31
    v_dot2_f32_bf16 v19, v189, s58, v31
    v_dot2_f32_bf16 v20, v190, s57, v31
    v_dot2_f32_bf16 v21, v190, s58, v31
    v_dot2_f32_bf16 v22, v191, s57, v31
    v_dot2_f32_bf16 v23, v191, s58, v31
    v_cvt_pk_bf16_f32 v188, v16, v17
    v_cvt_pk_bf16_f32 v189, v18, v19
    v_cvt_pk_bf16_f32 v190, v20, v21
    v_cvt_pk_bf16_f32 v191, v22, v23
    v_dot2_f32_bf16 v16, v192, s57, v31
    v_dot2_f32_bf16 v17, v192, s58, v31
    v_dot2_f32_bf16 v18, v193, s57, v31
    v_dot2_f32_bf16 v19, v193, s58, v31
    v_dot2_f32_bf16 v20, v194, s57, v31
    v_dot2_f32_bf16 v21, v194, s58, v31
    v_dot2_f32_bf16 v22, v195, s57, v31
    v_dot2_f32_bf16 v23, v195, s58, v31
    v_cvt_pk_bf16_f32 v192, v16, v17
    v_cvt_pk_bf16_f32 v193, v18, v19
    v_cvt_pk_bf16_f32 v194, v20, v21
    v_cvt_pk_bf16_f32 v195, v22, v23
    v_dot2_f32_bf16 v16, v196, s57, v31
    v_dot2_f32_bf16 v17, v196, s58, v31
    v_dot2_f32_bf16 v18, v197, s57, v31
    v_dot2_f32_bf16 v19, v197, s58, v31
    v_dot2_f32_bf16 v20, v198, s57, v31
    v_dot2_f32_bf16 v21, v198, s58, v31
    v_dot2_f32_bf16 v22, v199, s57, v31
    v_dot2_f32_bf16 v23, v199, s58, v31
    v_cvt_pk_bf16_f32 v196, v16, v17
    v_cvt_pk_bf16_f32 v197, v18, v19
    v_cvt_pk_bf16_f32 v198, v20, v21
    v_cvt_pk_bf16_f32 v199, v22, v23
    v_dot2_f32_bf16 v16, v200, s57, v31
    v_dot2_f32_bf16 v17, v200, s58, v31
    v_dot2_f32_bf16 v18, v201, s57, v31
    v_dot2_f32_bf16 v19, v201, s58, v31
    v_dot2_f32_bf16 v20, v202, s57, v31
    v_dot2_f32_bf16 v21, v202, s58, v31
    v_dot2_f32_bf16 v22, v203, s57, v31
    v_dot2_f32_bf16 v23, v203, s58, v31
    v_cvt_pk_bf16_f32 v200, v16, v17
    v_cvt_pk_bf16_f32 v201, v18, v19
    v_cvt_pk_bf16_f32 v202, v20, v21
    v_cvt_pk_bf16_f32 v203, v22, v23
    v_dot2_f32_bf16 v16, v204, s57, v31
    v_dot2_f32_bf16 v17, v204, s58, v31
    v_dot2_f32_bf16 v18, v205, s57, v31
    v_dot2_f32_bf16 v19, v205, s58, v31
    v_dot2_f32_bf16 v20, v206, s57, v31
    v_dot2_f32_bf16 v21, v206, s58, v31
    v_dot2_f32_bf16 v22, v207, s57, v31
    v_dot2_f32_bf16 v23, v207, s58, v31
    v_cvt_pk_bf16_f32 v204, v16, v17
    v_cvt_pk_bf16_f32 v205, v18, v19
    v_cvt_pk_bf16_f32 v206, v20, v21
    v_cvt_pk_bf16_f32 v207, v22, v23
    v_dot2_f32_bf16 v16, v208, s57, v31
    v_dot2_f32_bf16 v17, v208, s58, v31
    v_dot2_f32_bf16 v18, v209, s57, v31
    v_dot2_f32_bf16 v19, v209, s58, v31
    v_dot2_f32_bf16 v20, v210, s57, v31
    v_dot2_f32_bf16 v21, v210, s58, v31
    v_dot2_f32_bf16 v22, v211, s57, v31
    v_dot2_f32_bf16 v23, v211, s58, v31
    v_cvt_pk_bf16_f32 v208, v16, v17
    v_cvt_pk_bf16_f32 v209, v18, v19
    v_cvt_pk_bf16_f32 v210, v20, v21
    v_cvt_pk_bf16_f32 v211, v22, v23
    v_dot2_f32_bf16 v16, v212, s57, v31
    v_dot2_f32_bf16 v17, v212, s58, v31
    v_dot2_f32_bf16 v18, v213, s57, v31
    v_dot2_f32_bf16 v19, v213, s58, v31
    v_dot2_f32_bf16 v20, v214, s57, v31
    v_dot2_f32_bf16 v21, v214, s58, v31
    v_dot2_f32_bf16 v22, v215, s57, v31
    v_dot2_f32_bf16 v23, v215, s58, v31
    v_cvt_pk_bf16_f32 v212, v16, v17
    v_cvt_pk_bf16_f32 v213, v18, v19
    v_cvt_pk_bf16_f32 v214, v20, v21
    v_cvt_pk_bf16_f32 v215, v22, v23
    v_dot2_f32_bf16 v16, v216, s57, v31
    v_dot2_f32_bf16 v17, v216, s58, v31
    v_dot2_f32_bf16 v18, v217, s57, v31
    v_dot2_f32_bf16 v19, v217, s58, v31
    v_dot2_f32_bf16 v20, v218, s57, v31
    v_dot2_f32_bf16 v21, v218, s58, v31
    v_dot2_f32_bf16 v22, v219, s57, v31
    v_dot2_f32_bf16 v23, v219, s58, v31
    v_cvt_pk_bf16_f32 v216, v16, v17
    v_cvt_pk_bf16_f32 v217, v18, v19
    v_cvt_pk_bf16_f32 v218, v20, v21
    v_cvt_pk_bf16_f32 v219, v22, v23
    v_dot2_f32_bf16 v16, v220, s57, v31
    v_dot2_f32_bf16 v17, v220, s58, v31
    v_dot2_f32_bf16 v18, v221, s57, v31
    v_dot2_f32_bf16 v19, v221, s58, v31
    v_dot2_f32_bf16 v20, v222, s57, v31
    v_dot2_f32_bf16 v21, v222, s58, v31
    v_dot2_f32_bf16 v22, v223, s57, v31
    v_dot2_f32_bf16 v23, v223, s58, v31
    v_cvt_pk_bf16_f32 v220, v16, v17
    v_cvt_pk_bf16_f32 v221, v18, v19
    v_cvt_pk_bf16_f32 v222, v20, v21
    v_cvt_pk_bf16_f32 v223, v22, v23
    v_dot2_f32_bf16 v16, v224, s57, v31
    v_dot2_f32_bf16 v17, v224, s58, v31
    v_dot2_f32_bf16 v18, v225, s57, v31
    v_dot2_f32_bf16 v19, v225, s58, v31
    v_dot2_f32_bf16 v20, v226, s57, v31
    v_dot2_f32_bf16 v21, v226, s58, v31
    v_dot2_f32_bf16 v22, v227, s57, v31
    v_dot2_f32_bf16 v23, v227, s58, v31
    v_cvt_pk_bf16_f32 v224, v16, v17
    v_cvt_pk_bf16_f32 v225, v18, v19
    v_cvt_pk_bf16_f32 v226, v20, v21
    v_cvt_pk_bf16_f32 v227, v22, v23
    ds_read_b32 v2, v9 offset:0
    v_dot2_f32_bf16 v16, v228, s57, v31
    v_dot2_f32_bf16 v17, v228, s58, v31
    v_dot2_f32_bf16 v18, v229, s57, v31
    v_dot2_f32_bf16 v19, v229, s58, v31
    v_dot2_f32_bf16 v20, v230, s57, v31
    v_dot2_f32_bf16 v21, v230, s58, v31
    v_dot2_f32_bf16 v22, v231, s57, v31
    v_dot2_f32_bf16 v23, v231, s58, v31
    v_cvt_pk_bf16_f32 v228, v16, v17
    v_cvt_pk_bf16_f32 v229, v18, v19
    v_cvt_pk_bf16_f32 v230, v20, v21
    v_cvt_pk_bf16_f32 v231, v22, v23
    v_dot2_f32_bf16 v16, v232, s57, v31
    v_dot2_f32_bf16 v17, v232, s58, v31
    v_dot2_f32_bf16 v18, v233, s57, v31
    v_dot2_f32_bf16 v19, v233, s58, v31
    v_dot2_f32_bf16 v20, v234, s57, v31
    v_dot2_f32_bf16 v21, v234, s58, v31
    v_dot2_f32_bf16 v22, v235, s57, v31
    v_dot2_f32_bf16 v23, v235, s58, v31
    v_cvt_pk_bf16_f32 v232, v16, v17
    v_cvt_pk_bf16_f32 v233, v18, v19
    v_cvt_pk_bf16_f32 v234, v20, v21
    v_cvt_pk_bf16_f32 v235, v22, v23
    v_dot2_f32_bf16 v16, v236, s57, v31
    v_dot2_f32_bf16 v17, v236, s58, v31
    v_dot2_f32_bf16 v18, v237, s57, v31
    v_dot2_f32_bf16 v19, v237, s58, v31
    v_dot2_f32_bf16 v20, v238, s57, v31
    v_dot2_f32_bf16 v21, v238, s58, v31
    v_dot2_f32_bf16 v22, v239, s57, v31
    v_dot2_f32_bf16 v23, v239, s58, v31
    v_cvt_pk_bf16_f32 v236, v16, v17
    v_cvt_pk_bf16_f32 v237, v18, v19
    v_cvt_pk_bf16_f32 v238, v20, v21
    v_cvt_pk_bf16_f32 v239, v22, v23
    v_dot2_f32_bf16 v16, v240, s57, v31
    v_dot2_f32_bf16 v17, v240, s58, v31
    v_dot2_f32_bf16 v18, v241, s57, v31
    v_dot2_f32_bf16 v19, v241, s58, v31
    v_dot2_f32_bf16 v20, v242, s57, v31
    v_dot2_f32_bf16 v21, v242, s58, v31
    v_dot2_f32_bf16 v22, v243, s57, v31
    v_dot2_f32_bf16 v23, v243, s58, v31
    v_cvt_pk_bf16_f32 v240, v16, v17
    v_cvt_pk_bf16_f32 v241, v18, v19
    v_cvt_pk_bf16_f32 v242, v20, v21
    v_cvt_pk_bf16_f32 v243, v22, v23
    v_dot2_f32_bf16 v16, v244, s57, v31
    v_dot2_f32_bf16 v17, v244, s58, v31
    v_dot2_f32_bf16 v18, v245, s57, v31
    v_dot2_f32_bf16 v19, v245, s58, v31
    v_dot2_f32_bf16 v20, v246, s57, v31
    v_dot2_f32_bf16 v21, v246, s58, v31
    v_dot2_f32_bf16 v22, v247, s57, v31
    v_dot2_f32_bf16 v23, v247, s58, v31
    v_cvt_pk_bf16_f32 v244, v16, v17
    v_cvt_pk_bf16_f32 v245, v18, v19
    v_cvt_pk_bf16_f32 v246, v20, v21
    v_cvt_pk_bf16_f32 v247, v22, v23
    v_dot2_f32_bf16 v16, v248, s57, v31
    v_dot2_f32_bf16 v17, v248, s58, v31
    v_dot2_f32_bf16 v18, v249, s57, v31
    v_dot2_f32_bf16 v19, v249, s58, v31
    v_dot2_f32_bf16 v20, v250, s57, v31
    v_dot2_f32_bf16 v21, v250, s58, v31
    v_dot2_f32_bf16 v22, v251, s57, v31
    v_dot2_f32_bf16 v23, v251, s58, v31
    v_cvt_pk_bf16_f32 v248, v16, v17
    v_cvt_pk_bf16_f32 v249, v18, v19
    v_cvt_pk_bf16_f32 v250, v20, v21
    v_cvt_pk_bf16_f32 v251, v22, v23
    v_dot2_f32_bf16 v16, v252, s57, v31
    v_dot2_f32_bf16 v17, v252, s58, v31
    v_dot2_f32_bf16 v18, v253, s57, v31
    v_dot2_f32_bf16 v19, v253, s58, v31
    v_dot2_f32_bf16 v20, v254, s57, v31
    v_dot2_f32_bf16 v21, v254, s58, v31
    v_dot2_f32_bf16 v22, v255, s57, v31
    v_dot2_f32_bf16 v23, v255, s58, v31
    v_cvt_pk_bf16_f32 v252, v16, v17
    v_cvt_pk_bf16_f32 v253, v18, v19
    v_cvt_pk_bf16_f32 v254, v20, v21
    v_cvt_pk_bf16_f32 v255, v22, v23
    v_mul_i32_i24 v0, -98304, v8
    v_add_u32 v0, 131072, v0
    v_add_u32 v12, v0, v4
    v_add_u32 v13, v0, v5
    v_add_u32 v14, v0, v6
    v_add_u32 v15, v0, v7
    s_waitcnt lgkmcnt(0)
    v_readfirstlane_b32 s40, v2
    s_nop 0
    s_cmp_ge_u32 s40, 1
    s_cbranch_scc0 g1s_7
g1b_6:
    s_nop 0
    ds_read_b64_tr_b16 v[32:33], v12 offset:0
    ds_read_b64_tr_b16 v[34:35], v13 offset:0
    ds_read_b64_tr_b16 v[36:37], v14 offset:0
    ds_read_b64_tr_b16 v[38:39], v15 offset:0
    ds_read_b64_tr_b16 v[40:41], v12 offset:512
    ds_read_b64_tr_b16 v[42:43], v13 offset:512
    ds_read_b64_tr_b16 v[44:45], v14 offset:512
    ds_read_b64_tr_b16 v[46:47], v15 offset:512
    ds_read_b64_tr_b16 v[48:49], v12 offset:1024
    ds_read_b64_tr_b16 v[50:51], v13 offset:1024
    v_mul_i32_i24 v0, -57344, v8
    v_add_u32 v0, 65536, v0
    ds_read_b64_tr_b16 v[52:53], v14 offset:1024
    ds_read_b64_tr_b16 v[54:55], v15 offset:1024
    s_waitcnt lgkmcnt(8)
    s_nop 0
    v_mfma_f32_32x32x16_bf16 v[64:79], v[32:35], v[128:131], 0
    ds_read_b64_tr_b16 v[56:57], v12 offset:1536
    ds_read_b64_tr_b16 v[58:59], v13 offset:1536
    v_mfma_f32_32x32x16_bf16 v[80:95], v[36:39], v[128:131], 0
    ds_read_b64_tr_b16 v[60:61], v14 offset:1536
    ds_read_b64_tr_b16 v[62:63], v15 offset:1536
    s_waitcnt lgkmcnt(8)
    v_mfma_f32_32x32x16_bf16 v[64:79], v[40:43], v[132:135], v[64:79]
    ds_read_b64_tr_b16 v[32:33], v12 offset:2048
    ds_read_b64_tr_b16 v[34:35], v13 offset:2048
    v_add_u32 v16, v0, v4
    v_add_u32 v17, v0, v5
    s_lshl_b32 s42, s3, 11
    v_mfma_f32_32x32x16_bf16 v[80:95], v[44:47], v[132:135], v[80:95]
    ds_read_b64_tr_b16 v[36:37], v14 offset:2048
    ds_read_b64_tr_b16 v[38:39], v15 offset:2048
    v_add_u32 v18, v0, v6
    v_add_u32 v19, v0, v7
    s_waitcnt lgkmcnt(8)
    v_mfma_f32_32x32x16_bf16 v[64:79], v[48:51], v[136:139], v[64:79]
    ds_read_b64_tr_b16 v[40:41], v12 offset:2560
    ds_read_b64_tr_b16 v[42:43], v13 offset:2560
    ds_read_b32 v2, v9 offset:0
    s_add_u32 s42, s42, 147456
    v_add_u32 v22, s42, v3
    v_mfma_f32_32x32x16_bf16 v[80:95], v[52:55], v[136:139], v[80:95]
    ds_read_b64_tr_b16 v[44:45], v14 offset:2560
    ds_read_b64_tr_b16 v[46:47], v15 offset:2560
    s_movk_i32 s54, 128
    s_and_b32 s42, s3, 1
    s_waitcnt lgkmcnt(9)
    v_mfma_f32_32x32x16_bf16 v[64:79], v[56:59], v[140:143], v[64:79]
    ds_read_b64_tr_b16 v[48:49], v12 offset:3072
    ds_read_b64_tr_b16 v[50:51], v13 offset:3072
    s_lshl_b32 s42, s42, 5
    s_add_u32 s42, s42, s89
    s_mul_i32 s50, s42, 86
    v_mfma_f32_32x32x16_bf16 v[80:95], v[60:63], v[140:143], v[80:95]
    ds_read_b64_tr_b16 v[52:53], v14 offset:3072
    ds_read_b64_tr_b16 v[54:55], v15 offset:3072
    v_mov_b32 v0, 5
    s_lshr_b32 s51, s3, 1
    s_waitcnt lgkmcnt(9)
    v_mfma_f32_32x32x16_bf16 v[64:79], v[32:35], v[144:147], v[64:79]
    ds_read_b64_tr_b16 v[56:57], v12 offset:3584
    ds_read_b64_tr_b16 v[58:59], v13 offset:3584
    s_waitcnt lgkmcnt(8)
    v_readfirstlane_b32 s40, v2
    s_nop 0
    s_cmp_ge_u32 s40, 2
    s_cbranch_scc0 g1s_11
g1b_10:
    v_mfma_f32_32x32x16_bf16 v[80:95], v[36:39], v[144:147], v[80:95]
    ds_read_b64_tr_b16 v[60:61], v14 offset:3584
    ds_read_b64_tr_b16 v[62:63], v15 offset:3584
    ds_write_b32 v9, v0 offset:16
    s_add_u32 s50, s50, s51
    s_waitcnt lgkmcnt(8)
    v_mfma_f32_32x32x16_bf16 v[64:79], v[40:43], v[148:151], v[64:79]
    ds_read_b64_tr_b16 v[32:33], v16 offset:0
    ds_read_b64_tr_b16 v[34:35], v17 offset:0
    s_lshl_b32 s50, s50, 10
    s_add_u32 s50, s50, 6291456
    s_and_b32 s42, s89, 3
    v_mfma_f32_32x32x16_bf16 v[80:95], v[44:47], v[148:151], v[80:95]
    ds_read_b64_tr_b16 v[36:37], v18 offset:0
    ds_read_b64_tr_b16 v[38:39], v19 offset:0
    s_lshl1_add_u32 s42, s42, s90
    s_lshl_b32 s42, s42, 1
    s_waitcnt lgkmcnt(8)
    v_mfma_f32_32x32x16_bf16 v[64:79], v[48:51], v[152:155], v[64:79]
    ds_read_b64_tr_b16 v[40:41], v16 offset:512
    ds_read_b64_tr_b16 v[42:43], v17 offset:512
    s_and_b32 s42, s42, 15
    s_mul_i32 s43, s42, 11
    s_lshr_b32 s43, s43, 4
    v_mfma_f32_32x32x16_bf16 v[80:95], v[52:55], v[152:155], v[80:95]
    ds_read_b64_tr_b16 v[44:45], v18 offset:512
    ds_read_b64_tr_b16 v[46:47], v19 offset:512
    s_sub_u32 s43, s43, 32
    v_add_u32 v24, s43, v1
    s_waitcnt lgkmcnt(8)
    v_mfma_f32_32x32x16_bf16 v[64:79], v[56:59], v[156:159], v[64:79]
    ds_read_b64_tr_b16 v[48:49], v16 offset:1024
    ds_read_b64_tr_b16 v[50:51], v17 offset:1024
    v_mul_i32_i24 v0, 65536, v8
    v_add_u32 v0, 40960, v0
    v_subrev_u32_e64 v25, 11, v24
    v_mfma_f32_32x32x16_bf16 v[80:95], v[60:63], v[156:159], v[80:95]
    ds_read_b64_tr_b16 v[52:53], v18 offset:1024
    ds_read_b64_tr_b16 v[54:55], v19 offset:1024
    v_min_u32 v24, v24, v25
    v_lshrrev_b32 v25, 1, v24
    s_waitcnt lgkmcnt(8)
    v_mfma_f32_32x32x16_bf16 v[64:79], v[32:35], v[160:163], v[64:79]
    ds_read_b64_tr_b16 v[56:57], v16 offset:1536
    ds_read_b64_tr_b16 v[58:59], v17 offset:1536
    v_add3_u32 v24, v24, v25, 1
    v_min_u32 v24, 15, v24
    v_add_u32_e64 v25, s42, v1
    v_mfma_f32_32x32x16_bf16 v[80:95], v[36:39], v[160:163], v[80:95]
    ds_read_b64_tr_b16 v[60:61], v18 offset:1536
    ds_read_b64_tr_b16 v[62:63], v19 offset:1536
    v_and_b32 v25, 15, v25
    v_cmp_gt_u32 vcc, 32, v1
    s_waitcnt lgkmcnt(8)
    v_mfma_f32_32x32x16_bf16 v[64:79], v[40:43], v[164:167], v[64:79]
    ds_read_b64_tr_b16 v[32:33], v16 offset:2048
    ds_read_b64_tr_b16 v[34:35], v17 offset:2048
    v_add_u32 v12, v0, v4
    v_add_u32 v13, v0, v5
    v_cndmask_b32 v24, v24, v25, vcc
    v_mfma_f32_32x32x16_bf16 v[80:95], v[44:47], v[164:167], v[80:95]
    ds_read_b64_tr_b16 v[36:37], v18 offset:2048
    ds_read_b64_tr_b16 v[38:39], v19 offset:2048
    v_add_u32 v14, v0, v6
    v_add_u32 v15, v0, v7
    s_waitcnt lgkmcnt(8)
    v_mfma_f32_32x32x16_bf16 v[64:79], v[48:51], v[168:171], v[64:79]
    ds_read_b64_tr_b16 v[40:41], v16 offset:2560
    ds_read_b64_tr_b16 v[42:43], v17 offset:2560
    ds_read_b32 v2, v9 offset:0
    v_mul_u32_u24 v24, 43, v24
    v_cndmask_b32 v25, 16, 27, vcc
    v_mfma_f32_32x32x16_bf16 v[80:95], v[52:55], v[168:171], v[80:95]
    ds_read_b64_tr_b16 v[44:45], v18 offset:2560
    ds_read_b64_tr_b16 v[46:47], v19 offset:2560
    v_cmp_gt_u32 vcc, 16, v1
    s_nop 1
    v_cndmask_b32 v25, v25, 0, vcc
    s_waitcnt lgkmcnt(9)
    v_mfma_f32_32x32x16_bf16 v[64:79], v[56:59], v[172:175], v[64:79]
    ds_read_b64_tr_b16 v[48:49], v16 offset:3072
    ds_read_b64_tr_b16 v[50:51], v17 offset:3072
    v_add_u32 v24, v24, v25
    v_lshrrev_b32 v20, 4, v24
    v_lshlrev_b32 v20, 11, v20
    v_mfma_f32_32x32x16_bf16 v[80:95], v[60:63], v[172:175], v[80:95]
    ds_read_b64_tr_b16 v[52:53], v18 offset:3072
    ds_read_b64_tr_b16 v[54:55], v19 offset:3072
    v_mov_b32 v0, 6
    v_add_u32 v20, s50, v20
    s_waitcnt lgkmcnt(9)
    v_mfma_f32_32x32x16_bf16 v[64:79], v[32:35], v[176:179], v[64:79]
    ds_read_b64_tr_b16 v[56:57], v16 offset:3584
    ds_read_b64_tr_b16 v[58:59], v17 offset:3584
    s_waitcnt lgkmcnt(8)
    v_readfirstlane_b32 s40, v2
    s_nop 0
    s_cmp_ge_u32 s40, 3
    s_cbranch_scc0 g1s_13
g1b_12:
    v_mfma_f32_32x32x16_bf16 v[80:95], v[36:39], v[176:179], v[80:95]
    ds_read_b64_tr_b16 v[60:61], v18 offset:3584
    ds_read_b64_tr_b16 v[62:63], v19 offset:3584
    ds_write_b32 v9, v0 offset:16
    v_bfe_u32 v24, v1, 2, 2
    s_waitcnt lgkmcnt(8)
    v_mfma_f32_32x32x16_bf16 v[64:79], v[40:43], v[180:183], v[64:79]
    ds_read_b64_tr_b16 v[32:33], v12 offset:0
    ds_read_b64_tr_b16 v[34:35], v13 offset:0
    v_lshrrev_b32 v25, 5, v1
    v_lshl_add_u32 v25, v25, 3, v24
    s_lshl_b32 s42, s51, 4
    v_mfma_f32_32x32x16_bf16 v[80:95], v[44:47], v[180:183], v[80:95]
    ds_read_b64_tr_b16 v[36:37], v14 offset:0
    ds_read_b64_tr_b16 v[38:39], v15 offset:0
    v_add_u32 v25, s42, v25
    v_lshlrev_b32 v25, 7, v25
    s_waitcnt lgkmcnt(8)
    v_mfma_f32_32x32x16_bf16 v[64:79], v[48:51], v[184:187], v[64:79]
    ds_read_b64_tr_b16 v[40:41], v12 offset:512
    ds_read_b64_tr_b16 v[42:43], v13 offset:512
    v_lshrrev_b32_e64 v24, 1, v24
    v_lshl_add_u32 v25, v24, 6, v25
    v_bfe_u32 v24, v1, 4, 1
    v_mfma_f32_32x32x16_bf16 v[80:95], v[52:55], v[184:187], v[80:95]
    ds_read_b64_tr_b16 v[44:45], v14 offset:512
    ds_read_b64_tr_b16 v[46:47], v15 offset:512
    v_lshl_add_u32 v25, v24, 5, v25
    v_and_b32 v24, 3, v1
    s_waitcnt lgkmcnt(8)
    v_mfma_f32_32x32x16_bf16 v[64:79], v[56:59], v[188:191], v[64:79]
    ds_read_b64_tr_b16 v[48:49], v12 offset:1024
    ds_read_b64_tr_b16 v[50:51], v13 offset:1024
    v_mul_i32_i24 v0, 65536, v8
    v_add_u32 v0, 16384, v0
    v_lshl_add_u32 v21, v24, 3, v25
    v_mfma_f32_32x32x16_bf16 v[80:95], v[60:63], v[188:191], v[80:95]
    ds_read_b64_tr_b16 v[52:53], v14 offset:1024
    ds_read_b64_tr_b16 v[54:55], v15 offset:1024
    s_lshr_b32 s42, s3, 2
    s_lshl_b32 s42, s42, 20
    s_waitcnt lgkmcnt(8)
    v_mfma_f32_32x32x16_bf16 v[64:79], v[32:35], v[192:195], v[64:79]
    ds_read_b64_tr_b16 v[56:57], v12 offset:1536
    ds_read_b64_tr_b16 v[58:59], v13 offset:1536
    s_lshr_b32 s43, s89, 3
    s_lshl_b32 s43, s43, 18
    s_add_u32 s42, s42, s43
    v_mfma_f32_32x32x16_bf16 v[80:95], v[36:39], v[192:195], v[80:95]
    ds_read_b64_tr_b16 v[60:61], v14 offset:1536
    ds_read_b64_tr_b16 v[62:63], v15 offset:1536
    s_and_b32 s43, s89, 7
    s_lshl_b32 s43, s43, 12
    s_waitcnt lgkmcnt(8)
    v_mfma_f32_32x32x16_bf16 v[64:79], v[40:43], v[196:199], v[64:79]
    ds_read_b64_tr_b16 v[32:33], v12 offset:2048
    ds_read_b64_tr_b16 v[34:35], v13 offset:2048
    v_add_u32 v16, v0, v4
    v_add_u32 v17, v0, v5
    s_add_u32 s42, s42, s43
    v_mfma_f32_32x32x16_bf16 v[80:95], v[44:47], v[196:199], v[80:95]
    ds_read_b64_tr_b16 v[36:37], v14 offset:2048
    ds_read_b64_tr_b16 v[38:39], v15 offset:2048
    v_add_u32 v18, v0, v6
    v_add_u32 v19, v0, v7
    s_waitcnt lgkmcnt(8)
    v_mfma_f32_32x32x16_bf16 v[64:79], v[48:51], v[200:203], v[64:79]
    ds_read_b64_tr_b16 v[40:41], v12 offset:2560
    ds_read_b64_tr_b16 v[42:43], v13 offset:2560
    ds_read_b32 v2, v9 offset:0
    s_and_b32 s43, s3, 3
    s_lshl_b32 s43, s43, 16
    v_mfma_f32_32x32x16_bf16 v[80:95], v[52:55], v[200:203], v[80:95]
    ds_read_b64_tr_b16 v[44:45], v14 offset:2560
    ds_read_b64_tr_b16 v[46:47], v15 offset:2560
    s_add_u32 s42, s42, s43
    s_lshl_b32 s43, s90, 7
    s_waitcnt lgkmcnt(9)
    v_mfma_f32_32x32x16_bf16 v[64:79], v[56:59], v[204:207], v[64:79]
    ds_read_b64_tr_b16 v[48:49], v12 offset:3072
    ds_read_b64_tr_b16 v[50:51], v13 offset:3072
    s_add_u32 s91, s42, s43
    v_mfma_f32_32x32x16_bf16 v[80:95], v[60:63], v[204:207], v[80:95]
    ds_read_b64_tr_b16 v[52:53], v14 offset:3072
    ds_read_b64_tr_b16 v[54:55], v15 offset:3072
    v_mov_b32 v0, 7
    s_waitcnt lgkmcnt(9)
    v_mfma_f32_32x32x16_bf16 v[64:79], v[32:35], v[208:211], v[64:79]
    ds_read_b64_tr_b16 v[56:57], v12 offset:3584
    ds_read_b64_tr_b16 v[58:59], v13 offset:3584
    s_waitcnt lgkmcnt(8)
    v_readfirstlane_b32 s40, v2
    s_nop 0
    s_cmp_ge_u32 s40, 4
    s_cbranch_scc0 g1s_15
g1b_14:
    v_mfma_f32_32x32x16_bf16 v[80:95], v[36:39], v[208:211], v[80:95]
    ds_read_b64_tr_b16 v[60:61], v14 offset:3584
    ds_read_b64_tr_b16 v[62:63], v15 offset:3584
    ds_write_b32 v9, v0 offset:16
    s_waitcnt lgkmcnt(8)
    s_nop 0
    v_mfma_f32_32x32x16_bf16 v[64:79], v[40:43], v[212:215], v[64:79]
    ds_read_b64_tr_b16 v[32:33], v16 offset:0
    ds_read_b64_tr_b16 v[34:35], v17 offset:0
    v_mfma_f32_32x32x16_bf16 v[80:95], v[44:47], v[212:215], v[80:95]
    ds_read_b64_tr_b16 v[36:37], v18 offset:0
    ds_read_b64_tr_b16 v[38:39], v19 offset:0
    s_waitcnt lgkmcnt(8)
    s_nop 0
    v_mfma_f32_32x32x16_bf16 v[64:79], v[48:51], v[216:219], v[64:79]
    ds_read_b64_tr_b16 v[40:41], v16 offset:512
    ds_read_b64_tr_b16 v[42:43], v17 offset:512
    v_mfma_f32_32x32x16_bf16 v[80:95], v[52:55], v[216:219], v[80:95]
    ds_read_b64_tr_b16 v[44:45], v18 offset:512
    ds_read_b64_tr_b16 v[46:47], v19 offset:512
    s_waitcnt lgkmcnt(8)
    s_nop 0
    v_mfma_f32_32x32x16_bf16 v[64:79], v[56:59], v[220:223], v[64:79]
    ds_read_b64_tr_b16 v[48:49], v16 offset:1024
    ds_read_b64_tr_b16 v[50:51], v17 offset:1024
    v_mul_i32_i24 v0, 90112, v8
    v_add_u32 v0, 24576, v0
    v_mfma_f32_32x32x16_bf16 v[80:95], v[60:63], v[220:223], v[80:95]
    ds_read_b64_tr_b16 v[52:53], v18 offset:1024
    ds_read_b64_tr_b16 v[54:55], v19 offset:1024
    s_waitcnt lgkmcnt(8)
    s_nop 0
    v_mfma_f32_32x32x16_bf16 v[64:79], v[32:35], v[224:227], v[64:79]
    ds_read_b64_tr_b16 v[56:57], v16 offset:1536
    ds_read_b64_tr_b16 v[58:59], v17 offset:1536
    v_mfma_f32_32x32x16_bf16 v[80:95], v[36:39], v[224:227], v[80:95]
    ds_read_b64_tr_b16 v[60:61], v18 offset:1536
    ds_read_b64_tr_b16 v[62:63], v19 offset:1536
    s_waitcnt lgkmcnt(8)
    v_mfma_f32_32x32x16_bf16 v[64:79], v[40:43], v[228:231], v[64:79]
    ds_read_b64_tr_b16 v[32:33], v16 offset:2048
    ds_read_b64_tr_b16 v[34:35], v17 offset:2048
    v_add_u32 v12, v0, v4
    v_add_u32_e64 v13, v0, v5
    v_mfma_f32_32x32x16_bf16 v[80:95], v[44:47], v[228:231], v[80:95]
    ds_read_b64_tr_b16 v[36:37], v18 offset:2048
    ds_read_b64_tr_b16 v[38:39], v19 offset:2048
    v_add_u32 v14, v0, v6
    v_add_u32 v15, v0, v7
    s_waitcnt lgkmcnt(8)
    s_nop 0
    v_mfma_f32_32x32x16_bf16 v[64:79], v[48:51], v[232:235], v[64:79]
    ds_read_b64_tr_b16 v[40:41], v16 offset:2560
    ds_read_b64_tr_b16 v[42:43], v17 offset:2560
    ds_read_b32 v2, v9 offset:0
    v_mfma_f32_32x32x16_bf16 v[80:95], v[52:55], v[232:235], v[80:95]
    ds_read_b64_tr_b16 v[44:45], v18 offset:2560
    ds_read_b64_tr_b16 v[46:47], v19 offset:2560
    s_waitcnt lgkmcnt(9)
    s_nop 0
    v_mfma_f32_32x32x16_bf16 v[64:79], v[56:59], v[236:239], v[64:79]
    ds_read_b64_tr_b16 v[48:49], v16 offset:3072
    ds_read_b64_tr_b16 v[50:51], v17 offset:3072
    v_mfma_f32_32x32x16_bf16 v[80:95], v[60:63], v[236:239], v[80:95]
    ds_read_b64_tr_b16 v[52:53], v18 offset:3072
    ds_read_b64_tr_b16 v[54:55], v19 offset:3072
    v_mov_b32 v0, 8
    s_waitcnt lgkmcnt(9)
    v_mfma_f32_32x32x16_bf16 v[64:79], v[32:35], v[240:243], v[64:79]
    ds_read_b64_tr_b16 v[56:57], v16 offset:3584
    ds_read_b64_tr_b16 v[58:59], v17 offset:3584
    s_waitcnt lgkmcnt(8)
    v_readfirstlane_b32 s40, v2
    s_nop 0
    s_cmp_ge_u32 s40, 5
    s_cbranch_scc0 g1s_17
g1b_16:
    v_mfma_f32_32x32x16_bf16 v[80:95], v[36:39], v[240:243], v[80:95]
    ds_read_b64_tr_b16 v[60:61], v18 offset:3584
    ds_read_b64_tr_b16 v[62:63], v19 offset:3584
    ds_write_b32 v9, v0 offset:16
    s_waitcnt lgkmcnt(8)
    v_mfma_f32_32x32x16_bf16 v[64:79], v[40:43], v[244:247], v[64:79]
    ds_read_b64_tr_b16 v[32:33], v12 offset:0
    ds_read_b64_tr_b16 v[34:35], v13 offset:0
    v_mfma_f32_32x32x16_bf16 v[80:95], v[44:47], v[244:247], v[80:95]
    ds_read_b64_tr_b16 v[36:37], v14 offset:0
    ds_read_b64_tr_b16 v[38:39], v15 offset:0
    s_waitcnt lgkmcnt(8)
    s_nop 0
    v_mfma_f32_32x32x16_bf16 v[64:79], v[48:51], v[248:251], v[64:79]
    ds_read_b64_tr_b16 v[40:41], v12 offset:512
    ds_read_b64_tr_b16 v[42:43], v13 offset:512
    v_mfma_f32_32x32x16_bf16 v[80:95], v[52:55], v[248:251], v[80:95]
    ds_read_b64_tr_b16 v[44:45], v14 offset:512
    ds_read_b64_tr_b16 v[46:47], v15 offset:512
    s_waitcnt lgkmcnt(8)
    s_nop 0
    v_mfma_f32_32x32x16_bf16 v[64:79], v[56:59], v[252:255], v[64:79]
    ds_read_b64_tr_b16 v[48:49], v12 offset:1024
    ds_read_b64_tr_b16 v[50:51], v13 offset:1024
    v_mul_i32_i24 v0, -65536, v8
    v_add_u32 v0, 122880, v0
    v_mfma_f32_32x32x16_bf16 v[80:95], v[60:63], v[252:255], v[80:95]
    ds_read_b64_tr_b16 v[52:53], v14 offset:1024
    ds_read_b64_tr_b16 v[54:55], v15 offset:1024
    s_waitcnt vmcnt(0)
    s_waitcnt lgkmcnt(8)
    v_mfma_f32_32x32x16_bf16 v[96:111], v[32:35], v[128:131], 0
    ds_read_b64_tr_b16 v[56:57], v12 offset:1536
    ds_read_b64_tr_b16 v[58:59], v13 offset:1536
    v_mfma_f32_32x32x16_bf16 v[112:127], v[36:39], v[128:131], 0
    ds_read_b64_tr_b16 v[60:61], v14 offset:1536
    ds_read_b64_tr_b16 v[62:63], v15 offset:1536
    s_waitcnt lgkmcnt(8)
    v_mfma_f32_32x32x16_bf16 v[96:111], v[40:43], v[132:135], v[96:111]
    ds_read_b64_tr_b16 v[32:33], v12 offset:2048
    ds_read_b64_tr_b16 v[34:35], v13 offset:2048
    v_add_u32 v16, v0, v4
    v_add_u32 v17, v0, v5
    v_mul_f32 v72, v64, v72
    v_mul_f32 v64, v10, v64
    v_mul_f32 v73, v65, v73
    v_mul_f32 v65, v10, v65
    v_exp_f32 v64, v64
    v_mfma_f32_32x32x16_bf16 v[112:127], v[44:47], v[132:135], v[112:127]
    ds_read_b64_tr_b16 v[36:37], v14 offset:2048
    ds_read_b64_tr_b16 v[38:39], v15 offset:2048
    v_add_u32 v18, v0, v6
    v_add_u32 v19, v0, v7
    v_mul_f32 v74, v66, v74
    v_mul_f32 v66, v10, v66
    v_exp_f32 v65, v65
    v_fma_f32 v64, v64, v11, v11
    s_waitcnt lgkmcnt(8)
    v_mfma_f32_32x32x16_bf16 v[96:111], v[48:51], v[136:139], v[96:111]
    ds_read_b64_tr_b16 v[40:41], v12 offset:2560
    ds_read_b64_tr_b16 v[42:43], v13 offset:2560
    ds_read_b32 v2, v9 offset:0
    v_mul_f32 v75, v67, v75
    v_mul_f32 v67, v10, v67
    v_exp_f32 v66, v66
    v_fma_f32 v65, v65, v11, v11
    v_rcp_f32 v64, v64
    v_mfma_f32_32x32x16_bf16 v[112:127], v[52:55], v[136:139], v[112:127]
    ds_read_b64_tr_b16 v[44:45], v14 offset:2560
    ds_read_b64_tr_b16 v[46:47], v15 offset:2560
    v_mul_f32 v76, v68, v76
    v_mul_f32 v68, v10, v68
    v_exp_f32 v67, v67
    v_fma_f32 v66, v66, v11, v11
    v_mul_f32 v72, v72, v64
    s_waitcnt lgkmcnt(9)
    v_mfma_f32_32x32x16_bf16 v[96:111], v[56:59], v[140:143], v[96:111]
    ds_read_b64_tr_b16 v[48:49], v12 offset:3072
    ds_read_b64_tr_b16 v[50:51], v13 offset:3072
    v_rcp_f32 v65, v65
    v_mul_f32 v77, v69, v77
    v_mul_f32 v69, v10, v69
    v_exp_f32 v68, v68
    v_fma_f32 v67, v67, v11, v11
    v_mul_f32 v73, v73, v65
    v_mfma_f32_32x32x16_bf16 v[112:127], v[60:63], v[140:143], v[112:127]
    ds_read_b64_tr_b16 v[52:53], v14 offset:3072
    ds_read_b64_tr_b16 v[54:55], v15 offset:3072
    v_mov_b32 v0, 9
    v_rcp_f32 v66, v66
    v_mul_f32 v78, v70, v78
    v_mul_f32 v70, v10, v70
    v_exp_f32 v69, v69
    s_waitcnt lgkmcnt(9)
    v_mfma_f32_32x32x16_bf16 v[96:111], v[32:35], v[144:147], v[96:111]
    ds_read_b64_tr_b16 v[56:57], v12 offset:3584
    ds_read_b64_tr_b16 v[58:59], v13 offset:3584
    s_waitcnt lgkmcnt(8)
    v_readfirstlane_b32 s40, v2
    s_nop 0
    s_cmp_ge_u32 s40, 6
    s_cbranch_scc0 g1s_19
g1b_18:
    v_fma_f32 v68, v68, v11, v11
    v_mul_f32 v74, v74, v66
    v_rcp_f32_e64 v67, v67
    v_mfma_f32_32x32x16_bf16 v[112:127], v[36:39], v[144:147], v[112:127]
    ds_read_b64_tr_b16 v[60:61], v14 offset:3584
    ds_read_b64_tr_b16 v[62:63], v15 offset:3584
    ds_write_b32 v9, v0 offset:16
    v_cvt_pk_bf16_f32 v24, v72, v73
    v_mul_f32 v79, v71, v79
    v_mul_f32 v71, v10, v71
    v_exp_f32 v70, v70
    v_fma_f32 v69, v69, v11, v11
    s_waitcnt lgkmcnt(8)
    v_mfma_f32_32x32x16_bf16 v[96:111], v[40:43], v[148:151], v[96:111]
    ds_read_b64_tr_b16 v[32:33], v16 offset:0
    ds_read_b64_tr_b16 v[34:35], v17 offset:0
    v_mul_f32 v75, v75, v67
    v_rcp_f32 v68, v68
    v_mul_f32 v88, v80, v88
    v_mul_f32 v80, v10, v80
    v_exp_f32_e64 v71, v71
    v_fma_f32 v70, v70, v11, v11
    v_mfma_f32_32x32x16_bf16 v[112:127], v[44:47], v[148:151], v[112:127]
    ds_read_b64_tr_b16 v[36:37], v18 offset:0
    ds_read_b64_tr_b16 v[38:39], v19 offset:0
    v_mul_f32 v76, v76, v68
    v_rcp_f32 v69, v69
    v_cvt_pk_bf16_f32 v25, v74, v75
    v_mul_f32 v89, v81, v89
    v_mul_f32 v81, v10, v81
    s_waitcnt lgkmcnt(8)
    v_mfma_f32_32x32x16_bf16 v[96:111], v[48:51], v[152:155], v[96:111]
    ds_read_b64_tr_b16 v[40:41], v16 offset:512
    ds_read_b64_tr_b16 v[42:43], v17 offset:512
    v_exp_f32 v80, v80
    v_fma_f32 v71, v71, v11, v11
    v_mul_f32 v77, v77, v69
    v_rcp_f32 v70, v70
    v_mul_f32 v90, v82, v90
    v_mul_f32 v82, v10, v82
    v_mfma_f32_32x32x16_bf16 v[112:127], v[52:55], v[152:155], v[112:127]
    ds_read_b64_tr_b16 v[44:45], v18 offset:512
    ds_read_b64_tr_b16 v[46:47], v19 offset:512
    v_exp_f32 v81, v81
    v_fma_f32 v80, v80, v11, v11
    v_mul_f32 v78, v78, v70
    v_rcp_f32 v71, v71
    v_cvt_pk_bf16_f32 v26, v76, v77
    s_waitcnt lgkmcnt(8)
    v_mfma_f32_32x32x16_bf16 v[96:111], v[56:59], v[156:159], v[96:111]
    ds_read_b64_tr_b16 v[48:49], v16 offset:1024
    ds_read_b64_tr_b16 v[50:51], v17 offset:1024
    v_mul_i32_i24 v0, 65536, v8
    v_add_u32 v0, 65536, v0
    v_mul_f32 v91, v83, v91
    v_mul_f32 v83, v10, v83
    v_exp_f32 v82, v82
    v_fma_f32 v81, v81, v11, v11
    v_mul_f32 v79, v79, v71
    v_mfma_f32_32x32x16_bf16 v[112:127], v[60:63], v[156:159], v[112:127]
    ds_read_b64_tr_b16 v[52:53], v18 offset:1024
    ds_read_b64_tr_b16 v[54:55], v19 offset:1024
    v_rcp_f32 v80, v80
    v_mul_f32 v92, v84, v92
    v_mul_f32 v84, v10, v84
    v_exp_f32 v83, v83
    v_fma_f32 v82, v82, v11, v11
    s_waitcnt lgkmcnt(8)
    v_mfma_f32_32x32x16_bf16 v[96:111], v[32:35], v[160:163], v[96:111]
    ds_read_b64_tr_b16 v[56:57], v16 offset:1536
    ds_read_b64_tr_b16 v[58:59], v17 offset:1536
    v_mul_f32 v88, v88, v80
    v_rcp_f32 v81, v81
    v_cvt_pk_bf16_f32 v27, v78, v79
    v_mul_f32 v93, v85, v93
    v_mul_f32 v85, v10, v85
    v_exp_f32 v84, v84
    v_mfma_f32_32x32x16_bf16 v[112:127], v[36:39], v[160:163], v[112:127]
    ds_read_b64_tr_b16 v[60:61], v18 offset:1536
    ds_read_b64_tr_b16 v[62:63], v19 offset:1536
    v_fma_f32 v83, v83, v11, v11
    v_mul_f32 v89, v89, v81
    v_rcp_f32 v82, v82
    v_mul_f32 v94, v86, v94
    v_mul_f32 v86, v10, v86
    s_waitcnt lgkmcnt(8)
    v_mfma_f32_32x32x16_bf16 v[96:111], v[40:43], v[164:167], v[96:111]
    ds_read_b64_tr_b16 v[32:33], v16 offset:2048
    ds_read_b64_tr_b16 v[34:35], v17 offset:2048
    v_add_u32 v12, v0, v4
    v_add_u32 v13, v0, v5
    v_exp_f32 v85, v85
    v_fma_f32 v84, v84, v11, v11
    v_mul_f32 v90, v90, v82
    v_rcp_f32 v83, v83
    v_mfma_f32_32x32x16_bf16 v[112:127], v[44:47], v[164:167], v[112:127]
    ds_read_b64_tr_b16 v[36:37], v18 offset:2048
    ds_read_b64_tr_b16 v[38:39], v19 offset:2048
    v_add_u32 v14, v0, v6
    v_add_u32 v15, v0, v7
    v_cvt_pk_bf16_f32 v28, v88, v89
    v_mul_f32 v95, v87, v95
    v_mul_f32 v87, v10, v87
    v_exp_f32 v86, v86
    s_waitcnt lgkmcnt(8)
    v_mfma_f32_32x32x16_bf16 v[96:111], v[48:51], v[168:171], v[96:111]
    ds_read_b64_tr_b16 v[40:41], v16 offset:2560
    ds_read_b64_tr_b16 v[42:43], v17 offset:2560
    ds_read_b32 v2, v9 offset:0
    v_fma_f32 v85, v85, v11, v11
    v_mul_f32 v91, v91, v83
    v_rcp_f32 v84, v84
    v_exp_f32_e64 v87, v87
    v_fma_f32 v86, v86, v11, v11
    v_mfma_f32_32x32x16_bf16 v[112:127], v[52:55], v[168:171], v[112:127]
    ds_read_b64_tr_b16 v[44:45], v18 offset:2560
    ds_read_b64_tr_b16 v[46:47], v19 offset:2560
    v_mul_f32 v92, v92, v84
    v_rcp_f32 v85, v85
    v_cvt_pk_bf16_f32 v29, v90, v91
    v_fma_f32 v87, v87, v11, v11
    v_mul_f32 v93, v93, v85
    s_waitcnt lgkmcnt(9)
    v_mfma_f32_32x32x16_bf16 v[96:111], v[56:59], v[172:175], v[96:111]
    ds_read_b64_tr_b16 v[48:49], v16 offset:3072
    ds_read_b64_tr_b16 v[50:51], v17 offset:3072
    ds_write_b128 v22, v[24:27]
    v_rcp_f32 v86, v86
    s_nop 0
    v_mul_f32 v94, v94, v86
    v_rcp_f32 v87, v87
    v_cvt_pk_bf16_f32 v30, v92, v93
    v_mfma_f32_32x32x16_bf16 v[112:127], v[60:63], v[172:175], v[112:127]
    ds_read_b64_tr_b16 v[52:53], v18 offset:3072
    ds_read_b64_tr_b16 v[54:55], v19 offset:3072
    v_mov_b32 v0, 10
    v_mov_b32 v23, 1
    v_mul_f32_e64 v95, v95, v87
    v_cvt_pk_bf16_f32 v31, v94, v95
    ds_write_b128 v22, v[28:31] offset:1024
    s_waitcnt lgkmcnt(9)
    v_mfma_f32_32x32x16_bf16 v[96:111], v[32:35], v[176:179], v[96:111]
    ds_read_b64_tr_b16 v[56:57], v16 offset:3584
    ds_read_b64_tr_b16 v[58:59], v17 offset:3584
    s_waitcnt lgkmcnt(8)
    v_readfirstlane_b32 s40, v2
    s_nop 0
    s_cmp_ge_u32 s40, 7
    s_cbranch_scc0 g1s_21
g1b_20:
    ds_write_b32 v9, v23 offset:112
    v_mfma_f32_32x32x16_bf16 v[112:127], v[36:39], v[176:179], v[112:127]
    ds_read_b64_tr_b16 v[60:61], v18 offset:3584
    ds_read_b64_tr_b16 v[62:63], v19 offset:3584
    ds_write_b32 v9, v0 offset:16
    s_waitcnt lgkmcnt(8)
    s_nop 0
    v_mfma_f32_32x32x16_bf16 v[96:111], v[40:43], v[180:183], v[96:111]
    ds_read_b64_tr_b16 v[32:33], v12 offset:0
    ds_read_b64_tr_b16 v[34:35], v13 offset:0
    v_mfma_f32_32x32x16_bf16 v[112:127], v[44:47], v[180:183], v[112:127]
    ds_read_b64_tr_b16 v[36:37], v14 offset:0
    ds_read_b64_tr_b16 v[38:39], v15 offset:0
    s_waitcnt lgkmcnt(8)
    s_nop 0
    v_mfma_f32_32x32x16_bf16 v[96:111], v[48:51], v[184:187], v[96:111]
    ds_read_b64_tr_b16 v[40:41], v12 offset:512
    ds_read_b64_tr_b16 v[42:43], v13 offset:512
    v_mfma_f32_32x32x16_bf16 v[112:127], v[52:55], v[184:187], v[112:127]
    ds_read_b64_tr_b16 v[44:45], v14 offset:512
    ds_read_b64_tr_b16 v[46:47], v15 offset:512
    s_waitcnt lgkmcnt(8)
    s_nop 0
    v_mfma_f32_32x32x16_bf16 v[96:111], v[56:59], v[188:191], v[96:111]
    ds_read_b64_tr_b16 v[48:49], v12 offset:1024
    ds_read_b64_tr_b16 v[50:51], v13 offset:1024
    v_mul_i32_i24 v0, -98304, v8
    v_add_u32 v0, 106496, v0
    v_mfma_f32_32x32x16_bf16 v[112:127], v[60:63], v[188:191], v[112:127]
    ds_read_b64_tr_b16 v[52:53], v14 offset:1024
    ds_read_b64_tr_b16 v[54:55], v15 offset:1024
    s_waitcnt lgkmcnt(8)
    s_nop 0
    v_mfma_f32_32x32x16_bf16 v[96:111], v[32:35], v[192:195], v[96:111]
    ds_read_b64_tr_b16 v[56:57], v12 offset:1536
    ds_read_b64_tr_b16 v[58:59], v13 offset:1536
    v_mfma_f32_32x32x16_bf16 v[112:127], v[36:39], v[192:195], v[112:127]
    ds_read_b64_tr_b16 v[60:61], v14 offset:1536
    ds_read_b64_tr_b16 v[62:63], v15 offset:1536
    s_waitcnt lgkmcnt(8)
    v_mfma_f32_32x32x16_bf16 v[96:111], v[40:43], v[196:199], v[96:111]
    ds_read_b64_tr_b16 v[32:33], v12 offset:2048
    ds_read_b64_tr_b16 v[34:35], v13 offset:2048
    v_add_u32 v16, v0, v4
    v_add_u32_e64 v17, v0, v5
    v_mfma_f32_32x32x16_bf16 v[112:127], v[44:47], v[196:199], v[112:127]
    ds_read_b64_tr_b16 v[36:37], v14 offset:2048
    ds_read_b64_tr_b16 v[38:39], v15 offset:2048
    v_add_u32 v18, v0, v6
    v_add_u32 v19, v0, v7
    s_waitcnt lgkmcnt(8)
    s_nop 0
    v_mfma_f32_32x32x16_bf16 v[96:111], v[48:51], v[200:203], v[96:111]
    ds_read_b64_tr_b16 v[40:41], v12 offset:2560
    ds_read_b64_tr_b16 v[42:43], v13 offset:2560
    ds_read_b32 v2, v9 offset:0
    v_mfma_f32_32x32x16_bf16 v[112:127], v[52:55], v[200:203], v[112:127]
    ds_read_b64_tr_b16 v[44:45], v14 offset:2560
    ds_read_b64_tr_b16 v[46:47], v15 offset:2560
    s_waitcnt lgkmcnt(9)
    s_nop 0
    v_mfma_f32_32x32x16_bf16 v[96:111], v[56:59], v[204:207], v[96:111]
    ds_read_b64_tr_b16 v[48:49], v12 offset:3072
    ds_read_b64_tr_b16 v[50:51], v13 offset:3072
    v_mfma_f32_32x32x16_bf16 v[112:127], v[60:63], v[204:207], v[112:127]
    ds_read_b64_tr_b16 v[52:53], v14 offset:3072
    ds_read_b64_tr_b16 v[54:55], v15 offset:3072
    v_mov_b32 v0, 11
    s_waitcnt lgkmcnt(9)
    v_mfma_f32_32x32x16_bf16 v[96:111], v[32:35], v[208:211], v[96:111]
    ds_read_b64_tr_b16 v[56:57], v12 offset:3584
    ds_read_b64_tr_b16 v[58:59], v13 offset:3584
    s_waitcnt lgkmcnt(8)
    v_readfirstlane_b32 s40, v2
    s_nop 0
    s_cmp_ge_u32 s40, 8
    s_cbranch_scc0 g1s_23
g1b_22:
    v_mfma_f32_32x32x16_bf16 v[112:127], v[36:39], v[208:211], v[112:127]
    ds_read_b64_tr_b16 v[60:61], v14 offset:3584
    ds_read_b64_tr_b16 v[62:63], v15 offset:3584
    ds_write_b32 v9, v0 offset:16
    s_waitcnt lgkmcnt(8)
    v_mfma_f32_32x32x16_bf16 v[96:111], v[40:43], v[212:215], v[96:111]
    ds_read_b64_tr_b16 v[32:33], v16 offset:0
    ds_read_b64_tr_b16 v[34:35], v17 offset:0
    v_mfma_f32_32x32x16_bf16 v[112:127], v[44:47], v[212:215], v[112:127]
    ds_read_b64_tr_b16 v[36:37], v18 offset:0
    ds_read_b64_tr_b16 v[38:39], v19 offset:0
    s_waitcnt lgkmcnt(8)
    s_nop 0
    v_mfma_f32_32x32x16_bf16 v[96:111], v[48:51], v[216:219], v[96:111]
    ds_read_b64_tr_b16 v[40:41], v16 offset:512
    ds_read_b64_tr_b16 v[42:43], v17 offset:512
    v_mfma_f32_32x32x16_bf16 v[112:127], v[52:55], v[216:219], v[112:127]
    ds_read_b64_tr_b16 v[44:45], v18 offset:512
    ds_read_b64_tr_b16 v[46:47], v19 offset:512
    s_waitcnt lgkmcnt(8)
    v_mfma_f32_32x32x16_bf16 v[96:111], v[56:59], v[220:223], v[96:111]
    ds_read_b64_tr_b16 v[48:49], v16 offset:1024
    ds_read_b64_tr_b16 v[50:51], v17 offset:1024
    v_mul_i32_i24 v0, 139264, v8
    v_add_u32 v0, 0, v0
    v_mfma_f32_32x32x16_bf16 v[112:127], v[60:63], v[220:223], v[112:127]
    ds_read_b64_tr_b16 v[52:53], v18 offset:1024
    ds_read_b64_tr_b16 v[54:55], v19 offset:1024
    s_waitcnt lgkmcnt(8)
    s_nop 0
    v_mfma_f32_32x32x16_bf16 v[96:111], v[32:35], v[224:227], v[96:111]
    ds_read_b64_tr_b16 v[56:57], v16 offset:1536
    ds_read_b64_tr_b16 v[58:59], v17 offset:1536
    v_mfma_f32_32x32x16_bf16 v[112:127], v[36:39], v[224:227], v[112:127]
    ds_read_b64_tr_b16 v[60:61], v18 offset:1536
    ds_read_b64_tr_b16 v[62:63], v19 offset:1536
    s_waitcnt lgkmcnt(8)
    v_mfma_f32_32x32x16_bf16 v[96:111], v[40:43], v[228:231], v[96:111]
    ds_read_b64_tr_b16 v[32:33], v16 offset:2048
    ds_read_b64_tr_b16 v[34:35], v17 offset:2048
    v_add_u32 v12, v0, v4
    v_add_u32_e64 v13, v0, v5
    v_mfma_f32_32x32x16_bf16 v[112:127], v[44:47], v[228:231], v[112:127]
    ds_read_b64_tr_b16 v[36:37], v18 offset:2048
    ds_read_b64_tr_b16 v[38:39], v19 offset:2048
    v_add_u32 v14, v0, v6
    v_add_u32 v15, v0, v7
    s_waitcnt lgkmcnt(8)
    s_nop 0
    v_mfma_f32_32x32x16_bf16 v[96:111], v[48:51], v[232:235], v[96:111]
    ds_read_b64_tr_b16 v[40:41], v16 offset:2560
    ds_read_b64_tr_b16 v[42:43], v17 offset:2560
    v_mfma_f32_32x32x16_bf16 v[112:127], v[52:55], v[232:235], v[112:127]
    ds_read_b64_tr_b16 v[44:45], v18 offset:2560
    ds_read_b64_tr_b16 v[46:47], v19 offset:2560
    s_waitcnt lgkmcnt(8)
    s_nop 0
    v_mfma_f32_32x32x16_bf16 v[96:111], v[56:59], v[236:239], v[96:111]
    ds_read_b64_tr_b16 v[48:49], v16 offset:3072
    ds_read_b64_tr_b16 v[50:51], v17 offset:3072
    v_mfma_f32_32x32x16_bf16 v[112:127], v[60:63], v[236:239], v[112:127]
    ds_read_b64_tr_b16 v[52:53], v18 offset:3072
    ds_read_b64_tr_b16 v[54:55], v19 offset:3072
    v_mov_b32 v0, 12
    s_waitcnt lgkmcnt(8)
    v_mfma_f32_32x32x16_bf16 v[96:111], v[32:35], v[240:243], v[96:111]
    ds_read_b64_tr_b16 v[56:57], v16 offset:3584
    ds_read_b64_tr_b16 v[58:59], v17 offset:3584
    v_mfma_f32_32x32x16_bf16 v[112:127], v[36:39], v[240:243], v[112:127]
    ds_read_b64_tr_b16 v[60:61], v18 offset:3584
    ds_read_b64_tr_b16 v[62:63], v19 offset:3584
    ds_write_b32 v9, v0 offset:16
    s_waitcnt lgkmcnt(8)
    s_nop 0
    v_mfma_f32_32x32x16_bf16 v[96:111], v[40:43], v[244:247], v[96:111]
    ds_read_b64_tr_b16 v[32:33], v12 offset:0
    ds_read_b64_tr_b16 v[34:35], v13 offset:0
    v_mfma_f32_32x32x16_bf16 v[112:127], v[44:47], v[244:247], v[112:127]
    ds_read_b64_tr_b16 v[36:37], v14 offset:0
    ds_read_b64_tr_b16 v[38:39], v15 offset:0
    s_waitcnt lgkmcnt(8)
    s_nop 0
    v_mfma_f32_32x32x16_bf16 v[96:111], v[48:51], v[248:251], v[96:111]
    ds_read_b64_tr_b16 v[40:41], v12 offset:512
    ds_read_b64_tr_b16 v[42:43], v13 offset:512
    v_mfma_f32_32x32x16_bf16 v[112:127], v[52:55], v[248:251], v[112:127]
    ds_read_b64_tr_b16 v[44:45], v14 offset:512
    ds_read_b64_tr_b16 v[46:47], v15 offset:512
    s_waitcnt lgkmcnt(8)
    s_nop 0
    v_mfma_f32_32x32x16_bf16 v[96:111], v[56:59], v[252:255], v[96:111]
    ds_read_b64_tr_b16 v[48:49], v12 offset:1024
    ds_read_b64_tr_b16 v[50:51], v13 offset:1024
    v_mul_i32_i24 v0, -8192, v8
    v_add_u32 v0, 98304, v0
    v_mfma_f32_32x32x16_bf16 v[112:127], v[60:63], v[252:255], v[112:127]
    ds_read_b64_tr_b16 v[52:53], v14 offset:1024
    ds_read_b64_tr_b16 v[54:55], v15 offset:1024
    s_cmp_eq_u32 s87, 2
    s_cbranch_scc1 g1fin2_8
    s_waitcnt lgkmcnt(8)
    s_nop 0
    v_mfma_f32_32x32x16_bf16 v[64:79], v[32:35], v[128:131], 0
    ds_read_b64_tr_b16 v[56:57], v12 offset:1536
    ds_read_b64_tr_b16 v[58:59], v13 offset:1536
    v_mfma_f32_32x32x16_bf16 v[80:95], v[36:39], v[128:131], 0
    ds_read_b64_tr_b16 v[60:61], v14 offset:1536
    ds_read_b64_tr_b16 v[62:63], v15 offset:1536
    s_waitcnt lgkmcnt(8)
    v_mfma_f32_32x32x16_bf16 v[64:79], v[40:43], v[132:135], v[64:79]
    ds_read_b64_tr_b16 v[32:33], v12 offset:2048
    ds_read_b64_tr_b16 v[34:35], v13 offset:2048
    v_add_u32 v16, v0, v4
    v_add_u32 v17, v0, v5
    v_mul_f32 v104, v96, v104
    v_mul_f32 v96, v10, v96
    v_mul_f32 v105, v97, v105
    v_mul_f32 v97, v10, v97
    v_exp_f32 v96, v96
    v_mfma_f32_32x32x16_bf16 v[80:95], v[44:47], v[132:135], v[80:95]
    ds_read_b64_tr_b16 v[36:37], v14 offset:2048
    ds_read_b64_tr_b16 v[38:39], v15 offset:2048
    v_add_u32 v18, v0, v6
    v_add_u32 v19, v0, v7
    v_mul_f32 v106, v98, v106
    v_mul_f32 v98, v10, v98
    v_exp_f32 v97, v97
    v_fma_f32 v96, v96, v11, v11
    s_waitcnt lgkmcnt(8)
    v_mfma_f32_32x32x16_bf16 v[64:79], v[48:51], v[136:139], v[64:79]
    ds_read_b64_tr_b16 v[40:41], v12 offset:2560
    ds_read_b64_tr_b16 v[42:43], v13 offset:2560
    v_mul_f32 v107, v99, v107
    v_mul_f32 v99, v10, v99
    v_exp_f32 v98, v98
    v_fma_f32 v97, v97, v11, v11
    v_rcp_f32 v96, v96
    v_mul_f32_e64 v108, v100, v108
    v_mfma_f32_32x32x16_bf16 v[80:95], v[52:55], v[136:139], v[80:95]
    ds_read_b64_tr_b16 v[44:45], v14 offset:2560
    ds_read_b64_tr_b16 v[46:47], v15 offset:2560
    v_mul_f32 v100, v10, v100
    v_exp_f32 v99, v99
    v_fma_f32 v98, v98, v11, v11
    v_mul_f32 v104, v104, v96
    v_rcp_f32 v97, v97
    s_waitcnt lgkmcnt(8)
    v_mfma_f32_32x32x16_bf16 v[64:79], v[56:59], v[140:143], v[64:79]
    ds_read_b64_tr_b16 v[48:49], v12 offset:3072
    ds_read_b64_tr_b16 v[50:51], v13 offset:3072
    v_mul_f32 v109, v101, v109
    v_mul_f32 v101, v10, v101
    v_exp_f32 v100, v100
    v_fma_f32 v99, v99, v11, v11
    v_mul_f32 v105, v105, v97
    v_rcp_f32 v98, v98
    v_mfma_f32_32x32x16_bf16 v[80:95], v[60:63], v[140:143], v[80:95]
    ds_read_b64_tr_b16 v[52:53], v14 offset:3072
    ds_read_b64_tr_b16 v[54:55], v15 offset:3072
    v_mov_b32 v0, 13
    v_mul_f32 v110, v102, v110
    v_mul_f32 v102, v10, v102
    v_exp_f32 v101, v101
    v_fma_f32 v100, v100, v11, v11
    v_mul_f32 v106, v106, v98
    s_waitcnt lgkmcnt(8)
    v_mfma_f32_32x32x16_bf16 v[64:79], v[32:35], v[144:147], v[64:79]
    ds_read_b64_tr_b16 v[56:57], v12 offset:3584
    ds_read_b64_tr_b16 v[58:59], v13 offset:3584
    v_rcp_f32 v99, v99
    v_cvt_pk_bf16_f32 v24, v104, v105
    v_mul_f32 v111, v103, v111
    v_mul_f32 v103, v10, v103
    v_exp_f32 v102, v102
    v_fma_f32 v101, v101, v11, v11
    v_mfma_f32_32x32x16_bf16 v[80:95], v[36:39], v[144:147], v[80:95]
    ds_read_b64_tr_b16 v[60:61], v14 offset:3584
    ds_read_b64_tr_b16 v[62:63], v15 offset:3584
    ds_write_b32 v9, v0 offset:16
    v_mul_f32 v107, v107, v99
    v_rcp_f32 v100, v100
    v_mul_f32 v120, v112, v120
    v_mul_f32 v112, v10, v112
    s_waitcnt lgkmcnt(8)
    v_mfma_f32_32x32x16_bf16 v[64:79], v[40:43], v[148:151], v[64:79]
    ds_read_b64_tr_b16 v[32:33], v16 offset:0
    ds_read_b64_tr_b16 v[34:35], v17 offset:0
    v_exp_f32 v103, v103
    v_fma_f32 v102, v102, v11, v11
    v_mul_f32 v108, v108, v100
    v_rcp_f32 v101, v101
    v_cvt_pk_bf16_f32 v25, v106, v107
    v_mul_f32_e64 v121, v113, v121
    v_mfma_f32_32x32x16_bf16 v[80:95], v[44:47], v[148:151], v[80:95]
    ds_read_b64_tr_b16 v[36:37], v18 offset:0
    ds_read_b64_tr_b16 v[38:39], v19 offset:0
    v_mul_f32 v113, v10, v113
    v_exp_f32 v112, v112
    v_fma_f32 v103, v103, v11, v11
    v_mul_f32 v109, v109, v101
    v_rcp_f32 v102, v102
    s_waitcnt lgkmcnt(8)
    v_mfma_f32_32x32x16_bf16 v[64:79], v[48:51], v[152:155], v[64:79]
    ds_read_b64_tr_b16 v[40:41], v16 offset:512
    ds_read_b64_tr_b16 v[42:43], v17 offset:512
    v_mul_f32 v122, v114, v122
    v_mul_f32 v114, v10, v114
    v_exp_f32 v113, v113
    v_fma_f32 v112, v112, v11, v11
    v_mul_f32 v110, v110, v102
    v_rcp_f32 v103, v103
    v_mfma_f32_32x32x16_bf16 v[80:95], v[52:55], v[152:155], v[80:95]
    ds_read_b64_tr_b16 v[44:45], v18 offset:512
    ds_read_b64_tr_b16 v[46:47], v19 offset:512
    v_cvt_pk_bf16_f32 v26, v108, v109
    v_mul_f32 v123, v115, v123
    v_mul_f32 v115, v10, v115
    v_exp_f32 v114, v114
    v_fma_f32 v113, v113, v11, v11
    v_mul_f32 v111, v111, v103
    s_waitcnt lgkmcnt(8)
    v_mfma_f32_32x32x16_bf16 v[64:79], v[56:59], v[156:159], v[64:79]
    ds_read_b64_tr_b16 v[48:49], v16 offset:1024
    ds_read_b64_tr_b16 v[50:51], v17 offset:1024
    v_mul_i32_i24 v0, -40960, v8
    v_add_u32 v0, 73728, v0
    v_rcp_f32 v112, v112
    v_mul_f32 v124, v116, v124
    v_mul_f32 v116, v10, v116
    v_exp_f32_e64 v115, v115
    v_mfma_f32_32x32x16_bf16 v[80:95], v[60:63], v[156:159], v[80:95]
    ds_read_b64_tr_b16 v[52:53], v18 offset:1024
    ds_read_b64_tr_b16 v[54:55], v19 offset:1024
    ds_read_b32 v2, v9 offset:128
    v_fma_f32 v114, v114, v11, v11
    v_mul_f32 v120, v120, v112
    v_rcp_f32 v113, v113
    v_cvt_pk_bf16_f32 v27, v110, v111
    v_mul_f32 v125, v117, v125
    s_waitcnt lgkmcnt(9)
    v_mfma_f32_32x32x16_bf16 v[64:79], v[32:35], v[160:163], v[64:79]
    ds_read_b64_tr_b16 v[56:57], v16 offset:1536
    ds_read_b64_tr_b16 v[58:59], v17 offset:1536
    v_mul_f32 v117, v10, v117
    v_exp_f32 v116, v116
    v_fma_f32 v115, v115, v11, v11
    v_mul_f32 v121, v121, v113
    v_rcp_f32 v114, v114
    v_mul_f32_e64 v126, v118, v126
    v_mfma_f32_32x32x16_bf16 v[80:95], v[36:39], v[160:163], v[80:95]
    ds_read_b64_tr_b16 v[60:61], v18 offset:1536
    ds_read_b64_tr_b16 v[62:63], v19 offset:1536
    v_mul_f32 v118, v10, v118
    v_exp_f32 v117, v117
    v_fma_f32 v116, v116, v11, v11
    v_mul_f32 v122, v122, v114
    v_rcp_f32 v115, v115
    s_waitcnt lgkmcnt(9)
    v_mfma_f32_32x32x16_bf16 v[64:79], v[40:43], v[164:167], v[64:79]
    ds_read_b64_tr_b16 v[32:33], v16 offset:2048
    ds_read_b64_tr_b16 v[34:35], v17 offset:2048
    v_add_u32 v12, v0, v4
    v_add_u32 v13, v0, v5
    v_cvt_pk_bf16_f32 v28, v120, v121
    v_mul_f32 v127, v119, v127
    v_mul_f32 v119, v10, v119
    v_exp_f32 v118, v118
    v_fma_f32 v117, v117, v11, v11
    v_mfma_f32_32x32x16_bf16 v[80:95], v[44:47], v[164:167], v[80:95]
    ds_read_b64_tr_b16 v[36:37], v18 offset:2048
    ds_read_b64_tr_b16 v[38:39], v19 offset:2048
    v_add_u32 v14, v0, v6
    v_add_u32 v15, v0, v7
    v_mul_f32 v123, v123, v115
    v_rcp_f32 v116, v116
    v_exp_f32 v119, v119
    s_waitcnt lgkmcnt(9)
    v_mfma_f32_32x32x16_bf16 v[64:79], v[48:51], v[168:171], v[64:79]
    ds_read_b64_tr_b16 v[40:41], v16 offset:2560
    ds_read_b64_tr_b16 v[42:43], v17 offset:2560
    s_waitcnt lgkmcnt(10)
    v_readfirstlane_b32 s40, v2
    s_nop 0
    s_cmp_ge_u32 s40, 1
    s_cbranch_scc0 g1s_25
g1b_24:
    v_fma_f32 v118, v118, v11, v11
    v_mul_f32 v124, v124, v116
    v_rcp_f32_e64 v117, v117
    v_mfma_f32_32x32x16_bf16 v[80:95], v[52:55], v[168:171], v[80:95]
    ds_read_b64_tr_b16 v[44:45], v18 offset:2560
    ds_read_b64_tr_b16 v[46:47], v19 offset:2560
    v_cvt_pk_bf16_f32 v29, v122, v123
    v_fma_f32 v119, v119, v11, v11
    v_mul_f32 v125, v125, v117
    ds_write_b128 v22, v[24:27]
    v_rcp_f32 v118, v118
    s_waitcnt lgkmcnt(8)
    v_mfma_f32_32x32x16_bf16 v[64:79], v[56:59], v[172:175], v[64:79]
    ds_read_b64_tr_b16 v[48:49], v16 offset:3072
    ds_read_b64_tr_b16 v[50:51], v17 offset:3072
    v_mul_f32 v126, v126, v118
    v_rcp_f32 v119, v119
    v_cvt_pk_bf16_f32 v30, v124, v125
    v_mov_b32 v23, 2
    v_mul_f32_e64 v127, v127, v119
    v_cvt_pk_bf16_f32 v31, v126, v127
    v_mfma_f32_32x32x16_bf16 v[80:95], v[60:63], v[172:175], v[80:95]
    ds_read_b64_tr_b16 v[52:53], v18 offset:3072
    ds_read_b64_tr_b16 v[54:55], v19 offset:3072
    v_mov_b32_e64 v0, 14
    ds_write_b128 v22, v[28:31] offset:1024
    ds_write_b32 v9, v23 offset:112
    s_waitcnt lgkmcnt(8)
    s_nop 0
    v_mfma_f32_32x32x16_bf16 v[64:79], v[32:35], v[176:179], v[64:79]
    ds_read_b64_tr_b16 v[56:57], v16 offset:3584
    ds_read_b64_tr_b16 v[58:59], v17 offset:3584
    v_mfma_f32_32x32x16_bf16 v[80:95], v[36:39], v[176:179], v[80:95]
    ds_read_b64_tr_b16 v[60:61], v18 offset:3584
    ds_read_b64_tr_b16 v[62:63], v19 offset:3584
    ds_write_b32 v9, v0 offset:16
    s_waitcnt lgkmcnt(8)
    s_nop 0
    v_mfma_f32_32x32x16_bf16 v[64:79], v[40:43], v[180:183], v[64:79]
    ds_read_b64_tr_b16 v[32:33], v12 offset:0
    ds_read_b64_tr_b16 v[34:35], v13 offset:0
    v_mfma_f32_32x32x16_bf16 v[80:95], v[44:47], v[180:183], v[80:95]
    ds_read_b64_tr_b16 v[36:37], v14 offset:0
    ds_read_b64_tr_b16 v[38:39], v15 offset:0
    s_waitcnt lgkmcnt(8)
    s_nop 0
    v_mfma_f32_32x32x16_bf16 v[64:79], v[48:51], v[184:187], v[64:79]
    ds_read_b64_tr_b16 v[40:41], v12 offset:512
    ds_read_b64_tr_b16 v[42:43], v13 offset:512
    v_mfma_f32_32x32x16_bf16 v[80:95], v[52:55], v[184:187], v[80:95]
    ds_read_b64_tr_b16 v[44:45], v14 offset:512
    ds_read_b64_tr_b16 v[46:47], v15 offset:512
    s_waitcnt lgkmcnt(8)
    s_nop 0
    v_mfma_f32_32x32x16_bf16 v[64:79], v[56:59], v[188:191], v[64:79]
    ds_read_b64_tr_b16 v[48:49], v12 offset:1024
    ds_read_b64_tr_b16 v[50:51], v13 offset:1024
    v_mul_i32_i24 v0, -8192, v8
    v_add_u32 v0, 49152, v0
    v_mfma_f32_32x32x16_bf16 v[80:95], v[60:63], v[188:191], v[80:95]
    ds_read_b64_tr_b16 v[52:53], v14 offset:1024
    ds_read_b64_tr_b16 v[54:55], v15 offset:1024
    s_waitcnt lgkmcnt(8)
    s_nop 0
    v_mfma_f32_32x32x16_bf16 v[64:79], v[32:35], v[192:195], v[64:79]
    ds_read_b64_tr_b16 v[56:57], v12 offset:1536
    ds_read_b64_tr_b16 v[58:59], v13 offset:1536
    v_mfma_f32_32x32x16_bf16 v[80:95], v[36:39], v[192:195], v[80:95]
    ds_read_b64_tr_b16 v[60:61], v14 offset:1536
    ds_read_b64_tr_b16 v[62:63], v15 offset:1536
    s_waitcnt lgkmcnt(8)
    v_mfma_f32_32x32x16_bf16 v[64:79], v[40:43], v[196:199], v[64:79]
    ds_read_b64_tr_b16 v[32:33], v12 offset:2048
    ds_read_b64_tr_b16 v[34:35], v13 offset:2048
    v_add_u32 v16, v0, v4
    v_add_u32_e64 v17, v0, v5
    v_mfma_f32_32x32x16_bf16 v[80:95], v[44:47], v[196:199], v[80:95]
    ds_read_b64_tr_b16 v[36:37], v14 offset:2048
    ds_read_b64_tr_b16 v[38:39], v15 offset:2048
    v_add_u32 v18, v0, v6
    v_add_u32 v19, v0, v7
    s_waitcnt lgkmcnt(8)
    s_nop 0
    v_mfma_f32_32x32x16_bf16 v[64:79], v[48:51], v[200:203], v[64:79]
    ds_read_b64_tr_b16 v[40:41], v12 offset:2560
    ds_read_b64_tr_b16 v[42:43], v13 offset:2560
    v_mfma_f32_32x32x16_bf16 v[80:95], v[52:55], v[200:203], v[80:95]
    ds_read_b64_tr_b16 v[44:45], v14 offset:2560
    ds_read_b64_tr_b16 v[46:47], v15 offset:2560
    s_waitcnt lgkmcnt(8)
    s_nop 0
    v_mfma_f32_32x32x16_bf16 v[64:79], v[56:59], v[204:207], v[64:79]
    ds_read_b64_tr_b16 v[48:49], v12 offset:3072
    ds_read_b64_tr_b16 v[50:51], v13 offset:3072
    v_mfma_f32_32x32x16_bf16 v[80:95], v[60:63], v[204:207], v[80:95]
    ds_read_b64_tr_b16 v[52:53], v14 offset:3072
    ds_read_b64_tr_b16 v[54:55], v15 offset:3072
    v_mov_b32 v0, 15
    s_waitcnt lgkmcnt(8)
    v_mfma_f32_32x32x16_bf16 v[64:79], v[32:35], v[208:211], v[64:79]
    ds_read_b64_tr_b16 v[56:57], v12 offset:3584
    ds_read_b64_tr_b16 v[58:59], v13 offset:3584
    s_load_dword s53, s[64:65], s54 glc
    v_mfma_f32_32x32x16_bf16 v[80:95], v[36:39], v[208:211], v[80:95]
    ds_read_b64_tr_b16 v[60:61], v14 offset:3584
    ds_read_b64_tr_b16 v[62:63], v15 offset:3584
    ds_write_b32 v9, v0 offset:16
    s_waitcnt lgkmcnt(8)
    s_nop 0
    v_mfma_f32_32x32x16_bf16 v[64:79], v[40:43], v[212:215], v[64:79]
    ds_read_b64_tr_b16 v[32:33], v16 offset:0
    ds_read_b64_tr_b16 v[34:35], v17 offset:0
    v_mfma_f32_32x32x16_bf16 v[80:95], v[44:47], v[212:215], v[80:95]
    ds_read_b64_tr_b16 v[36:37], v18 offset:0
    ds_read_b64_tr_b16 v[38:39], v19 offset:0
    s_waitcnt lgkmcnt(8)
    s_nop 0
    v_mfma_f32_32x32x16_bf16 v[64:79], v[48:51], v[216:219], v[64:79]
    ds_read_b64_tr_b16 v[40:41], v16 offset:512
    ds_read_b64_tr_b16 v[42:43], v17 offset:512
    v_mfma_f32_32x32x16_bf16 v[80:95], v[52:55], v[216:219], v[80:95]
    ds_read_b64_tr_b16 v[44:45], v18 offset:512
    ds_read_b64_tr_b16 v[46:47], v19 offset:512
    s_waitcnt lgkmcnt(8)
    s_nop 0
    v_mfma_f32_32x32x16_bf16 v[64:79], v[56:59], v[220:223], v[64:79]
    ds_read_b64_tr_b16 v[48:49], v16 offset:1024
    ds_read_b64_tr_b16 v[50:51], v17 offset:1024
    v_mfma_f32_32x32x16_bf16 v[80:95], v[60:63], v[220:223], v[80:95]
    ds_read_b64_tr_b16 v[52:53], v18 offset:1024
    ds_read_b64_tr_b16 v[54:55], v19 offset:1024
    s_waitcnt lgkmcnt(8)
    s_nop 0
    v_mfma_f32_32x32x16_bf16 v[64:79], v[32:35], v[224:227], v[64:79]
    ds_read_b64_tr_b16 v[56:57], v16 offset:1536
    ds_read_b64_tr_b16 v[58:59], v17 offset:1536
    v_mfma_f32_32x32x16_bf16 v[80:95], v[36:39], v[224:227], v[80:95]
    ds_read_b64_tr_b16 v[60:61], v18 offset:1536
    ds_read_b64_tr_b16 v[62:63], v19 offset:1536
    s_waitcnt lgkmcnt(8)
    s_nop 0
    v_mfma_f32_32x32x16_bf16 v[64:79], v[40:43], v[228:231], v[64:79]
    ds_read_b64_tr_b16 v[32:33], v16 offset:2048
    ds_read_b64_tr_b16 v[34:35], v17 offset:2048
    v_mfma_f32_32x32x16_bf16 v[80:95], v[44:47], v[228:231], v[80:95]
    ds_read_b64_tr_b16 v[36:37], v18 offset:2048
    ds_read_b64_tr_b16 v[38:39], v19 offset:2048
    s_waitcnt lgkmcnt(8)
    s_nop 0
    v_mfma_f32_32x32x16_bf16 v[64:79], v[48:51], v[232:235], v[64:79]
    ds_read_b64_tr_b16 v[40:41], v16 offset:2560
    ds_read_b64_tr_b16 v[42:43], v17 offset:2560
    v_mfma_f32_32x32x16_bf16 v[80:95], v[52:55], v[232:235], v[80:95]
    ds_read_b64_tr_b16 v[44:45], v18 offset:2560
    ds_read_b64_tr_b16 v[46:47], v19 offset:2560
    s_waitcnt lgkmcnt(8)
    s_nop 0
    v_mfma_f32_32x32x16_bf16 v[64:79], v[56:59], v[236:239], v[64:79]
    ds_read_b64_tr_b16 v[48:49], v16 offset:3072
    ds_read_b64_tr_b16 v[50:51], v17 offset:3072
    v_mfma_f32_32x32x16_bf16 v[80:95], v[60:63], v[236:239], v[80:95]
    ds_read_b64_tr_b16 v[52:53], v18 offset:3072
    ds_read_b64_tr_b16 v[54:55], v19 offset:3072
    v_mov_b32 v0, 16
    s_waitcnt lgkmcnt(0)
    s_bitcmp1_b32 s53, 4
    s_cbranch_scc0 g1late_26
    v_readlane_b32 s68, v20, 0
    v_readlane_b32 s69, v20, 1
    v_readlane_b32 s70, v20, 2
    v_mfma_f32_32x32x16_bf16 v[64:79], v[32:35], v[240:243], v[64:79]
    ds_read_b64_tr_b16 v[56:57], v16 offset:3584
    ds_read_b64_tr_b16 v[58:59], v17 offset:3584
    v_readlane_b32 s71, v20, 3
    buffer_load_dwordx4 v[128:131], v3, s[36:39], s68 offen sc1
    v_mfma_f32_32x32x16_bf16 v[80:95], v[36:39], v[240:243], v[80:95]
    ds_read_b64_tr_b16 v[60:61], v18 offset:3584
    ds_read_b64_tr_b16 v[62:63], v19 offset:3584
    ds_write_b32 v9, v0 offset:16
    v_readlane_b32 s68, v20, 4
    buffer_load_dwordx4 v[132:135], v3, s[36:39], s69 offen sc1
    v_mfma_f32_32x32x16_bf16 v[64:79], v[40:43], v[244:247], v[64:79]
    v_readlane_b32 s69, v20, 5
    buffer_load_dwordx4 v[136:139], v3, s[36:39], s70 offen sc1
    v_mfma_f32_32x32x16_bf16 v[80:95], v[44:47], v[244:247], v[80:95]
    v_readlane_b32 s70, v20, 6
    buffer_load_dwordx4 v[140:143], v3, s[36:39], s71 offen sc1
    v_mfma_f32_32x32x16_bf16 v[64:79], v[48:51], v[248:251], v[64:79]
    v_readlane_b32 s71, v20, 7
    buffer_load_dwordx4 v[144:147], v3, s[36:39], s68 offen sc1
    v_mfma_f32_32x32x16_bf16 v[80:95], v[52:55], v[248:251], v[80:95]
    buffer_load_dwordx4 v[148:151], v3, s[36:39], s69 offen sc1
    s_waitcnt lgkmcnt(0)
    v_mfma_f32_32x32x16_bf16 v[64:79], v[56:59], v[252:255], v[64:79]
    buffer_load_dwordx4 v[152:155], v3, s[36:39], s70 offen sc1
    v_mfma_f32_32x32x16_bf16 v[80:95], v[60:63], v[252:255], v[80:95]
    buffer_load_dwordx4 v[156:159], v3, s[36:39], s71 offen sc1
    s_load_dword s53, s[64:65], s54 glc
    s_nop 7
    v_mul_f32 v72, v64, v72
    v_mul_f32 v64, v10, v64
    v_mul_f32 v73, v65, v73
    v_mul_f32 v65, v10, v65
    v_exp_f32 v64, v64
    v_mul_f32 v74, v66, v74
    v_mul_f32 v66, v10, v66
    v_exp_f32 v65, v65
    v_fma_f32 v64, v64, v11, v11
    v_mul_f32 v75, v67, v75
    v_mul_f32 v67, v10, v67
    v_exp_f32 v66, v66
    v_fma_f32 v65, v65, v11, v11
    v_rcp_f32 v64, v64
    v_mul_f32 v76, v68, v76
    v_mul_f32 v68, v10, v68
    v_exp_f32 v67, v67
    v_fma_f32 v66, v66, v11, v11
    v_mul_f32 v72, v72, v64
    v_rcp_f32 v65, v65
    v_mul_f32 v77, v69, v77
    v_mul_f32 v69, v10, v69
    v_exp_f32 v68, v68
    v_fma_f32 v67, v67, v11, v11
    v_mul_f32 v73, v73, v65
    v_rcp_f32 v66, v66
    v_mul_f32 v78, v70, v78
    v_mul_f32 v70, v10, v70
    v_exp_f32 v69, v69
    v_fma_f32 v68, v68, v11, v11
    v_mul_f32 v74, v74, v66
    v_rcp_f32 v67, v67
    v_cvt_pk_bf16_f32 v24, v72, v73
    v_mul_f32 v79, v71, v79
    v_mul_f32 v71, v10, v71
    v_exp_f32 v70, v70
    v_fma_f32 v69, v69, v11, v11
    v_mul_f32 v75, v75, v67
    v_rcp_f32 v68, v68
    v_mul_f32 v88, v80, v88
    v_mul_f32 v80, v10, v80
    v_exp_f32 v71, v71
    v_fma_f32 v70, v70, v11, v11
    v_mul_f32 v76, v76, v68
    v_rcp_f32 v69, v69
    v_cvt_pk_bf16_f32 v25, v74, v75
    v_mul_f32 v89, v81, v89
    v_mul_f32 v81, v10, v81
    v_exp_f32 v80, v80
    v_fma_f32 v71, v71, v11, v11
    v_mul_f32 v77, v77, v69
    v_rcp_f32 v70, v70
    v_mul_f32 v90, v82, v90
    v_mul_f32 v82, v10, v82
    v_exp_f32 v81, v81
    v_fma_f32 v80, v80, v11, v11
    v_mul_f32 v78, v78, v70
    v_rcp_f32 v71, v71
    v_cvt_pk_bf16_f32 v26, v76, v77
    v_mul_f32 v91, v83, v91
    v_mul_f32 v83, v10, v83
    v_exp_f32 v82, v82
    v_fma_f32 v81, v81, v11, v11
    v_mul_f32 v79, v79, v71
    v_rcp_f32 v80, v80
    v_mul_f32 v92, v84, v92
    v_mul_f32 v84, v10, v84
    v_exp_f32 v83, v83
    v_fma_f32 v82, v82, v11, v11
    v_mul_f32 v88, v88, v80
    v_rcp_f32 v81, v81
    v_cvt_pk_bf16_f32 v27, v78, v79
    v_mul_f32 v93, v85, v93
    v_mul_f32 v85, v10, v85
    buffer_store_dwordx4 v[24:27], v3, s[36:39], s62 offen sc0 sc1
    v_exp_f32 v84, v84
    v_fma_f32 v83, v83, v11, v11
    v_mul_f32 v89, v89, v81
    v_rcp_f32 v82, v82
    v_mul_f32 v94, v86, v94
    v_mul_f32 v86, v10, v86
    v_exp_f32 v85, v85
    v_fma_f32 v84, v84, v11, v11
    v_mul_f32 v90, v90, v82
    v_rcp_f32 v83, v83
    v_cvt_pk_bf16_f32 v28, v88, v89
    v_mul_f32 v95, v87, v95
    v_mul_f32 v87, v10, v87
    v_exp_f32 v86, v86
    v_fma_f32 v85, v85, v11, v11
    v_mul_f32 v91, v91, v83
    v_rcp_f32 v84, v84
    v_exp_f32 v87, v87
    v_fma_f32 v86, v86, v11, v11
    v_mul_f32 v92, v92, v84
    v_rcp_f32_e64 v85, v85
    v_cvt_pk_bf16_f32 v29, v90, v91
    v_fma_f32 v87, v87, v11, v11
    v_mul_f32 v93, v93, v85
    v_rcp_f32 v86, v86
    s_nop 0
    v_mul_f32 v94, v94, v86
    v_rcp_f32 v87, v87
    v_cvt_pk_bf16_f32 v30, v92, v93
    v_mul_f32 v95, v95, v87
    v_cvt_pk_bf16_f32 v31, v94, v95
    buffer_store_dwordx4 v[28:31], v3, s[36:39], s62 offen offset:1024 sc0 sc1
    s_mov_b32 s58, 0
    s_branch g1done_9
g1late_26:
    v_mfma_f32_32x32x16_bf16 v[64:79], v[32:35], v[240:243], v[64:79]
    ds_read_b64_tr_b16 v[56:57], v16 offset:3584
    ds_read_b64_tr_b16 v[58:59], v17 offset:3584
    v_mfma_f32_32x32x16_bf16 v[80:95], v[36:39], v[240:243], v[80:95]
    ds_read_b64_tr_b16 v[60:61], v18 offset:3584
    ds_read_b64_tr_b16 v[62:63], v19 offset:3584
    ds_write_b32 v9, v0 offset:16
    v_mfma_f32_32x32x16_bf16 v[64:79], v[40:43], v[244:247], v[64:79]
    v_mfma_f32_32x32x16_bf16 v[80:95], v[44:47], v[244:247], v[80:95]
    v_mfma_f32_32x32x16_bf16 v[64:79], v[48:51], v[248:251], v[64:79]
    v_mfma_f32_32x32x16_bf16 v[80:95], v[52:55], v[248:251], v[80:95]
    s_waitcnt lgkmcnt(0)
    v_mfma_f32_32x32x16_bf16 v[64:79], v[56:59], v[252:255], v[64:79]
    v_mfma_f32_32x32x16_bf16 v[80:95], v[60:63], v[252:255], v[80:95]
    s_load_dword s53, s[64:65], s54 glc
    s_nop 9
    v_mul_f32 v72, v64, v72
    v_mul_f32 v64, v10, v64
    v_mul_f32 v73, v65, v73
    v_mul_f32 v65, v10, v65
    v_exp_f32 v64, v64
    v_mul_f32 v74, v66, v74
    v_mul_f32 v66, v10, v66
    v_exp_f32 v65, v65
    v_fma_f32 v64, v64, v11, v11
    v_mul_f32 v75, v67, v75
    v_mul_f32 v67, v10, v67
    v_exp_f32 v66, v66
    v_fma_f32 v65, v65, v11, v11
    v_rcp_f32 v64, v64
    v_mul_f32 v76, v68, v76
    v_mul_f32 v68, v10, v68
    v_exp_f32 v67, v67
    v_fma_f32 v66, v66, v11, v11
    v_mul_f32 v72, v72, v64
    v_rcp_f32 v65, v65
    v_mul_f32 v77, v69, v77
    v_mul_f32 v69, v10, v69
    v_exp_f32 v68, v68
    v_fma_f32 v67, v67, v11, v11
    v_mul_f32 v73, v73, v65
    v_rcp_f32 v66, v66
    v_mul_f32 v78, v70, v78
    v_mul_f32 v70, v10, v70
    v_exp_f32 v69, v69
    v_fma_f32 v68, v68, v11, v11
    v_mul_f32 v74, v74, v66
    v_rcp_f32 v67, v67
    v_cvt_pk_bf16_f32 v24, v72, v73
    v_mul_f32 v79, v71, v79
    v_mul_f32 v71, v10, v71
    v_exp_f32 v70, v70
    v_fma_f32 v69, v69, v11, v11
    v_mul_f32 v75, v75, v67
    v_rcp_f32 v68, v68
    v_mul_f32 v88, v80, v88
    v_mul_f32 v80, v10, v80
    v_exp_f32 v71, v71
    v_fma_f32 v70, v70, v11, v11
    v_mul_f32 v76, v76, v68
    v_rcp_f32 v69, v69
    v_cvt_pk_bf16_f32 v25, v74, v75
    v_mul_f32 v89, v81, v89
    v_mul_f32 v81, v10, v81
    v_exp_f32 v80, v80
    v_fma_f32 v71, v71, v11, v11
    v_mul_f32 v77, v77, v69
    v_rcp_f32 v70, v70
    v_mul_f32 v90, v82, v90
    v_mul_f32 v82, v10, v82
    v_exp_f32 v81, v81
    v_fma_f32 v80, v80, v11, v11
    v_mul_f32 v78, v78, v70
    v_rcp_f32 v71, v71
    v_cvt_pk_bf16_f32 v26, v76, v77
    v_mul_f32 v91, v83, v91
    v_mul_f32 v83, v10, v83
    v_exp_f32 v82, v82
    v_fma_f32 v81, v81, v11, v11
    v_mul_f32 v79, v79, v71
    v_rcp_f32 v80, v80
    v_mul_f32 v92, v84, v92
    v_mul_f32 v84, v10, v84
    v_exp_f32 v83, v83
    v_fma_f32 v82, v82, v11, v11
    v_mul_f32 v88, v88, v80
    v_rcp_f32 v81, v81
    v_cvt_pk_bf16_f32 v27, v78, v79
    v_mul_f32 v93, v85, v93
    v_mul_f32 v85, v10, v85
    buffer_store_dwordx4 v[24:27], v3, s[36:39], s62 offen sc0 sc1
    v_exp_f32 v84, v84
    v_fma_f32 v83, v83, v11, v11
    v_mul_f32 v89, v89, v81
    v_rcp_f32 v82, v82
    v_mul_f32 v94, v86, v94
    v_mul_f32 v86, v10, v86
    v_exp_f32 v85, v85
    v_fma_f32 v84, v84, v11, v11
    v_mul_f32 v90, v90, v82
    v_rcp_f32 v83, v83
    v_cvt_pk_bf16_f32 v28, v88, v89
    v_mul_f32 v95, v87, v95
    v_mul_f32 v87, v10, v87
    v_exp_f32 v86, v86
    v_fma_f32 v85, v85, v11, v11
    v_mul_f32 v91, v91, v83
    v_rcp_f32 v84, v84
    v_exp_f32 v87, v87
    v_fma_f32 v86, v86, v11, v11
    v_mul_f32 v92, v92, v84
    v_rcp_f32_e64 v85, v85
    v_cvt_pk_bf16_f32 v29, v90, v91
    v_fma_f32 v87, v87, v11, v11
    v_mul_f32 v93, v93, v85
    v_rcp_f32 v86, v86
    s_nop 0
    v_mul_f32 v94, v94, v86
    v_rcp_f32 v87, v87
    v_cvt_pk_bf16_f32 v30, v92, v93
    v_mul_f32 v95, v95, v87
    v_cvt_pk_bf16_f32 v31, v94, v95
    buffer_store_dwordx4 v[28:31], v3, s[36:39], s62 offen offset:1024 sc0 sc1
    s_waitcnt lgkmcnt(0)
    s_mov_b32 s58, 2
    s_bitcmp1_b32 s53, 4
    s_cbranch_scc1 k_g2mid
    s_waitcnt vmcnt(0)
    s_nop 0
    s_mov_b32 s59, 0x10000
    s_atomic_add s59, s[60:61], 0
    s_atomic_add s59, s[60:61], 8192
    s_atomic_add s59, s[60:61], 16384
    s_atomic_add s59, s[60:61], 24576
    s_atomic_add s59, s[60:61], 32768
    s_atomic_add s59, s[60:61], 40960
    s_atomic_add s59, s[60:61], 49152
    s_atomic_add s59, s[60:61], 57344
    s_branch k_g2late
g1fin2_8:
    v_mov_b32 v0, 16
    ds_write_b32 v9, v0 offset:16
    s_mov_b32 s56, 0
    s_mov_b32 s53, 0
    s_nop 15
    v_mul_f32 v104, v96, v104
    v_mul_f32 v96, v10, v96
    v_mul_f32 v105, v97, v105
    v_mul_f32 v97, v10, v97
    v_exp_f32 v96, v96
    v_mul_f32 v106, v98, v106
    v_mul_f32 v98, v10, v98
    v_exp_f32 v97, v97
    v_fma_f32 v96, v96, v11, v11
    v_mul_f32 v107, v99, v107
    v_mul_f32 v99, v10, v99
    v_exp_f32 v98, v98
    v_fma_f32 v97, v97, v11, v11
    v_rcp_f32 v96, v96
    v_mul_f32 v108, v100, v108
    v_mul_f32 v100, v10, v100
    v_exp_f32 v99, v99
    v_fma_f32 v98, v98, v11, v11
    v_mul_f32 v104, v104, v96
    v_rcp_f32 v97, v97
    v_mul_f32 v109, v101, v109
    v_mul_f32 v101, v10, v101
    v_exp_f32 v100, v100
    v_fma_f32 v99, v99, v11, v11
    v_mul_f32 v105, v105, v97
    v_rcp_f32 v98, v98
    v_mul_f32 v110, v102, v110
    v_mul_f32 v102, v10, v102
    v_exp_f32 v101, v101
    v_fma_f32 v100, v100, v11, v11
    v_mul_f32 v106, v106, v98
    v_rcp_f32 v99, v99
    v_cvt_pk_bf16_f32 v24, v104, v105
    v_mul_f32 v111, v103, v111
    v_mul_f32 v103, v10, v103
    v_exp_f32 v102, v102
    v_fma_f32 v101, v101, v11, v11
    v_mul_f32 v107, v107, v99
    v_rcp_f32 v100, v100
    v_mul_f32 v120, v112, v120
    v_mul_f32 v112, v10, v112
    v_exp_f32 v103, v103
    v_fma_f32 v102, v102, v11, v11
    v_mul_f32 v108, v108, v100
    v_rcp_f32 v101, v101
    v_cvt_pk_bf16_f32 v25, v106, v107
    v_mul_f32 v121, v113, v121
    v_mul_f32 v113, v10, v113
    v_exp_f32 v112, v112
    v_fma_f32 v103, v103, v11, v11
    v_mul_f32 v109, v109, v101
    v_rcp_f32 v102, v102
    v_mul_f32 v122, v114, v122
    v_mul_f32 v114, v10, v114
    v_exp_f32 v113, v113
    v_fma_f32 v112, v112, v11, v11
    v_mul_f32 v110, v110, v102
    v_rcp_f32 v103, v103
    v_cvt_pk_bf16_f32 v26, v108, v109
    v_mul_f32 v123, v115, v123
    v_mul_f32 v115, v10, v115
    v_exp_f32 v114, v114
    v_fma_f32 v113, v113, v11, v11
    v_mul_f32 v111, v111, v103
    v_rcp_f32 v112, v112
    v_mul_f32 v124, v116, v124
    v_mul_f32 v116, v10, v116
    v_exp_f32 v115, v115
    v_fma_f32 v114, v114, v11, v11
    v_mul_f32 v120, v120, v112
    v_rcp_f32 v113, v113
    v_cvt_pk_bf16_f32 v27, v110, v111
    v_mul_f32 v125, v117, v125
    v_mul_f32 v117, v10, v117
    v_exp_f32 v116, v116
    v_fma_f32 v115, v115, v11, v11
    v_mul_f32 v121, v121, v113
    v_rcp_f32 v114, v114
    v_mul_f32 v126, v118, v126
    v_mul_f32 v118, v10, v118
    v_exp_f32 v117, v117
    v_fma_f32 v116, v116, v11, v11
    v_mul_f32 v122, v122, v114
    v_rcp_f32 v115, v115
    v_cvt_pk_bf16_f32 v28, v120, v121
    v_mul_f32 v127, v119, v127
    v_mul_f32 v119, v10, v119
    v_exp_f32 v118, v118
    v_fma_f32 v117, v117, v11, v11
    v_mul_f32 v123, v123, v115
    v_rcp_f32 v116, v116
    v_exp_f32 v119, v119
    v_fma_f32 v118, v118, v11, v11
    v_mul_f32 v124, v124, v116
    v_rcp_f32 v117, v117
    v_cvt_pk_bf16_f32 v29, v122, v123
    v_fma_f32 v119, v119, v11, v11
    v_mul_f32 v125, v125, v117
    s_cmp_ge_u32 s56, 1
    s_cbranch_scc0 g1s_28
g1b_27:
    ds_write_b128 v22, v[24:27]
    v_rcp_f32 v118, v118
    s_nop 0
    v_mul_f32 v126, v126, v118
    v_rcp_f32 v119, v119
    v_cvt_pk_bf16_f32 v30, v124, v125
    v_mov_b32 v23, 2
    v_mul_f32_e64 v127, v127, v119
    v_cvt_pk_bf16_f32 v31, v126, v127
    ds_write_b128 v22, v[28:31] offset:1024
    ds_write_b32 v9, v23 offset:112
k_g2late:
    s_mov_b32 s58, 1
    s_waitcnt lgkmcnt(0)
    s_bitcmp1_b32 s53, 4
    s_cbranch_scc1 hpd_30
    s_mov_b32 s41, 2097152
hp_29:
    ds_read_b32 v2, v9 offset:176
    s_waitcnt lgkmcnt(0)
    v_readfirstlane_b32 s40, v2
    s_nop 0
    s_max_u32 s53, s53, s40
    s_bitcmp1_b32 s53, 4
    s_cbranch_scc1 hpd_30
    s_sub_u32 s41, s41, 1
    s_cbranch_scc0 hp_29
hpd_30:
k_g2mid:
    v_readlane_b32 s68, v20, 0
    v_readlane_b32 s69, v20, 1
    v_readlane_b32 s70, v20, 2
    v_readlane_b32 s71, v20, 3
    s_nop 1
    s_nop 0
    buffer_load_dwordx4 v[128:131], v3, s[36:39], s68 offen sc1
    v_readlane_b32 s68, v20, 4
    buffer_load_dwordx4 v[132:135], v3, s[36:39], s69 offen sc1
    v_readlane_b32 s69, v20, 5
    buffer_load_dwordx4 v[136:139], v3, s[36:39], s70 offen sc1
    v_readlane_b32 s70, v20, 6
    buffer_load_dwordx4 v[140:143], v3, s[36:39], s71 offen sc1
    v_readlane_b32 s71, v20, 7
    buffer_load_dwordx4 v[144:147], v3, s[36:39], s68 offen sc1
    buffer_load_dwordx4 v[148:151], v3, s[36:39], s69 offen sc1
    s_nop 0
    buffer_load_dwordx4 v[152:155], v3, s[36:39], s70 offen sc1
    s_nop 0
    buffer_load_dwordx4 v[156:159], v3, s[36:39], s71 offen sc1
    s_branch g1done_9
g1s_7:
    s_mov_b32 s41, 2097152
lw_31:
    ds_read_b32 v2, v9 offset:0
    s_waitcnt lgkmcnt(0)
    v_readfirstlane_b32 s40, v2
    s_nop 0
    s_cmp_ge_u32 s40, 1
    s_cbranch_scc1 lwd_32
    s_sub_u32 s41, s41, 1
    s_cbranch_scc0 lw_31
lwd_32:
    s_branch g1b_6
g1s_11:
    s_mov_b32 s41, 2097152
lw_33:
    ds_read_b32 v2, v9 offset:0
    s_waitcnt lgkmcnt(0)
    v_readfirstlane_b32 s40, v2
    s_nop 0
    s_cmp_ge_u32 s40, 2
    s_cbranch_scc1 lwd_34
    s_sub_u32 s41, s41, 1
    s_cbranch_scc0 lw_33
lwd_34:
    s_branch g1b_10
g1s_13:
    s_mov_b32 s41, 2097152
lw_35:
    ds_read_b32 v2, v9 offset:0
    s_waitcnt lgkmcnt(0)
    v_readfirstlane_b32 s40, v2
    s_nop 0
    s_cmp_ge_u32 s40, 3
    s_cbranch_scc1 lwd_36
    s_sub_u32 s41, s41, 1
    s_cbranch_scc0 lw_35
lwd_36:
    s_branch g1b_12
g1s_15:
    s_mov_b32 s41, 2097152
lw_37:
    ds_read_b32 v2, v9 offset:0
    s_waitcnt lgkmcnt(0)
    v_readfirstlane_b32 s40, v2
    s_nop 0
    s_cmp_ge_u32 s40, 4
    s_cbranch_scc1 lwd_38
    s_sub_u32 s41, s41, 1
    s_cbranch_scc0 lw_37
lwd_38:
    s_branch g1b_14
g1s_17:
    s_mov_b32 s41, 2097152
lw_39:
    ds_read_b32 v2, v9 offset:0
    s_waitcnt lgkmcnt(0)
    v_readfirstlane_b32 s40, v2
    s_nop 0
    s_cmp_ge_u32 s40, 5
    s_cbranch_scc1 lwd_40
    s_sub_u32 s41, s41, 1
    s_cbranch_scc0 lw_39
lwd_40:
    s_branch g1b_16
g1s_19:
    s_mov_b32 s41, 2097152
lw_41:
    ds_read_b32 v2, v9 offset:0
    s_waitcnt lgkmcnt(0)
    v_readfirstlane_b32 s40, v2
    s_nop 0
    s_cmp_ge_u32 s40, 6
    s_cbranch_scc1 lwd_42
    s_sub_u32 s41, s41, 1
    s_cbranch_scc0 lw_41
lwd_42:
    s_branch g1b_18
g1s_21:
    s_mov_b32 s41, 2097152
lw_43:
    ds_read_b32 v2, v9 offset:0
    s_waitcnt lgkmcnt(0)
    v_readfirstlane_b32 s40, v2
    s_nop 0
    s_cmp_ge_u32 s40, 7
    s_cbranch_scc1 lwd_44
    s_sub_u32 s41, s41, 1
    s_cbranch_scc0 lw_43
lwd_44:
    s_branch g1b_20
g1s_23:
    s_mov_b32 s41, 2097152
lw_45:
    ds_read_b32 v2, v9 offset:0
    s_waitcnt lgkmcnt(0)
    v_readfirstlane_b32 s40, v2
    s_nop 0
    s_cmp_ge_u32 s40, 8
    s_cbranch_scc1 lwd_46
    s_sub_u32 s41, s41, 1
    s_cbranch_scc0 lw_45
lwd_46:
    s_branch g1b_22
g1s_25:
    s_mov_b32 s41, 2097152
lw_47:
    ds_read_b32 v2, v9 offset:128
    s_waitcnt lgkmcnt(0)
    v_readfirstlane_b32 s40, v2
    s_nop 0
    s_cmp_ge_u32 s40, 1
    s_cbranch_scc1 lwd_48
    s_sub_u32 s41, s41, 1
    s_cbranch_scc0 lw_47
lwd_48:
    s_branch g1b_24
g1s_28:
    s_mov_b32 s41, 2097152
lw_49:
    ds_read_b32 v2, v9 offset:128
    s_waitcnt lgkmcnt(0)
    v_readfirstlane_b32 s40, v2
    s_nop 0
    s_cmp_ge_u32 s40, 1
    s_cbranch_scc1 lwd_50
    s_sub_u32 s41, s41, 1
    s_cbranch_scc0 lw_49
lwd_50:
    s_branch g1b_27
g1done_9:
    v_mov_b32 v8, v20
    s_nop 0
    v_readlane_b32 s68, v8, 8
    v_readlane_b32 s69, v8, 9
    v_readlane_b32 s70, v8, 10
    s_mov_b32 s55, 0
    s_mov_b32 s57, 0
    ds_read_b32 v2, v9 offset:64
    v_mov_b32 v4, v21
    v_xor_b32_e64 v5, 64, v21
    v_add_u32 v6, 0x10000, v4
    v_add_u32 v7, 0x10000, v5
    v_add_u32 v18, 0x20000, v4
    v_add_u32 v19, 0x20000, v5
    s_waitcnt lgkmcnt(0)
    v_readfirstlane_b32 s52, v2
    s_nop 0
    s_cmp_ge_u32 s52, 8
    s_cbranch_scc0 fs_52
fb_51:
    s_nop 0
    ds_read_b64_tr_b16 v[20:21], v4 offset:16384
    ds_read_b64_tr_b16 v[22:23], v4 offset:16896
    ds_read_b64_tr_b16 v[24:25], v5 offset:16384
    ds_read_b64_tr_b16 v[26:27], v5 offset:16896
    ds_read_b64_tr_b16 v[28:29], v4 offset:20480
    ds_read_b64_tr_b16 v[30:31], v4 offset:20992
    ds_read_b64_tr_b16 v[32:33], v5 offset:20480
    ds_read_b64_tr_b16 v[34:35], v5 offset:20992
    v_mov_b32_e64 v0, 17
    ds_write_b32 v9, v0 offset:16
    ds_read_b64_tr_b16 v[36:37], v6 offset:16384
    ds_read_b64_tr_b16 v[38:39], v6 offset:16896
    ds_read_b64_tr_b16 v[40:41], v7 offset:16384
    ds_read_b64_tr_b16 v[42:43], v7 offset:16896
    s_waitcnt vmcnt(7)
    s_cmp_lg_u32 s58, 2
    s_cbranch_scc1 ep_53
    s_nop 0
    s_mov_b32 s59, 0x10000
    s_atomic_add s59, s[60:61], 0
    s_atomic_add s59, s[60:61], 8192
    s_atomic_add s59, s[60:61], 16384
    s_atomic_add s59, s[60:61], 24576
    s_atomic_add s59, s[60:61], 32768
    s_atomic_add s59, s[60:61], 40960
    s_atomic_add s59, s[60:61], 49152
    s_atomic_add s59, s[60:61], 57344
ep_53:
    s_waitcnt lgkmcnt(8)
    s_nop 0
    v_mfma_f32_32x32x16_bf16 v[52:67], v[20:23], v[128:131], 0
    ds_read_b64_tr_b16 v[44:45], v6 offset:20480
    ds_read_b64_tr_b16 v[46:47], v6 offset:20992
    v_mfma_f32_32x32x16_bf16 v[68:83], v[24:27], v[128:131], 0
    ds_read_b64_tr_b16 v[48:49], v7 offset:20480
    ds_read_b64_tr_b16 v[50:51], v7 offset:20992
    v_mov_b32_e64 v0, 18
    ds_write_b32 v9, v0 offset:16
    v_readlane_b32 s71, v8, 11
    buffer_load_dwordx4 v[160:163], v3, s[36:39], s68 offen sc1
    s_waitcnt vmcnt(7)
    s_waitcnt lgkmcnt(8)
    v_mfma_f32_32x32x16_bf16 v[52:67], v[28:31], v[132:135], v[52:67]
    ds_read_b64_tr_b16 v[20:21], v6 offset:49152
    ds_read_b64_tr_b16 v[22:23], v6 offset:49664
    v_mfma_f32_32x32x16_bf16 v[68:83], v[32:35], v[132:135], v[68:83]
    ds_read_b64_tr_b16 v[24:25], v7 offset:49152
    ds_read_b64_tr_b16 v[26:27], v7 offset:49664
    v_readlane_b32 s68, v8, 12
    buffer_load_dwordx4 v[164:167], v3, s[36:39], s69 offen sc1
    s_waitcnt vmcnt(7)
    s_waitcnt lgkmcnt(8)
    v_mfma_f32_32x32x16_bf16 v[52:67], v[36:39], v[136:139], v[52:67]
    ds_read_b64_tr_b16 v[28:29], v6 offset:53248
    ds_read_b64_tr_b16 v[30:31], v6 offset:53760
    v_mfma_f32_32x32x16_bf16 v[68:83], v[40:43], v[136:139], v[68:83]
    ds_read_b64_tr_b16 v[32:33], v7 offset:53248
    ds_read_b64_tr_b16 v[34:35], v7 offset:53760
    v_mov_b32_e64 v0, 19
    ds_write_b32 v9, v0 offset:16
    v_readlane_b32 s69, v8, 13
    buffer_load_dwordx4 v[168:171], v3, s[36:39], s70 offen sc1
    s_waitcnt vmcnt(7)
    s_waitcnt lgkmcnt(8)
    v_mfma_f32_32x32x16_bf16 v[52:67], v[44:47], v[140:143], v[52:67]
    ds_read_b64_tr_b16 v[36:37], v4 offset:24576
    ds_read_b64_tr_b16 v[38:39], v4 offset:25088
    v_mfma_f32_32x32x16_bf16 v[68:83], v[48:51], v[140:143], v[68:83]
    ds_read_b64_tr_b16 v[40:41], v5 offset:24576
    ds_read_b64_tr_b16 v[42:43], v5 offset:25088
    v_readlane_b32 s70, v8, 14
    buffer_load_dwordx4 v[172:175], v3, s[36:39], s71 offen sc1
    s_waitcnt vmcnt(7)
    s_waitcnt lgkmcnt(8)
    v_mfma_f32_32x32x16_bf16 v[52:67], v[20:23], v[144:147], v[52:67]
    ds_read_b64_tr_b16 v[44:45], v4 offset:28672
    ds_read_b64_tr_b16 v[46:47], v4 offset:29184
    v_mfma_f32_32x32x16_bf16 v[68:83], v[24:27], v[144:147], v[68:83]
    ds_read_b64_tr_b16 v[48:49], v5 offset:28672
    ds_read_b64_tr_b16 v[50:51], v5 offset:29184
    v_mov_b32_e64 v0, 20
    ds_write_b32 v9, v0 offset:16
    v_readlane_b32 s71, v8, 15
    buffer_load_dwordx4 v[176:179], v3, s[36:39], s68 offen sc1
    s_waitcnt vmcnt(7)
    s_waitcnt lgkmcnt(8)
    v_mfma_f32_32x32x16_bf16 v[52:67], v[28:31], v[148:151], v[52:67]
    ds_read_b64_tr_b16 v[20:21], v4 offset:57344
    ds_read_b64_tr_b16 v[22:23], v4 offset:57856
    v_mfma_f32_32x32x16_bf16 v[68:83], v[32:35], v[148:151], v[68:83]
    ds_read_b64_tr_b16 v[24:25], v5 offset:57344
    ds_read_b64_tr_b16 v[26:27], v5 offset:57856
    v_readlane_b32 s68, v8, 16
    buffer_load_dwordx4 v[180:183], v3, s[36:39], s69 offen sc1
    s_waitcnt vmcnt(7)
    s_waitcnt lgkmcnt(8)
    v_mfma_f32_32x32x16_bf16 v[52:67], v[36:39], v[152:155], v[52:67]
    ds_read_b64_tr_b16 v[28:29], v4 offset:61440
    ds_read_b64_tr_b16 v[30:31], v4 offset:61952
    v_mfma_f32_32x32x16_bf16 v[68:83], v[40:43], v[152:155], v[68:83]
    ds_read_b64_tr_b16 v[32:33], v5 offset:61440
    ds_read_b64_tr_b16 v[34:35], v5 offset:61952
    v_mov_b32_e64 v0, 21
    ds_write_b32 v9, v0 offset:16
    v_readlane_b32 s69, v8, 17
    buffer_load_dwordx4 v[184:187], v3, s[36:39], s70 offen sc1
    ds_read_b32 v2, v9 offset:176
    s_waitcnt vmcnt(7)
    s_waitcnt lgkmcnt(9)
    v_mfma_f32_32x32x16_bf16 v[52:67], v[44:47], v[156:159], v[52:67]
    ds_read_b64_tr_b16 v[36:37], v6 offset:57344
    ds_read_b64_tr_b16 v[38:39], v6 offset:57856
    v_mfma_f32_32x32x16_bf16 v[68:83], v[48:51], v[156:159], v[68:83]
    ds_read_b64_tr_b16 v[40:41], v7 offset:57344
    ds_read_b64_tr_b16 v[42:43], v7 offset:57856
    v_readlane_b32 s70, v8, 18
    buffer_load_dwordx4 v[188:191], v3, s[36:39], s71 offen sc1
    s_waitcnt vmcnt(7)
    s_waitcnt lgkmcnt(9)
    v_mfma_f32_32x32x16_bf16 v[52:67], v[20:23], v[160:163], v[52:67]
    ds_read_b64_tr_b16 v[44:45], v6 offset:61440
    ds_read_b64_tr_b16 v[46:47], v6 offset:61952
    v_mfma_f32_32x32x16_bf16 v[68:83], v[24:27], v[160:163], v[68:83]
    ds_read_b64_tr_b16 v[48:49], v7 offset:61440
    ds_read_b64_tr_b16 v[50:51], v7 offset:61952
    v_mov_b32 v0, 22
    ds_write_b32 v9, v0 offset:16
    s_cmp_lg_u32 s58, 0
    s_cbranch_scc1 ep_54
    s_waitcnt vmcnt(8)
    s_mov_b32 s59, 0x10000
    s_atomic_add s59, s[60:61], 0
    s_atomic_add s59, s[60:61], 8192
    s_atomic_add s59, s[60:61], 16384
    s_atomic_add s59, s[60:61], 24576
    s_atomic_add s59, s[60:61], 32768
    s_atomic_add s59, s[60:61], 40960
    s_atomic_add s59, s[60:61], 49152
    s_atomic_add s59, s[60:61], 57344
ep_54:
    s_waitcnt lgkmcnt(8)
    v_readfirstlane_b32 s40, v2
    s_nop 0
    s_max_u32 s53, s53, s40
    s_bitcmp1_b32 s53, 12
    s_cbranch_scc1 hpd_56
    s_mov_b32 s41, 2097152
hp_55:
    ds_read_b32 v2, v9 offset:176
    s_waitcnt lgkmcnt(0)
    v_readfirstlane_b32 s40, v2
    s_nop 0
    s_max_u32 s53, s53, s40
    s_bitcmp1_b32 s53, 12
    s_cbranch_scc1 hpd_56
    s_sub_u32 s41, s41, 1
    s_cbranch_scc0 hp_55
hpd_56:
    v_readlane_b32 s71, v8, 19
    buffer_load_dwordx4 v[192:195], v3, s[36:39], s68 offen sc1
    s_waitcnt vmcnt(7)
    s_nop 0
    v_mfma_f32_32x32x16_bf16 v[52:67], v[28:31], v[164:167], v[52:67]
    ds_read_b64_tr_b16 v[20:21], v18 offset:0
    ds_read_b64_tr_b16 v[22:23], v18 offset:512
    v_mfma_f32_32x32x16_bf16 v[68:83], v[32:35], v[164:167], v[68:83]
    ds_read_b64_tr_b16 v[24:25], v19 offset:0
    ds_read_b64_tr_b16 v[26:27], v19 offset:512
    v_readlane_b32 s68, v8, 20
    buffer_load_dwordx4 v[196:199], v3, s[36:39], s69 offen sc1
    s_waitcnt vmcnt(7)
    s_waitcnt lgkmcnt(8)
    v_mfma_f32_32x32x16_bf16 v[52:67], v[36:39], v[168:171], v[52:67]
    ds_read_b64_tr_b16 v[28:29], v18 offset:4096
    ds_read_b64_tr_b16 v[30:31], v18 offset:4608
    v_mfma_f32_32x32x16_bf16 v[68:83], v[40:43], v[168:171], v[68:83]
    ds_read_b64_tr_b16 v[32:33], v19 offset:4096
    ds_read_b64_tr_b16 v[34:35], v19 offset:4608
    v_mov_b32_e64 v0, 23
    ds_write_b32 v9, v0 offset:16
    v_readlane_b32 s69, v8, 21
    buffer_load_dwordx4 v[200:203], v3, s[36:39], s70 offen sc1
    s_waitcnt vmcnt(7)
    s_waitcnt lgkmcnt(8)
    v_mfma_f32_32x32x16_bf16 v[52:67], v[44:47], v[172:175], v[52:67]
    ds_read_b64_tr_b16 v[36:37], v6 offset:0
    ds_read_b64_tr_b16 v[38:39], v6 offset:512
    v_mfma_f32_32x32x16_bf16 v[68:83], v[48:51], v[172:175], v[68:83]
    ds_read_b64_tr_b16 v[40:41], v7 offset:0
    ds_read_b64_tr_b16 v[42:43], v7 offset:512
    v_readlane_b32 s70, v8, 22
    buffer_load_dwordx4 v[204:207], v3, s[36:39], s71 offen sc1
    s_waitcnt vmcnt(7)
    s_waitcnt lgkmcnt(8)
    v_mfma_f32_32x32x16_bf16 v[52:67], v[20:23], v[176:179], v[52:67]
    ds_read_b64_tr_b16 v[44:45], v6 offset:4096
    ds_read_b64_tr_b16 v[46:47], v6 offset:4608
    v_mfma_f32_32x32x16_bf16 v[68:83], v[24:27], v[176:179], v[68:83]
    ds_read_b64_tr_b16 v[48:49], v7 offset:4096
    ds_read_b64_tr_b16 v[50:51], v7 offset:4608
    v_mov_b32_e64 v0, 24
    ds_write_b32 v9, v0 offset:16
    v_readlane_b32 s71, v8, 23
    buffer_load_dwordx4 v[208:211], v3, s[36:39], s68 offen sc1
    s_waitcnt vmcnt(7)
    s_waitcnt lgkmcnt(8)
    v_mfma_f32_32x32x16_bf16 v[52:67], v[28:31], v[180:183], v[52:67]
    s_cmp_ge_u32 s52, 9
    s_cbranch_scc0 fs_58
fb_57:
    ds_read_b64_tr_b16 v[20:21], v4 offset:8192
    ds_read_b64_tr_b16 v[22:23], v4 offset:8704
    v_mfma_f32_32x32x16_bf16 v[68:83], v[32:35], v[180:183], v[68:83]
    ds_read_b64_tr_b16 v[24:25], v5 offset:8192
    ds_read_b64_tr_b16 v[26:27], v5 offset:8704
    v_readlane_b32 s68, v8, 24
    buffer_load_dwordx4 v[212:215], v3, s[36:39], s69 offen sc1
    s_waitcnt vmcnt(7)
    s_waitcnt lgkmcnt(8)
    v_mfma_f32_32x32x16_bf16 v[52:67], v[36:39], v[184:187], v[52:67]
    ds_read_b64_tr_b16 v[28:29], v4 offset:12288
    ds_read_b64_tr_b16 v[30:31], v4 offset:12800
    v_mfma_f32_32x32x16_bf16 v[68:83], v[40:43], v[184:187], v[68:83]
    ds_read_b64_tr_b16 v[32:33], v5 offset:12288
    ds_read_b64_tr_b16 v[34:35], v5 offset:12800
    v_mov_b32_e64 v0, 25
    ds_write_b32 v9, v0 offset:16
    v_readlane_b32 s69, v8, 25
    buffer_load_dwordx4 v[216:219], v3, s[36:39], s70 offen sc1
    s_waitcnt vmcnt(7)
    s_waitcnt lgkmcnt(8)
    v_mfma_f32_32x32x16_bf16 v[52:67], v[44:47], v[188:191], v[52:67]
    s_cmp_ge_u32 s52, 10
    s_cbranch_scc0 fs_60
fb_59:
    ds_read_b64_tr_b16 v[36:37], v6 offset:40960
    ds_read_b64_tr_b16 v[38:39], v6 offset:41472
    v_mfma_f32_32x32x16_bf16 v[68:83], v[48:51], v[188:191], v[68:83]
    ds_read_b64_tr_b16 v[40:41], v7 offset:40960
    ds_read_b64_tr_b16 v[42:43], v7 offset:41472
    v_readlane_b32 s70, v8, 26
    buffer_load_dwordx4 v[220:223], v3, s[36:39], s71 offen sc1
    s_waitcnt vmcnt(7)
    s_waitcnt lgkmcnt(8)
    v_mfma_f32_32x32x16_bf16 v[52:67], v[20:23], v[192:195], v[52:67]
    ds_read_b64_tr_b16 v[44:45], v6 offset:45056
    ds_read_b64_tr_b16 v[46:47], v6 offset:45568
    v_mfma_f32_32x32x16_bf16 v[68:83], v[24:27], v[192:195], v[68:83]
    ds_read_b64_tr_b16 v[48:49], v7 offset:45056
    ds_read_b64_tr_b16 v[50:51], v7 offset:45568
    v_readlane_b32 s71, v8, 27
    buffer_load_dwordx4 v[224:227], v3, s[36:39], s68 offen sc1
    v_bfe_u32 v12, v1, 3, 2
    v_and_b32 v11, 7, v1
    v_lshlrev_b32 v11, 4, v11
    v_lshl_add_u32 v11, v12, 10, v11
    v_lshrrev_b32_e64 v12, 5, v1
    v_lshl_add_u32 v11, v12, 15, v11
    buffer_load_dwordx4 v[12:15], v11, s[8:11], s91 offen
    s_waitcnt vmcnt(8)
    s_waitcnt lgkmcnt(8)
    v_mfma_f32_32x32x16_bf16 v[52:67], v[28:31], v[196:199], v[52:67]
    s_cmp_ge_u32 s52, 11
    s_cbranch_scc0 fs_62
fb_61:
    ds_read_b64_tr_b16 v[20:21], v4 offset:0
    ds_read_b64_tr_b16 v[22:23], v4 offset:512
    v_mfma_f32_32x32x16_bf16 v[68:83], v[32:35], v[196:199], v[68:83]
    ds_read_b64_tr_b16 v[24:25], v5 offset:0
    ds_read_b64_tr_b16 v[26:27], v5 offset:512
    v_readlane_b32 s68, v8, 28
    buffer_load_dwordx4 v[228:231], v3, s[36:39], s69 offen sc1
    s_waitcnt vmcnt(8)
    s_waitcnt lgkmcnt(8)
    v_mfma_f32_32x32x16_bf16 v[52:67], v[36:39], v[200:203], v[52:67]
    ds_read_b64_tr_b16 v[28:29], v4 offset:4096
    ds_read_b64_tr_b16 v[30:31], v4 offset:4608
    v_mfma_f32_32x32x16_bf16 v[68:83], v[40:43], v[200:203], v[68:83]
    ds_read_b64_tr_b16 v[32:33], v5 offset:4096
    ds_read_b64_tr_b16 v[34:35], v5 offset:4608
    v_readlane_b32 s69, v8, 29
    buffer_load_dwordx4 v[232:235], v3, s[36:39], s70 offen sc1
    s_waitcnt vmcnt(8)
    s_waitcnt lgkmcnt(8)
    v_mfma_f32_32x32x16_bf16 v[52:67], v[44:47], v[204:207], v[52:67]
    s_cmp_ge_u32 s52, 12
    s_cbranch_scc0 fs_64
fb_63:
    ds_read_b64_tr_b16 v[36:37], v18 offset:8192
    ds_read_b64_tr_b16 v[38:39], v18 offset:8704
    v_mfma_f32_32x32x16_bf16 v[68:83], v[48:51], v[204:207], v[68:83]
    ds_read_b64_tr_b16 v[40:41], v19 offset:8192
    ds_read_b64_tr_b16 v[42:43], v19 offset:8704
    v_readlane_b32 s70, v8, 30
    buffer_load_dwordx4 v[236:239], v3, s[36:39], s71 offen sc1
    s_waitcnt vmcnt(8)
    s_waitcnt lgkmcnt(8)
    v_mfma_f32_32x32x16_bf16 v[52:67], v[20:23], v[208:211], v[52:67]
    ds_read_b64_tr_b16 v[44:45], v18 offset:12288
    ds_read_b64_tr_b16 v[46:47], v18 offset:12800
    v_mfma_f32_32x32x16_bf16 v[68:83], v[24:27], v[208:211], v[68:83]
    ds_read_b64_tr_b16 v[48:49], v19 offset:12288
    ds_read_b64_tr_b16 v[50:51], v19 offset:12800
    v_readlane_b32 s71, v8, 31
    buffer_load_dwordx4 v[240:243], v3, s[36:39], s68 offen sc1
    s_waitcnt vmcnt(8)
    s_waitcnt lgkmcnt(8)
    v_mfma_f32_32x32x16_bf16 v[52:67], v[28:31], v[212:215], v[52:67]
    s_cmp_ge_u32 s52, 13
    s_cbranch_scc0 fs_66
fb_65:
    ds_read_b64_tr_b16 v[20:21], v6 offset:32768
    ds_read_b64_tr_b16 v[22:23], v6 offset:33280
    v_mfma_f32_32x32x16_bf16 v[68:83], v[32:35], v[212:215], v[68:83]
    ds_read_b64_tr_b16 v[24:25], v7 offset:32768
    ds_read_b64_tr_b16 v[26:27], v7 offset:33280
    v_readlane_b32 s68, v8, 32
    buffer_load_dwordx4 v[244:247], v3, s[36:39], s69 offen sc1
    s_waitcnt vmcnt(8)
    s_waitcnt lgkmcnt(8)
    v_mfma_f32_32x32x16_bf16 v[52:67], v[36:39], v[216:219], v[52:67]
    ds_read_b64_tr_b16 v[28:29], v6 offset:36864
    ds_read_b64_tr_b16 v[30:31], v6 offset:37376
    v_mfma_f32_32x32x16_bf16 v[68:83], v[40:43], v[216:219], v[68:83]
    ds_read_b64_tr_b16 v[32:33], v7 offset:36864
    ds_read_b64_tr_b16 v[34:35], v7 offset:37376
    v_readlane_b32 s69, v8, 33
    buffer_load_dwordx4 v[248:251], v3, s[36:39], s70 offen sc1
    ds_read_b32 v2, v9 offset:176
    s_waitcnt vmcnt(8)
    s_waitcnt lgkmcnt(9)
    v_mfma_f32_32x32x16_bf16 v[52:67], v[44:47], v[220:223], v[52:67]
    s_cmp_ge_u32 s52, 14
    s_cbranch_scc0 fs_68
fb_67:
    ds_read_b64_tr_b16 v[36:37], v6 offset:24576
    ds_read_b64_tr_b16 v[38:39], v6 offset:25088
    v_mfma_f32_32x32x16_bf16 v[68:83], v[48:51], v[220:223], v[68:83]
    ds_read_b64_tr_b16 v[40:41], v7 offset:24576
    ds_read_b64_tr_b16 v[42:43], v7 offset:25088
    v_readlane_b32 s70, v8, 34
    buffer_load_dwordx4 v[252:255], v3, s[36:39], s71 offen sc1
    s_waitcnt vmcnt(8)
    s_waitcnt lgkmcnt(9)
    v_mfma_f32_32x32x16_bf16 v[52:67], v[20:23], v[224:227], v[52:67]
    ds_read_b64_tr_b16 v[44:45], v6 offset:28672
    ds_read_b64_tr_b16 v[46:47], v6 offset:29184
    v_mfma_f32_32x32x16_bf16 v[68:83], v[24:27], v[224:227], v[68:83]
    ds_read_b64_tr_b16 v[48:49], v7 offset:28672
    ds_read_b64_tr_b16 v[50:51], v7 offset:29184
    s_waitcnt lgkmcnt(8)
    v_readfirstlane_b32 s40, v2
    s_nop 0
    s_max_u32 s53, s53, s40
    s_bitcmp1_b32 s53, 21
    s_cbranch_scc1 hpd_70
    s_mov_b32 s41, 2097152
hp_69:
    ds_read_b32 v2, v9 offset:176
    s_waitcnt lgkmcnt(0)
    v_readfirstlane_b32 s40, v2
    s_nop 0
    s_max_u32 s53, s53, s40
    s_bitcmp1_b32 s53, 21
    s_cbranch_scc1 hpd_70
    s_sub_u32 s41, s41, 1
    s_cbranch_scc0 hp_69
hpd_70:
    v_readlane_b32 s71, v8, 35
    buffer_load_dwordx4 v[84:87], v3, s[36:39], s68 offen sc1
    s_waitcnt vmcnt(7)
    v_mfma_f32_32x32x16_bf16 v[52:67], v[28:31], v[228:231], v[52:67]
    s_cmp_ge_u32 s52, 15
    s_cbranch_scc0 fs_72
fb_71:
    s_nop 0
    ds_read_b64_tr_b16 v[20:21], v6 offset:8192
    ds_read_b64_tr_b16 v[22:23], v6 offset:8704
    v_mfma_f32_32x32x16_bf16 v[68:83], v[32:35], v[228:231], v[68:83]
    ds_read_b64_tr_b16 v[24:25], v7 offset:8192
    ds_read_b64_tr_b16 v[26:27], v7 offset:8704
    v_readlane_b32 s68, v8, 36
    buffer_load_dwordx4 v[88:91], v3, s[36:39], s69 offen sc1
    s_waitcnt vmcnt(7)
    s_waitcnt lgkmcnt(8)
    v_mfma_f32_32x32x16_bf16 v[52:67], v[36:39], v[232:235], v[52:67]
    ds_read_b64_tr_b16 v[28:29], v6 offset:12288
    ds_read_b64_tr_b16 v[30:31], v6 offset:12800
    v_mfma_f32_32x32x16_bf16 v[68:83], v[40:43], v[232:235], v[68:83]
    ds_read_b64_tr_b16 v[32:33], v7 offset:12288
    ds_read_b64_tr_b16 v[34:35], v7 offset:12800
    v_readlane_b32 s69, v8, 37
    buffer_load_dwordx4 v[92:95], v3, s[36:39], s70 offen sc1
    s_waitcnt vmcnt(7)
    s_waitcnt lgkmcnt(8)
    v_mfma_f32_32x32x16_bf16 v[52:67], v[44:47], v[236:239], v[52:67]
    s_cmp_ge_u32 s52, 16
    s_cbranch_scc0 fs_74
fb_73:
    ds_read_b64_tr_b16 v[36:37], v4 offset:32768
    ds_read_b64_tr_b16 v[38:39], v4 offset:33280
    v_mfma_f32_32x32x16_bf16 v[68:83], v[48:51], v[236:239], v[68:83]
    ds_read_b64_tr_b16 v[40:41], v5 offset:32768
    ds_read_b64_tr_b16 v[42:43], v5 offset:33280
    v_readlane_b32 s70, v8, 38
    buffer_load_dwordx4 v[96:99], v3, s[36:39], s71 offen sc1
    s_waitcnt vmcnt(7)
    s_waitcnt lgkmcnt(8)
    v_mfma_f32_32x32x16_bf16 v[52:67], v[20:23], v[240:243], v[52:67]
    ds_read_b64_tr_b16 v[44:45], v4 offset:36864
    ds_read_b64_tr_b16 v[46:47], v4 offset:37376
    v_mfma_f32_32x32x16_bf16 v[68:83], v[24:27], v[240:243], v[68:83]
    ds_read_b64_tr_b16 v[48:49], v5 offset:36864
    ds_read_b64_tr_b16 v[50:51], v5 offset:37376
    v_readlane_b32 s71, v8, 39
    buffer_load_dwordx4 v[100:103], v3, s[36:39], s68 offen sc1
    s_waitcnt vmcnt(7)
    s_waitcnt lgkmcnt(8)
    v_mfma_f32_32x32x16_bf16 v[52:67], v[28:31], v[244:247], v[52:67]
    s_cmp_ge_u32 s52, 17
    s_cbranch_scc0 fs_76
fb_75:
    ds_read_b64_tr_b16 v[20:21], v4 offset:49152
    ds_read_b64_tr_b16 v[22:23], v4 offset:49664
    v_mfma_f32_32x32x16_bf16 v[68:83], v[32:35], v[244:247], v[68:83]
    ds_read_b64_tr_b16 v[24:25], v5 offset:49152
    ds_read_b64_tr_b16 v[26:27], v5 offset:49664
    v_readlane_b32 s68, v8, 40
    buffer_load_dwordx4 v[104:107], v3, s[36:39], s69 offen sc1
    s_waitcnt vmcnt(7)
    s_waitcnt lgkmcnt(8)
    v_mfma_f32_32x32x16_bf16 v[52:67], v[36:39], v[248:251], v[52:67]
    ds_read_b64_tr_b16 v[28:29], v4 offset:53248
    ds_read_b64_tr_b16 v[30:31], v4 offset:53760
    v_mfma_f32_32x32x16_bf16 v[68:83], v[40:43], v[248:251], v[68:83]
    ds_read_b64_tr_b16 v[32:33], v5 offset:53248
    ds_read_b64_tr_b16 v[34:35], v5 offset:53760
    v_readlane_b32 s69, v8, 41
    buffer_load_dwordx4 v[108:111], v3, s[36:39], s70 offen sc1
    s_waitcnt vmcnt(7)
    s_waitcnt lgkmcnt(8)
    v_mfma_f32_32x32x16_bf16 v[52:67], v[44:47], v[252:255], v[52:67]
    s_cmp_ge_u32 s52, 18
    s_cbranch_scc0 fs_78
fb_77:
    ds_read_b64_tr_b16 v[36:37], v4 offset:40960
    ds_read_b64_tr_b16 v[38:39], v4 offset:41472
    v_mfma_f32_32x32x16_bf16 v[68:83], v[48:51], v[252:255], v[68:83]
    ds_read_b64_tr_b16 v[40:41], v5 offset:40960
    ds_read_b64_tr_b16 v[42:43], v5 offset:41472
    v_readlane_b32 s70, v8, 42
    buffer_load_dwordx4 v[112:115], v3, s[36:39], s71 offen sc1
    s_waitcnt vmcnt(7)
    s_waitcnt lgkmcnt(8)
    v_mfma_f32_32x32x16_bf16 v[52:67], v[20:23], v[84:87], v[52:67]
    ds_read_b64_tr_b16 v[44:45], v4 offset:45056
    ds_read_b64_tr_b16 v[46:47], v4 offset:45568
    s_mov_b32 s42, 122880
    s_cmp_eq_u32 s3, 1
    s_cmov_b32 s42, 131072
    v_mfma_f32_32x32x16_bf16 v[68:83], v[24:27], v[84:87], v[68:83]
    ds_read_b64_tr_b16 v[48:49], v5 offset:45056
    ds_read_b64_tr_b16 v[50:51], v5 offset:45568
    s_cmp_eq_u32 s3, 2
    s_cmov_b32 s42, 65536
    s_cmp_eq_u32 s3, 3
    s_cmov_b32 s42, 8192
    buffer_load_dwordx4 v[116:119], v3, s[36:39], s68 offen sc1
    s_waitcnt vmcnt(7)
    s_waitcnt lgkmcnt(8)
    v_mfma_f32_32x32x16_bf16 v[52:67], v[28:31], v[88:91], v[52:67]
    s_cmp_ge_u32 s52, 19
    s_cbranch_scc0 fs_80
fb_79:
    ds_read_b64_tr_b16 v[20:21], v4 offset:16384
    ds_read_b64_tr_b16 v[22:23], v4 offset:16896
    v_and_b32 v136, 31, v1
    v_lshrrev_b32 v137, 5, v1
    v_and_b32 v138, 7, v1
    v_mfma_f32_32x32x16_bf16 v[68:83], v[32:35], v[88:91], v[68:83]
    ds_read_b64_tr_b16 v[24:25], v5 offset:16384
    ds_read_b64_tr_b16 v[26:27], v5 offset:16896
    v_xor_b32 v137, v137, v138
    v_lshlrev_b32 v137, 4, v137
    v_lshl_add_u32 v136, v136, 8, v137
    buffer_load_dwordx4 v[120:123], v3, s[36:39], s69 offen sc1
    s_waitcnt vmcnt(7)
    s_waitcnt lgkmcnt(8)
    v_mfma_f32_32x32x16_bf16 v[52:67], v[36:39], v[92:95], v[52:67]
    ds_read_b64_tr_b16 v[28:29], v4 offset:20480
    ds_read_b64_tr_b16 v[30:31], v4 offset:20992
    v_add_u32 v136, s42, v136
    v_xor_b32 v137, 32, v136
    v_xor_b32_e64 v138, 64, v136
    v_mfma_f32_32x32x16_bf16 v[68:83], v[40:43], v[92:95], v[68:83]
    ds_read_b64_tr_b16 v[32:33], v5 offset:20480
    ds_read_b64_tr_b16 v[34:35], v5 offset:20992
    v_xor_b32 v139, 96, v136
    v_mov_b32 v140, 155648
    s_and_b32 s44, s3, 3
    buffer_load_dwordx4 v[124:127], v3, s[36:39], s70 offen sc1
    s_waitcnt vmcnt(7)
    s_waitcnt lgkmcnt(8)
    v_mfma_f32_32x32x16_bf16 v[52:67], v[44:47], v[96:99], v[52:67]
    s_cmp_ge_u32 s52, 20
    s_cbranch_scc0 fs_82
fb_81:
    ds_read_b64_tr_b16 v[36:37], v6 offset:16384
    ds_read_b64_tr_b16 v[38:39], v6 offset:16896
    s_lshl_b32 s44, s44, 11
    s_lshr_b32 s45, s3, 2
    s_mov_b32 s42, 122880
    v_mfma_f32_32x32x16_bf16 v[68:83], v[48:51], v[96:99], v[68:83]
    ds_read_b64_tr_b16 v[40:41], v7 offset:16384
    ds_read_b64_tr_b16 v[42:43], v7 offset:16896
    s_cmp_eq_u32 s45, 1
    s_cmov_b32 s42, 131072
    s_mov_b32 s43, 65536
    s_waitcnt vmcnt(6)
    s_waitcnt lgkmcnt(8)
    v_mfma_f32_32x32x16_bf16 v[52:67], v[20:23], v[100:103], v[52:67]
    ds_read_b64_tr_b16 v[44:45], v6 offset:20480
    ds_read_b64_tr_b16 v[46:47], v6 offset:20992
    s_cmp_eq_u32 s45, 1
    s_cmov_b32 s43, 8192
    v_lshrrev_b32 v128, 3, v1
    v_mfma_f32_32x32x16_bf16 v[68:83], v[24:27], v[100:103], v[68:83]
    ds_read_b64_tr_b16 v[48:49], v7 offset:20480
    ds_read_b64_tr_b16 v[50:51], v7 offset:20992
    v_and_b32 v129, 7, v1
    v_lshlrev_b32 v129, 1, v129
    v_xor_b32 v129, v129, v128
    s_waitcnt vmcnt(5)
    s_waitcnt lgkmcnt(8)
    v_mfma_f32_32x32x16_bf16 v[52:67], v[28:31], v[104:107], v[52:67]
    s_cmp_ge_u32 s52, 21
    s_cbranch_scc0 fs_84
fb_83:
    ds_read_b64_tr_b16 v[20:21], v6 offset:49152
    ds_read_b64_tr_b16 v[22:23], v6 offset:49664
    v_lshlrev_b32 v129, 4, v129
    v_lshl_add_u32 v128, v128, 8, v129
    v_add_u32_e64 v128, s44, v128
    v_mfma_f32_32x32x16_bf16 v[68:83], v[32:35], v[104:107], v[68:83]
    ds_read_b64_tr_b16 v[24:25], v7 offset:49152
    ds_read_b64_tr_b16 v[26:27], v7 offset:49664
    v_xor_b32 v129, 16, v128
    v_add_u32 v132, s42, v128
    v_add_u32 v133, s42, v129
    s_waitcnt vmcnt(4)
    s_waitcnt lgkmcnt(8)
    v_mfma_f32_32x32x16_bf16 v[52:67], v[36:39], v[108:111], v[52:67]
    ds_read_b64_tr_b16 v[28:29], v6 offset:53248
    ds_read_b64_tr_b16 v[30:31], v6 offset:53760
    v_add_u32 v134, s43, v128
    v_add_u32 v135, s43, v129
    s_lshl_b32 s44, s3, 10
    v_mfma_f32_32x32x16_bf16 v[68:83], v[40:43], v[108:111], v[68:83]
    ds_read_b64_tr_b16 v[32:33], v7 offset:53248
    ds_read_b64_tr_b16 v[34:35], v7 offset:53760
    s_add_u32 s44, s44, 57344
    v_lshl_add_u32 v128, v1, 4, s44
    v_lshlrev_b32 v144, 16, v12
    s_waitcnt vmcnt(3)
    s_waitcnt lgkmcnt(8)
    v_mfma_f32_32x32x16_bf16 v[52:67], v[44:47], v[112:115], v[52:67]
    s_cmp_ge_u32 s52, 22
    s_cbranch_scc0 fs_86
fb_85:
    ds_read_b64_tr_b16 v[36:37], v4 offset:24576
    ds_read_b64_tr_b16 v[38:39], v4 offset:25088
    v_and_b32 v145, 0xffff0000, v12
    v_lshlrev_b32 v146, 16, v13
    v_and_b32 v147, 0xffff0000, v13
    v_mfma_f32_32x32x16_bf16 v[68:83], v[48:51], v[112:115], v[68:83]
    ds_read_b64_tr_b16 v[40:41], v5 offset:24576
    ds_read_b64_tr_b16 v[42:43], v5 offset:25088
    v_lshlrev_b32 v148, 16, v14
    v_and_b32 v149, 0xffff0000, v14
    v_lshlrev_b32 v150, 16, v15
    s_waitcnt vmcnt(2)
    s_waitcnt lgkmcnt(8)
    v_mfma_f32_32x32x16_bf16 v[52:67], v[20:23], v[116:119], v[52:67]
    v_and_b32 v151, 0xffff0000, v15
    v_mfma_f32_32x32x16_bf16 v[68:83], v[24:27], v[116:119], v[68:83]
    s_waitcnt vmcnt(1)
    s_waitcnt lgkmcnt(4)
    v_mfma_f32_32x32x16_bf16 v[52:67], v[28:31], v[120:123], v[52:67]
    v_mfma_f32_32x32x16_bf16 v[68:83], v[32:35], v[120:123], v[68:83]
    ds_read_b128 v[4:7], v140 offset:16
    s_waitcnt vmcnt(0)
    s_waitcnt lgkmcnt(1)
    v_mfma_f32_32x32x16_bf16 v[52:67], v[36:39], v[124:127], v[52:67]
    v_mfma_f32_32x32x16_bf16 v[68:83], v[40:43], v[124:127], v[68:83]
    s_waitcnt lgkmcnt(0)
    v_min_u32 v4, v4, v5
    v_min3_u32 v4, v4, v6, v7
    s_nop 0
    v_readfirstlane_b32 s52, v4
    s_nop 0
    s_cmp_ge_u32 s52, 25
    s_cbranch_scc0 fs_88
fb_87:
    s_nop 2
    ds_write_b128 v136, v[52:55] offset:0
    ds_write_b128 v137, v[56:59] offset:0
    ds_write_b128 v138, v[60:63] offset:0
    ds_write_b128 v139, v[64:67] offset:0
    ds_write_b128 v136, v[68:71] offset:128
    ds_write_b128 v137, v[72:75] offset:128
    ds_write_b128 v138, v[76:79] offset:128
    ds_write_b128 v139, v[80:83] offset:128
    s_branch k_fin2
fs_52:
    s_mov_b32 s41, 2097152
lw_89:
    ds_read_b32 v16, v9 offset:64
    s_waitcnt lgkmcnt(0)
    v_readfirstlane_b32 s52, v16
    s_nop 0
    s_cmp_ge_u32 s52, 8
    s_cbranch_scc1 lwd_90
    s_sleep 1
    s_sub_u32 s41, s41, 1
    s_cbranch_scc0 lw_89
lwd_90:
    s_branch fb_51
fs_58:
    s_mov_b32 s41, 2097152
lw_91:
    ds_read_b32 v16, v9 offset:64
    s_waitcnt lgkmcnt(0)
    v_readfirstlane_b32 s52, v16
    s_nop 0
    s_cmp_ge_u32 s52, 9
    s_cbranch_scc1 lwd_92
    s_sleep 1
    s_sub_u32 s41, s41, 1
    s_cbranch_scc0 lw_91
lwd_92:
    s_branch fb_57
fs_60:
    s_mov_b32 s41, 2097152
lw_93:
    ds_read_b32 v16, v9 offset:64
    s_waitcnt lgkmcnt(0)
    v_readfirstlane_b32 s52, v16
    s_nop 0
    s_cmp_ge_u32 s52, 10
    s_cbranch_scc1 lwd_94
    s_sleep 1
    s_sub_u32 s41, s41, 1
    s_cbranch_scc0 lw_93
lwd_94:
    s_branch fb_59
fs_62:
    s_mov_b32 s41, 2097152
lw_95:
    ds_read_b32 v16, v9 offset:64
    s_waitcnt lgkmcnt(0)
    v_readfirstlane_b32 s52, v16
    s_nop 0
    s_cmp_ge_u32 s52, 11
    s_cbranch_scc1 lwd_96
    s_sleep 1
    s_sub_u32 s41, s41, 1
    s_cbranch_scc0 lw_95
lwd_96:
    s_branch fb_61
fs_64:
    s_mov_b32 s41, 2097152
lw_97:
    ds_read_b32 v16, v9 offset:64
    s_waitcnt lgkmcnt(0)
    v_readfirstlane_b32 s52, v16
    s_nop 0
    s_cmp_ge_u32 s52, 12
    s_cbranch_scc1 lwd_98
    s_sleep 1
    s_sub_u32 s41, s41, 1
    s_cbranch_scc0 lw_97
lwd_98:
    s_branch fb_63
fs_66:
    s_mov_b32 s41, 2097152
lw_99:
    ds_read_b32 v16, v9 offset:64
    s_waitcnt lgkmcnt(0)
    v_readfirstlane_b32 s52, v16
    s_nop 0
    s_cmp_ge_u32 s52, 13
    s_cbranch_scc1 lwd_100
    s_sleep 1
    s_sub_u32 s41, s41, 1
    s_cbranch_scc0 lw_99
lwd_100:
    s_branch fb_65
fs_68:
    s_mov_b32 s41, 2097152
lw_101:
    ds_read_b32 v16, v9 offset:64
    s_waitcnt lgkmcnt(0)
    v_readfirstlane_b32 s52, v16
    s_nop 0
    s_cmp_ge_u32 s52, 14
    s_cbranch_scc1 lwd_102
    s_sleep 1
    s_sub_u32 s41, s41, 1
    s_cbranch_scc0 lw_101
lwd_102:
    s_branch fb_67
fs_72:
    s_mov_b32 s41, 2097152
lw_103:
    ds_read_b32 v16, v9 offset:64
    s_waitcnt lgkmcnt(0)
    v_readfirstlane_b32 s52, v16
    s_nop 0
    s_cmp_ge_u32 s52, 15
    s_cbranch_scc1 lwd_104
    s_sleep 1
    s_sub_u32 s41, s41, 1
    s_cbranch_scc0 lw_103
lwd_104:
    s_branch fb_71
fs_74:
    s_mov_b32 s41, 2097152
lw_105:
    ds_read_b32 v16, v9 offset:64
    s_waitcnt lgkmcnt(0)
    v_readfirstlane_b32 s52, v16
    s_nop 0
    s_cmp_ge_u32 s52, 16
    s_cbranch_scc1 lwd_106
    s_sleep 1
    s_sub_u32 s41, s41, 1
    s_cbranch_scc0 lw_105
lwd_106:
    s_branch fb_73
fs_76:
    s_mov_b32 s41, 2097152
lw_107:
    ds_read_b32 v16, v9 offset:64
    s_waitcnt lgkmcnt(0)
    v_readfirstlane_b32 s52, v16
    s_nop 0
    s_cmp_ge_u32 s52, 17
    s_cbranch_scc1 lwd_108
    s_sleep 1
    s_sub_u32 s41, s41, 1
    s_cbranch_scc0 lw_107
lwd_108:
    s_branch fb_75
fs_78:
    s_mov_b32 s41, 2097152
lw_109:
    ds_read_b32 v16, v9 offset:64
    s_waitcnt lgkmcnt(0)
    v_readfirstlane_b32 s52, v16
    s_nop 0
    s_cmp_ge_u32 s52, 18
    s_cbranch_scc1 lwd_110
    s_sleep 1
    s_sub_u32 s41, s41, 1
    s_cbranch_scc0 lw_109
lwd_110:
    s_branch fb_77
fs_80:
    s_mov_b32 s41, 2097152
lw_111:
    ds_read_b32 v16, v9 offset:64
    s_waitcnt lgkmcnt(0)
    v_readfirstlane_b32 s52, v16
    s_nop 0
    s_cmp_ge_u32 s52, 19
    s_cbranch_scc1 lwd_112
    s_sleep 1
    s_sub_u32 s41, s41, 1
    s_cbranch_scc0 lw_111
lwd_112:
    s_branch fb_79
fs_82:
    s_mov_b32 s41, 2097152
lw_113:
    ds_read_b32 v16, v9 offset:64
    s_waitcnt lgkmcnt(0)
    v_readfirstlane_b32 s52, v16
    s_nop 0
    s_cmp_ge_u32 s52, 20
    s_cbranch_scc1 lwd_114
    s_sleep 1
    s_sub_u32 s41, s41, 1
    s_cbranch_scc0 lw_113
lwd_114:
    s_branch fb_81
fs_84:
    s_mov_b32 s41, 2097152
lw_115:
    ds_read_b32 v16, v9 offset:64
    s_waitcnt lgkmcnt(0)
    v_readfirstlane_b32 s52, v16
    s_nop 0
    s_cmp_ge_u32 s52, 21
    s_cbranch_scc1 lwd_116
    s_sleep 1
    s_sub_u32 s41, s41, 1
    s_cbranch_scc0 lw_115
lwd_116:
    s_branch fb_83
fs_86:
    s_mov_b32 s41, 2097152
lw_117:
    ds_read_b32 v16, v9 offset:64
    s_waitcnt lgkmcnt(0)
    v_readfirstlane_b32 s52, v16
    s_nop 0
    s_cmp_ge_u32 s52, 22
    s_cbranch_scc1 lwd_118
    s_sleep 1
    s_sub_u32 s41, s41, 1
    s_cbranch_scc0 lw_117
lwd_118:
    s_branch fb_85
fs_88:
    s_mov_b32 s41, 2097152
lw_119:
    ds_read_b128 v[4:7], v140 offset:16
    s_waitcnt lgkmcnt(0)
    v_min_u32 v4, v4, v5
    v_min3_u32 v4, v4, v6, v7
    s_nop 0
    v_readfirstlane_b32 s52, v4
    s_nop 0
    s_cmp_ge_u32 s52, 25
    s_cbranch_scc1 lwd_120
    s_sleep 1
    s_sub_u32 s41, s41, 1
    s_cbranch_scc0 lw_119
lwd_120:
    s_branch fb_87
k_h12:
    s_setprio 3
    v_bfe_u32 v245, v1, 2, 1
    v_lshlrev_b32_e64 v240, 4, v245
    v_bfe_u32 v245, v1, 3, 2
    v_lshl_add_u32 v240, v245, 2, v240
    v_and_b32 v245, 3, v1
    v_add_u32 v240, v240, v245
    v_lshl_add_u32 v242, v240, 1, s6
    v_cvt_f32_u32 v242, v242
    v_cvt_f32_u32 v240, v240
    v_lshrrev_b32 v241, 5, v1
    v_cvt_f32_u32 v241, v241
    v_mul_f32 v244, 0x3c800000, v242
    v_mul_f32 v243, 4.0, v241
    v_mul_f32 v243, v243, v244
    v_mul_f32 v245, 0x40a00000, v244
    v_cos_f32 v246, v243
    v_sin_f32 v248, v243
    v_add_f32 v243, v243, v244
    v_cos_f32 v247, v243
    v_sin_f32_e64 v249, v243
    v_cvt_pk_bf16_f32 v128, v246, v248
    v_cvt_pk_bf16_f32 v132, -v248, v246
    v_add_f32 v243, v243, v244
    v_cos_f32 v246, v243
    v_sin_f32_e64 v248, v243
    v_cvt_pk_bf16_f32 v129, v247, v249
    v_cvt_pk_bf16_f32 v133, -v249, v247
    v_add_f32 v243, v243, v244
    v_cos_f32 v247, v243
    v_sin_f32_e64 v249, v243
    v_cvt_pk_bf16_f32 v130, v246, v248
    v_cvt_pk_bf16_f32 v134, -v248, v246
    v_add_f32 v243, v243, v245
    v_cos_f32 v246, v243
    v_sin_f32_e64 v248, v243
    v_cvt_pk_bf16_f32 v131, v247, v249
    v_cvt_pk_bf16_f32 v135, -v249, v247
    v_add_f32 v243, v243, v244
    v_cos_f32 v247, v243
    v_sin_f32_e64 v249, v243
    v_cvt_pk_bf16_f32 v136, v246, v248
    v_cvt_pk_bf16_f32 v140, -v248, v246
    v_add_f32 v243, v243, v244
    v_cos_f32 v246, v243
    v_sin_f32_e64 v248, v243
    v_cvt_pk_bf16_f32 v137, v247, v249
    v_cvt_pk_bf16_f32 v141, -v249, v247
    v_add_f32 v243, v243, v244
    v_cos_f32 v247, v243
    v_sin_f32_e64 v249, v243
    v_cvt_pk_bf16_f32 v138, v246, v248
    v_cvt_pk_bf16_f32 v142, -v248, v246
    v_add_f32 v243, v243, v245
    v_cos_f32 v246, v243
    v_sin_f32_e64 v248, v243
    v_cvt_pk_bf16_f32 v139, v247, v249
    v_cvt_pk_bf16_f32 v143, -v249, v247
    v_add_f32 v243, v243, v244
    v_cos_f32 v247, v243
    v_sin_f32_e64 v249, v243
    v_cvt_pk_bf16_f32 v144, v246, v248
    v_cvt_pk_bf16_f32 v148, -v248, v246
    v_add_f32 v243, v243, v244
    v_cos_f32 v246, v243
    v_sin_f32_e64 v248, v243
    v_cvt_pk_bf16_f32 v145, v247, v249
    v_cvt_pk_bf16_f32 v149, -v249, v247
    v_add_f32 v243, v243, v244
    v_cos_f32 v247, v243
    v_sin_f32_e64 v249, v243
    v_cvt_pk_bf16_f32 v146, v246, v248
    v_cvt_pk_bf16_f32 v150, -v248, v246
    v_add_f32 v243, v243, v245
    v_cos_f32 v246, v243
    v_sin_f32_e64 v248, v243
    v_cvt_pk_bf16_f32 v147, v247, v249
    v_cvt_pk_bf16_f32 v151, -v249, v247
    v_add_f32 v243, v243, v244
    v_cos_f32 v247, v243
    v_sin_f32_e64 v249, v243
    v_cvt_pk_bf16_f32 v152, v246, v248
    v_cvt_pk_bf16_f32 v156, -v248, v246
    v_add_f32 v243, v243, v244
    v_cos_f32 v246, v243
    v_sin_f32_e64 v248, v243
    v_cvt_pk_bf16_f32 v153, v247, v249
    v_cvt_pk_bf16_f32 v157, -v249, v247
    v_add_f32 v243, v243, v244
    v_cos_f32 v247, v243
    v_sin_f32_e64 v249, v243
    v_cvt_pk_bf16_f32 v154, v246, v248
    v_cvt_pk_bf16_f32 v158, -v248, v246
    v_cvt_pk_bf16_f32 v155, v247, v249
    v_cvt_pk_bf16_f32 v159, -v249, v247
    v_mul_f32 v241, 0x41800000, v241
    v_mul_f32 v244, 0x3d000000, v240
    v_mul_f32 v243, v241, v244
    v_sin_f32 v248, v243
    v_cos_f32 v246, v243
    v_add_f32 v243, v243, v244
    v_sin_f32 v249, v243
    v_cos_f32 v247, v243
    v_cvt_pk_bf16_f32 v168, v248, v249
    v_cvt_pk_bf16_f32 v160, v246, v247
    v_xor_b32 v176, 0x80008000, v168
    v_add_f32 v243, v243, v244
    v_sin_f32 v248, v243
    v_cos_f32 v246, v243
    v_add_f32 v243, v243, v244
    v_sin_f32 v249, v243
    v_cos_f32 v247, v243
    v_cvt_pk_bf16_f32 v169, v248, v249
    v_cvt_pk_bf16_f32 v161, v246, v247
    v_xor_b32 v177, 0x80008000, v169
    v_add_f32 v243, v243, v244
    v_sin_f32 v248, v243
    v_cos_f32 v246, v243
    v_add_f32 v243, v243, v244
    v_sin_f32 v249, v243
    v_cos_f32 v247, v243
    v_cvt_pk_bf16_f32 v170, v248, v249
    v_cvt_pk_bf16_f32 v162, v246, v247
    v_xor_b32 v178, 0x80008000, v170
    v_add_f32 v243, v243, v244
    v_sin_f32 v248, v243
    v_cos_f32 v246, v243
    v_add_f32 v243, v243, v244
    v_sin_f32 v249, v243
    v_cos_f32 v247, v243
    v_cvt_pk_bf16_f32 v171, v248, v249
    v_cvt_pk_bf16_f32 v163, v246, v247
    v_xor_b32 v179, 0x80008000, v171
    v_add_f32 v243, v243, v244
    v_sin_f32 v248, v243
    v_cos_f32 v246, v243
    v_add_f32 v243, v243, v244
    v_sin_f32 v249, v243
    v_cos_f32 v247, v243
    v_cvt_pk_bf16_f32 v172, v248, v249
    v_cvt_pk_bf16_f32 v164, v246, v247
    v_xor_b32 v180, 0x80008000, v172
    v_add_f32 v243, v243, v244
    v_sin_f32 v248, v243
    v_cos_f32 v246, v243
    v_add_f32 v243, v243, v244
    v_sin_f32 v249, v243
    v_cos_f32 v247, v243
    v_cvt_pk_bf16_f32 v173, v248, v249
    v_cvt_pk_bf16_f32 v165, v246, v247
    v_xor_b32 v181, 0x80008000, v173
    v_add_f32 v243, v243, v244
    v_sin_f32 v248, v243
    v_cos_f32 v246, v243
    v_add_f32 v243, v243, v244
    v_sin_f32 v249, v243
    v_cos_f32 v247, v243
    v_cvt_pk_bf16_f32 v174, v248, v249
    v_cvt_pk_bf16_f32 v166, v246, v247
    v_xor_b32 v182, 0x80008000, v174
    v_add_f32 v243, v243, v244
    v_sin_f32 v248, v243
    v_cos_f32 v246, v243
    v_add_f32 v243, v243, v244
    v_sin_f32 v249, v243
    v_cos_f32 v247, v243
    v_cvt_pk_bf16_f32 v175, v248, v249
    v_cvt_pk_bf16_f32 v167, v246, v247
    v_xor_b32 v183, 0x80008000, v175
    v_cvt_f32_u32 v245, s6
    v_fma_f32 v241, 0.5, v245, v241
    v_and_b32 v245, 31, v1
    v_cvt_f32_u32 v245, v245
    v_mul_f32 v244, 0x3d000000, v245
    v_mul_f32 v243, v241, v244
    v_sin_f32 v248, v243
    v_cos_f32 v246, v243
    v_add_f32 v243, v243, v244
    v_sin_f32 v249, v243
    v_cos_f32_e64 v247, v243
    v_cvt_pk_bf16_f32 v192, v248, v249
    v_cvt_pk_bf16_f32 v184, v246, v247
    v_xor_b32 v200, 0x80008000, v192
    v_add_f32 v243, v243, v244
    v_sin_f32 v248, v243
    v_cos_f32 v246, v243
    v_add_f32 v243, v243, v244
    v_sin_f32 v249, v243
    v_cos_f32 v247, v243
    v_cvt_pk_bf16_f32 v193, v248, v249
    v_cvt_pk_bf16_f32 v185, v246, v247
    v_xor_b32 v201, 0x80008000, v193
    v_add_f32 v243, v243, v244
    v_sin_f32 v248, v243
    v_cos_f32 v246, v243
    v_add_f32 v243, v243, v244
    v_sin_f32 v249, v243
    v_cos_f32 v247, v243
    v_cvt_pk_bf16_f32 v194, v248, v249
    v_cvt_pk_bf16_f32 v186, v246, v247
    v_xor_b32 v202, 0x80008000, v194
    v_add_f32 v243, v243, v244
    v_sin_f32 v248, v243
    v_cos_f32 v246, v243
    v_add_f32 v243, v243, v244
    v_sin_f32 v249, v243
    v_cos_f32 v247, v243
    v_cvt_pk_bf16_f32 v195, v248, v249
    v_cvt_pk_bf16_f32 v187, v246, v247
    v_xor_b32 v203, 0x80008000, v195
    v_add_f32 v243, v243, v244
    v_sin_f32 v248, v243
    v_cos_f32 v246, v243
    v_add_f32 v243, v243, v244
    v_sin_f32 v249, v243
    v_cos_f32 v247, v243
    v_cvt_pk_bf16_f32 v196, v248, v249
    v_cvt_pk_bf16_f32 v188, v246, v247
    v_xor_b32 v204, 0x80008000, v196
    v_add_f32 v243, v243, v244
    v_sin_f32 v248, v243
    v_cos_f32 v246, v243
    v_add_f32 v243, v243, v244
    v_sin_f32 v249, v243
    v_cos_f32 v247, v243
    v_cvt_pk_bf16_f32 v197, v248, v249
    v_cvt_pk_bf16_f32 v189, v246, v247
    v_xor_b32 v205, 0x80008000, v197
    v_add_f32 v243, v243, v244
    v_sin_f32 v248, v243
    v_cos_f32 v246, v243
    v_add_f32 v243, v243, v244
    v_sin_f32 v249, v243
    v_cos_f32 v247, v243
    v_cvt_pk_bf16_f32 v198, v248, v249
    v_cvt_pk_bf16_f32 v190, v246, v247
    v_xor_b32 v206, 0x80008000, v198
    v_add_f32 v243, v243, v244
    v_sin_f32 v248, v243
    v_cos_f32 v246, v243
    v_add_f32 v243, v243, v244
    v_sin_f32 v249, v243
    v_cos_f32 v247, v243
    v_cvt_pk_bf16_f32 v199, v248, v249
    v_cvt_pk_bf16_f32 v191, v246, v247
    v_xor_b32 v207, 0x80008000, v199
    v_mul_f32 v244, 0x3a800000, v240
    v_mul_f32 v243, v241, v244
    v_cos_f32 v48, v243
    v_sin_f32 v64, v243
    v_add_f32 v243, v243, v244
    v_cos_f32 v49, v243
    v_sin_f32 v65, v243
    v_add_f32 v243, v243, v244
    v_cos_f32 v50, v243
    v_sin_f32 v66, v243
    v_add_f32 v243, v243, v244
    v_cos_f32 v51, v243
    v_sin_f32 v67, v243
    v_add_f32 v243, v243, v244
    v_cos_f32 v52, v243
    v_sin_f32 v68, v243
    v_add_f32 v243, v243, v244
    v_cos_f32 v53, v243
    v_sin_f32 v69, v243
    v_add_f32 v243, v243, v244
    v_cos_f32 v54, v243
    v_sin_f32 v70, v243
    v_add_f32 v243, v243, v244
    v_cos_f32 v55, v243
    v_sin_f32 v71, v243
    v_add_f32 v243, v243, v244
    v_cos_f32 v56, v243
    v_sin_f32 v72, v243
    v_add_f32 v243, v243, v244
    v_cos_f32 v57, v243
    v_sin_f32 v73, v243
    v_add_f32 v243, v243, v244
    v_cos_f32 v58, v243
    v_sin_f32 v74, v243
    v_add_f32 v243, v243, v244
    v_cos_f32 v59, v243
    v_sin_f32 v75, v243
    v_add_f32 v243, v243, v244
    v_cos_f32 v60, v243
    v_sin_f32 v76, v243
    v_add_f32 v243, v243, v244
    v_cos_f32 v61, v243
    v_sin_f32 v77, v243
    v_add_f32 v243, v243, v244
    v_cos_f32 v62, v243
    v_sin_f32 v78, v243
    v_add_f32 v243, v243, v244
    v_cos_f32 v63, v243
    v_sin_f32 v79, v243
    s_cmp_eq_u32 s83, 255
    s_mov_b32 s62, 0x36000000
    s_cmov_b32 s62, 0x35800000
    v_mul_f32 v48, s62, v48
    v_mul_f32 v49, s62, v49
    v_mul_f32 v50, s62, v50
    v_mul_f32 v51, s62, v51
    v_mul_f32 v52, s62, v52
    v_mul_f32 v53, s62, v53
    v_mul_f32 v54, s62, v54
    v_mul_f32 v55, s62, v55
    v_mul_f32 v56, s62, v56
    v_mul_f32 v57, s62, v57
    v_mul_f32 v58, s62, v58
    v_mul_f32 v59, s62, v59
    v_mul_f32 v60, s62, v60
    v_mul_f32 v61, s62, v61
    v_mul_f32 v62, s62, v62
    v_mul_f32 v63, s62, v63
    v_mul_f32 v64, s62, v64
    v_mul_f32 v65, s62, v65
    v_mul_f32 v66, s62, v66
    v_mul_f32 v67, s62, v67
    v_mul_f32 v68, s62, v68
    v_mul_f32 v69, s62, v69
    v_mul_f32 v70, s62, v70
    v_mul_f32 v71, s62, v71
    v_mul_f32 v72, s62, v72
    v_mul_f32 v73, s62, v73
    v_mul_f32 v74, s62, v74
    v_mul_f32 v75, s62, v75
    v_mul_f32 v76, s62, v76
    v_mul_f32 v77, s62, v77
    v_mul_f32 v78, s62, v78
    v_mul_f32 v79, s62, v79
    v_floor_f32 v245, v241
    v_mul_f32 v244, 0x3a000000, v242
    v_mul_f32 v243, v245, v244
    v_cos_f32 v16, v243
    v_sin_f32 v32, v243
    v_add_f32 v243, v243, v244
    v_cos_f32 v17, v243
    v_sin_f32 v33, v243
    v_add_f32 v243, v243, v244
    v_cos_f32 v18, v243
    v_sin_f32 v34, v243
    v_add_f32 v243, v243, v244
    v_cos_f32 v19, v243
    v_sin_f32 v35, v243
    v_add_f32 v243, v243, v244
    v_cos_f32 v20, v243
    v_sin_f32 v36, v243
    v_add_f32 v243, v243, v244
    v_cos_f32 v21, v243
    v_sin_f32 v37, v243
    v_add_f32 v243, v243, v244
    v_cos_f32 v22, v243
    v_sin_f32 v38, v243
    v_add_f32 v243, v243, v244
    v_cos_f32 v23, v243
    v_sin_f32 v39, v243
    v_add_f32 v243, v243, v244
    v_cos_f32 v24, v243
    v_sin_f32 v40, v243
    v_add_f32 v243, v243, v244
    v_cos_f32 v25, v243
    v_sin_f32 v41, v243
    v_add_f32 v243, v243, v244
    v_cos_f32 v26, v243
    v_sin_f32 v42, v243
    v_add_f32 v243, v243, v244
    v_cos_f32 v27, v243
    v_sin_f32 v43, v243
    v_add_f32 v243, v243, v244
    v_cos_f32 v28, v243
    v_sin_f32 v44, v243
    v_add_f32 v243, v243, v244
    v_cos_f32 v29, v243
    v_sin_f32 v45, v243
    v_add_f32 v243, v243, v244
    v_cos_f32 v30, v243
    v_sin_f32 v46, v243
    v_add_f32 v243, v243, v244
    v_cos_f32 v31, v243
    v_sin_f32 v47, v243
    v_bfe_u32 v13, v1, 2, 1
    v_lshlrev_b32 v14, 4, v13
    v_bfe_u32 v13, v1, 3, 2
    v_lshl_add_u32 v14, v13, 2, v14
    v_and_b32 v13, 0x23, v1
    v_add_u32 v14, v14, v13
    v_lshlrev_b32 v14, 13, v14
    v_lshlrev_b32 v15, 4, v1
    v_bfe_u32 v12, v1, 3, 2
    v_lshlrev_b32 v12, 10, v12
    v_lshrrev_b32 v13, 5, v1
    v_lshl_add_u32 v12, v13, 9, v12
    v_and_b32 v13, 7, v1
    v_lshl_add_u32 v12, v13, 4, v12
    s_lshl_b32 s59, s83, 5
    s_lshl_b32 s61, s6, 4
    s_add_u32 s59, s59, s61
    s_add_u32 s59, s59, 0
    s_lshl_b32 s60, s83, 13
    s_lshl_b32 s61, s6, 12
    s_add_u32 s60, s60, s61
    s_add_u32 s61, s60, 2097152
    s_setprio 2
    s_mov_b32 s41, 262144
    s_add_u32 s42, s5, 1
    s_mov_b32 s43, s42
    s_and_b32 s40, s2, 255
    s_lshl_b32 s40, s40, 8
    s_add_u32 s40, s40, 65536
gp_121:
    s_load_dwordx2 s[44:45], s[80:81], s40 glc
    s_waitcnt lgkmcnt(0)
    s_xor_b64 s[44:45], s[44:45], s[42:43]
    s_cbranch_scc0 gpd_122
    s_sleep 2
    s_sub_u32 s41, s41, 1
    s_cbranch_scc0 gp_121
gpd_122:
    buffer_load_dwordx4 v[80:83], v14, s[36:39], s59 offen sc1
    s_add_u32 s59, s59, 524288
    buffer_load_dwordx4 v[84:87], v14, s[36:39], s59 offen sc1
    s_add_u32 s59, s59, 524288
    buffer_load_dwordx4 v[88:91], v14, s[36:39], s59 offen sc1
    s_add_u32 s59, s59, 524288
    buffer_load_dwordx4 v[92:95], v14, s[36:39], s59 offen sc1
    buffer_load_dwordx4 v[96:99], v15, s[36:39], s61 offen offset:0 sc1
    buffer_load_dwordx4 v[100:103], v15, s[36:39], s61 offen offset:1024 sc1
    buffer_load_dwordx4 v[104:107], v15, s[36:39], s61 offen offset:2048 sc1
    buffer_load_dwordx4 v[108:111], v15, s[36:39], s61 offen offset:3072 sc1
    s_waitcnt vmcnt(7)
    v_mfma_f32_32x32x16_bf16 v[208:223], v[80:83], v[128:131], 0
    v_mfma_f32_32x32x16_bf16 v[224:239], v[80:83], v[132:135], 0
    s_waitcnt vmcnt(6)
    v_mfma_f32_32x32x16_bf16 v[208:223], v[84:87], v[136:139], v[208:223]
    v_mfma_f32_32x32x16_bf16 v[224:239], v[84:87], v[140:143], v[224:239]
    s_waitcnt vmcnt(5)
    v_mfma_f32_32x32x16_bf16 v[208:223], v[88:91], v[144:147], v[208:223]
    v_mfma_f32_32x32x16_bf16 v[224:239], v[88:91], v[148:151], v[224:239]
    s_waitcnt vmcnt(4)
    v_mfma_f32_32x32x16_bf16 v[208:223], v[92:95], v[152:155], v[208:223]
    v_mfma_f32_32x32x16_bf16 v[224:239], v[92:95], v[156:159], v[224:239]
    s_nop 10
    v_mul_f32 v112, v208, v16
    v_mul_f32 v114, v224, v16
    v_mul_f32 v113, v209, v17
    v_mul_f32_e64 v115, v225, v17
    v_fma_f32 v112, v224, v32, v112
    v_fma_f32 v114, -v208, v32, v114
    v_fma_f32 v113, v225, v33, v113
    v_fma_f32 v115, -v209, v33, v115
    v_cvt_pk_bf16_f32 v80, v112, v113
    v_cvt_pk_bf16_f32 v88, v114, v115
    v_mul_f32 v116, v210, v18
    v_mul_f32 v118, v226, v18
    v_mul_f32 v117, v211, v19
    v_mul_f32 v119, v227, v19
    v_fma_f32 v116, v226, v34, v116
    v_fma_f32 v118, -v210, v34, v118
    v_fma_f32 v117, v227, v35, v117
    v_fma_f32 v119, -v211, v35, v119
    v_cvt_pk_bf16_f32 v81, v116, v117
    v_cvt_pk_bf16_f32 v89, v118, v119
    v_mul_f32 v112, v212, v20
    v_mul_f32 v114, v228, v20
    v_mul_f32 v113, v213, v21
    v_mul_f32 v115, v229, v21
    v_fma_f32 v112, v228, v36, v112
    v_fma_f32 v114, -v212, v36, v114
    v_fma_f32 v113, v229, v37, v113
    v_fma_f32 v115, -v213, v37, v115
    v_cvt_pk_bf16_f32 v82, v112, v113
    v_cvt_pk_bf16_f32 v90, v114, v115
    v_mul_f32 v116, v214, v22
    v_mul_f32 v118, v230, v22
    v_mul_f32 v117, v215, v23
    v_mul_f32 v119, v231, v23
    v_fma_f32 v116, v230, v38, v116
    v_fma_f32 v118, -v214, v38, v118
    v_fma_f32 v117, v231, v39, v117
    v_fma_f32 v119, -v215, v39, v119
    v_cvt_pk_bf16_f32 v83, v116, v117
    v_cvt_pk_bf16_f32 v91, v118, v119
    v_mul_f32 v112, v216, v24
    v_mul_f32 v114, v232, v24
    v_mul_f32 v113, v217, v25
    v_mul_f32 v115, v233, v25
    v_mfma_f32_32x32x16_bf16 v[128:143], v[160:163], v[80:83], 0
    v_fma_f32 v112, v232, v40, v112
    v_fma_f32 v114, -v216, v40, v114
    v_fma_f32 v113, v233, v41, v113
    v_fma_f32 v115, -v217, v41, v115
    v_cvt_pk_bf16_f32 v84, v112, v113
    v_cvt_pk_bf16_f32 v92, v114, v115
    v_mul_f32 v116, v218, v26
    v_mul_f32 v118, v234, v26
    v_mul_f32 v117, v219, v27
    v_mul_f32 v119, v235, v27
    v_mfma_f32_32x32x16_bf16 v[144:159], v[176:179], v[80:83], 0
    v_fma_f32 v116, v234, v42, v116
    v_fma_f32 v118, -v218, v42, v118
    v_fma_f32 v117, v235, v43, v117
    v_fma_f32 v119, -v219, v43, v119
    v_cvt_pk_bf16_f32 v85, v116, v117
    v_cvt_pk_bf16_f32 v93, v118, v119
    v_mul_f32 v112, v220, v28
    v_mul_f32 v114, v236, v28
    v_mul_f32 v113, v221, v29
    v_mul_f32 v115, v237, v29
    v_mfma_f32_32x32x16_bf16 v[128:143], v[168:171], v[88:91], v[128:143]
    v_fma_f32 v112, v236, v44, v112
    v_fma_f32 v114, -v220, v44, v114
    v_fma_f32 v113, v237, v45, v113
    v_fma_f32 v115, -v221, v45, v115
    v_cvt_pk_bf16_f32 v86, v112, v113
    v_cvt_pk_bf16_f32 v94, v114, v115
    v_mul_f32 v116, v222, v30
    v_mul_f32 v118, v238, v30
    v_mul_f32 v117, v223, v31
    v_mul_f32 v119, v239, v31
    v_mfma_f32_32x32x16_bf16 v[144:159], v[160:163], v[88:91], v[144:159]
    v_fma_f32 v116, v238, v46, v116
    v_fma_f32 v118, -v222, v46, v118
    v_fma_f32 v117, v239, v47, v117
    v_fma_f32 v119, -v223, v47, v119
    v_cvt_pk_bf16_f32 v87, v116, v117
    v_cvt_pk_bf16_f32 v95, v118, v119
    s_waitcnt vmcnt(0)
    v_mfma_f32_32x32x16_bf16 v[128:143], v[164:167], v[84:87], v[128:143]
    v_lshlrev_b32 v16, 16, v96
    v_and_b32 v32, 0xffff0000, v96
    v_lshlrev_b32 v17, 16, v97
    v_and_b32 v33, 0xffff0000, v97
    v_lshlrev_b32 v18, 16, v98
    v_and_b32 v34, 0xffff0000, v98
    v_lshlrev_b32_e64 v19, 16, v99
    v_and_b32 v35, 0xffff0000, v99
    v_mfma_f32_32x32x16_bf16 v[144:159], v[180:183], v[84:87], v[144:159]
    v_lshlrev_b32 v20, 16, v100
    v_and_b32 v36, 0xffff0000, v100
    v_lshlrev_b32 v21, 16, v101
    v_and_b32 v37, 0xffff0000, v101
    v_lshlrev_b32 v22, 16, v102
    v_and_b32 v38, 0xffff0000, v102
    v_lshlrev_b32 v23, 16, v103
    v_and_b32 v39, 0xffff0000, v103
    v_mfma_f32_32x32x16_bf16 v[128:143], v[172:175], v[92:95], v[128:143]
    v_lshlrev_b32 v24, 16, v104
    v_and_b32 v40, 0xffff0000, v104
    v_lshlrev_b32 v25, 16, v105
    v_and_b32 v41, 0xffff0000, v105
    v_lshlrev_b32 v26, 16, v106
    v_and_b32 v42, 0xffff0000, v106
    v_lshlrev_b32 v27, 16, v107
    v_and_b32 v43, 0xffff0000, v107
    v_mfma_f32_32x32x16_bf16 v[144:159], v[164:167], v[92:95], v[144:159]
    v_lshlrev_b32 v28, 16, v108
    v_and_b32 v44, 0xffff0000, v108
    v_lshlrev_b32 v29, 16, v109
    v_and_b32 v45, 0xffff0000, v109
    v_lshlrev_b32 v30, 16, v110
    v_and_b32 v46, 0xffff0000, v110
    v_lshlrev_b32 v31, 16, v111
    v_and_b32 v47, 0xffff0000, v111
    v_mul_f32 v112, v128, v16
    s_nop 2
    v_mul_f32 v114, v144, v16
    v_mul_f32 v113, v129, v17
    v_mul_f32_e64 v115, v145, v17
    v_fma_f32 v112, -v144, v32, v112
    v_fma_f32 v114, v128, v32, v114
    v_fma_f32 v113, -v145, v33, v113
    v_fma_f32 v115, v129, v33, v115
    v_cvt_pk_bf16_f32 v80, v112, v113
    v_cvt_pk_bf16_f32 v88, v114, v115
    v_mul_f32 v116, v130, v18
    v_mul_f32 v118, v146, v18
    v_mul_f32 v117, v131, v19
    v_mul_f32 v119, v147, v19
    v_fma_f32 v116, -v146, v34, v116
    v_fma_f32 v118, v130, v34, v118
    v_fma_f32 v117, -v147, v35, v117
    v_fma_f32 v119, v131, v35, v119
    v_cvt_pk_bf16_f32 v81, v116, v117
    v_cvt_pk_bf16_f32 v89, v118, v119
    v_mul_f32 v112, v132, v20
    v_mul_f32 v114, v148, v20
    v_mul_f32 v113, v133, v21
    v_mul_f32 v115, v149, v21
    v_fma_f32 v112, -v148, v36, v112
    v_fma_f32 v114, v132, v36, v114
    v_fma_f32 v113, -v149, v37, v113
    v_fma_f32 v115, v133, v37, v115
    v_cvt_pk_bf16_f32 v82, v112, v113
    v_cvt_pk_bf16_f32 v90, v114, v115
    v_mul_f32 v116, v134, v22
    v_mul_f32 v118, v150, v22
    v_mul_f32 v117, v135, v23
    v_mul_f32 v119, v151, v23
    v_fma_f32 v116, -v150, v38, v116
    v_fma_f32 v118, v134, v38, v118
    v_fma_f32 v117, -v151, v39, v117
    v_fma_f32 v119, v135, v39, v119
    v_cvt_pk_bf16_f32 v83, v116, v117
    v_cvt_pk_bf16_f32 v91, v118, v119
    v_mul_f32 v112, v136, v24
    v_mul_f32 v114, v152, v24
    v_mul_f32 v113, v137, v25
    v_mul_f32 v115, v153, v25
    v_mfma_f32_32x32x16_bf16 v[208:223], v[80:83], v[160:163], 0
    v_fma_f32 v112, -v152, v40, v112
    v_fma_f32 v114, v136, v40, v114
    v_fma_f32 v113, -v153, v41, v113
    v_fma_f32 v115, v137, v41, v115
    v_cvt_pk_bf16_f32 v84, v112, v113
    v_cvt_pk_bf16_f32 v92, v114, v115
    v_mul_f32 v116, v138, v26
    v_mul_f32 v118, v154, v26
    v_mul_f32 v117, v139, v27
    v_mul_f32 v119, v155, v27
    v_mfma_f32_32x32x16_bf16 v[224:239], v[80:83], v[168:171], 0
    v_fma_f32 v116, -v154, v42, v116
    v_fma_f32 v118, v138, v42, v118
    v_fma_f32 v117, -v155, v43, v117
    v_fma_f32 v119, v139, v43, v119
    v_cvt_pk_bf16_f32 v85, v116, v117
    v_cvt_pk_bf16_f32 v93, v118, v119
    v_mul_f32 v112, v140, v28
    v_mul_f32 v114, v156, v28
    v_mul_f32 v113, v141, v29
    v_mul_f32 v115, v157, v29
    v_mfma_f32_32x32x16_bf16 v[208:223], v[88:91], v[176:179], v[208:223]
    v_fma_f32 v112, -v156, v44, v112
    v_fma_f32 v114, v140, v44, v114
    v_fma_f32 v113, -v157, v45, v113
    v_fma_f32 v115, v141, v45, v115
    v_cvt_pk_bf16_f32 v86, v112, v113
    v_cvt_pk_bf16_f32 v94, v114, v115
    v_mul_f32 v116, v142, v30
    v_mul_f32 v118, v158, v30
    v_mul_f32 v117, v143, v31
    v_mul_f32 v119, v159, v31
    v_mfma_f32_32x32x16_bf16 v[224:239], v[88:91], v[160:163], v[224:239]
    v_fma_f32 v116, -v158, v46, v116
    v_fma_f32 v118, v142, v46, v118
    v_fma_f32 v117, -v159, v47, v117
    v_fma_f32 v119, v143, v47, v119
    v_cvt_pk_bf16_f32 v87, v116, v117
    v_cvt_pk_bf16_f32 v95, v118, v119
    s_nop 0
    v_mfma_f32_32x32x16_bf16 v[208:223], v[84:87], v[164:167], v[208:223]
    v_mfma_f32_32x32x16_bf16 v[224:239], v[84:87], v[172:175], v[224:239]
    v_mfma_f32_32x32x16_bf16 v[208:223], v[92:95], v[180:183], v[208:223]
    v_mfma_f32_32x32x16_bf16 v[224:239], v[92:95], v[164:167], v[224:239]
    s_nop 10
    v_mul_f32 v112, v208, v48
    v_mul_f32 v114, v224, v48
    v_mul_f32 v113, v209, v49
    v_mul_f32 v115, v225, v49
    v_fma_f32 v112, -v224, v64, v112
    v_fma_f32 v114, v208, v64, v114
    v_fma_f32 v113, -v225, v65, v113
    v_fma_f32 v115, v209, v65, v115
    v_cvt_pk_bf16_f32 v80, v112, v113
    v_cvt_pk_bf16_f32 v88, v114, v115
    v_mul_f32 v116, v210, v50
    v_mul_f32 v118, v226, v50
    v_mul_f32 v117, v211, v51
    v_mul_f32 v119, v227, v51
    v_fma_f32 v116, -v226, v66, v116
    v_fma_f32 v118, v210, v66, v118
    v_fma_f32 v117, -v227, v67, v117
    v_fma_f32 v119, v211, v67, v119
    v_cvt_pk_bf16_f32 v81, v116, v117
    v_cvt_pk_bf16_f32 v89, v118, v119
    v_mul_f32 v112, v212, v52
    v_mul_f32 v114, v228, v52
    v_mul_f32 v113, v213, v53
    v_mul_f32 v115, v229, v53
    v_fma_f32 v112, -v228, v68, v112
    v_fma_f32 v114, v212, v68, v114
    v_fma_f32 v113, -v229, v69, v113
    v_fma_f32 v115, v213, v69, v115
    v_cvt_pk_bf16_f32 v82, v112, v113
    v_cvt_pk_bf16_f32 v90, v114, v115
    v_mul_f32 v116, v214, v54
    v_mul_f32 v118, v230, v54
    v_mul_f32 v117, v215, v55
    v_mul_f32 v119, v231, v55
    v_fma_f32 v116, -v230, v70, v116
    v_fma_f32 v118, v214, v70, v118
    v_fma_f32 v117, -v231, v71, v117
    v_fma_f32 v119, v215, v71, v119
    v_cvt_pk_bf16_f32 v83, v116, v117
    v_cvt_pk_bf16_f32 v91, v118, v119
    v_mul_f32 v112, v216, v56
    v_mul_f32 v114, v232, v56
    v_mul_f32 v113, v217, v57
    v_mul_f32 v115, v233, v57
    v_mfma_f32_32x32x16_bf16 v[128:143], v[80:83], v[184:187], 0
    v_fma_f32 v112, -v232, v72, v112
    v_fma_f32 v114, v216, v72, v114
    v_fma_f32 v113, -v233, v73, v113
    v_fma_f32 v115, v217, v73, v115
    v_cvt_pk_bf16_f32 v84, v112, v113
    v_cvt_pk_bf16_f32 v92, v114, v115
    v_mul_f32 v116, v218, v58
    v_mul_f32 v118, v234, v58
    v_mul_f32 v117, v219, v59
    v_mul_f32 v119, v235, v59
    v_mfma_f32_32x32x16_bf16 v[144:159], v[80:83], v[192:195], 0
    v_fma_f32 v116, -v234, v74, v116
    v_fma_f32 v118, v218, v74, v118
    v_fma_f32 v117, -v235, v75, v117
    v_fma_f32 v119, v219, v75, v119
    v_cvt_pk_bf16_f32 v85, v116, v117
    v_cvt_pk_bf16_f32 v93, v118, v119
    v_mul_f32 v112, v220, v60
    v_mul_f32 v114, v236, v60
    v_mul_f32 v113, v221, v61
    v_mul_f32 v115, v237, v61
    v_mfma_f32_32x32x16_bf16 v[128:143], v[88:91], v[200:203], v[128:143]
    v_fma_f32 v112, -v236, v76, v112
    v_fma_f32 v114, v220, v76, v114
    v_fma_f32 v113, -v237, v77, v113
    v_fma_f32 v115, v221, v77, v115
    v_cvt_pk_bf16_f32 v86, v112, v113
    v_cvt_pk_bf16_f32 v94, v114, v115
    v_mul_f32 v116, v222, v62
    v_mul_f32 v118, v238, v62
    v_mul_f32 v117, v223, v63
    v_mul_f32 v119, v239, v63
    v_mfma_f32_32x32x16_bf16 v[144:159], v[88:91], v[184:187], v[144:159]
    v_fma_f32 v116, -v238, v78, v116
    v_fma_f32 v118, v222, v78, v118
    v_fma_f32 v117, -v239, v79, v117
    v_fma_f32 v119, v223, v79, v119
    v_cvt_pk_bf16_f32 v87, v116, v117
    v_cvt_pk_bf16_f32 v95, v118, v119
    s_nop 0
    v_mfma_f32_32x32x16_bf16 v[128:143], v[84:87], v[188:191], v[128:143]
    v_mfma_f32_32x32x16_bf16 v[144:159], v[84:87], v[196:199], v[144:159]
    v_mfma_f32_32x32x16_bf16 v[128:143], v[92:95], v[204:207], v[128:143]
    v_mfma_f32_32x32x16_bf16 v[144:159], v[92:95], v[188:191], v[144:159]
    s_add_u32 s60, s60, 4194304
    s_nop 10
    v_cvt_pk_bf16_f32 v80, v128, v144
    v_cvt_pk_bf16_f32 v81, v129, v145
    v_cvt_pk_bf16_f32 v82, v130, v146
    v_cvt_pk_bf16_f32 v83, v131, v147
    buffer_store_dwordx4 v[80:83], v12, s[36:39], s60 offen offset:0 sc0 sc1
    v_cvt_pk_bf16_f32 v84, v132, v148
    v_cvt_pk_bf16_f32 v85, v133, v149
    v_cvt_pk_bf16_f32 v86, v134, v150
    v_cvt_pk_bf16_f32 v87, v135, v151
    buffer_store_dwordx4 v[84:87], v12, s[36:39], s60 offen offset:128 sc0 sc1
    v_cvt_pk_bf16_f32 v88, v136, v152
    v_cvt_pk_bf16_f32 v89, v137, v153
    v_cvt_pk_bf16_f32 v90, v138, v154
    v_cvt_pk_bf16_f32 v91, v139, v155
    buffer_store_dwordx4 v[88:91], v12, s[36:39], s60 offen offset:256 sc0 sc1
    v_cvt_pk_bf16_f32 v92, v140, v156
    v_cvt_pk_bf16_f32 v93, v141, v157
    v_cvt_pk_bf16_f32 v94, v142, v158
    v_cvt_pk_bf16_f32 v95, v143, v159
    buffer_store_dwordx4 v[92:95], v12, s[36:39], s60 offen offset:384 sc0 sc1
    v_mov_b32 v2, 155648
    v_mov_b32 v3, 1
    s_waitcnt vmcnt(0)
    s_mov_b64 exec, 1
    ds_add_rtn_u32 v14, v2, v3 offset:44
    s_mov_b64 exec, -1
    s_waitcnt lgkmcnt(0)
    v_readfirstlane_b32 s40, v14
    s_nop 0
    s_cmp_lg_u32 s40, 1
    s_cbranch_scc1 zf_123
    s_bfe_u32 s43, s2, 0x30003
    s_lshl_b32 s41, s43, 7
    s_add_u32 s41, s41, 4096
    s_mov_b32 s40, 1
    s_atomic_add s40, s[80:81], s41 glc
    s_waitcnt lgkmcnt(0)
    s_cmp_lg_u32 s40, 31
    s_cbranch_scc1 zf_123
    s_lshl_b32 s43, s43, 2
    s_add_u32 s43, s43, 12648480
    s_add_u32 s40, s5, 1
    v_mov_b32 v14, s40
    v_lshlrev_b32 v15, 8, v1
    buffer_store_dword v14, v15, s[36:39], s43 offen sc0 sc1
    s_add_u32 s43, s43, 0x4000
    buffer_store_dword v14, v15, s[36:39], s43 offen sc0 sc1
    s_add_u32 s43, s43, 0x4000
    buffer_store_dword v14, v15, s[36:39], s43 offen sc0 sc1
    s_add_u32 s43, s43, 0x4000
    buffer_store_dword v14, v15, s[36:39], s43 offen sc0 sc1
    s_add_u32 s43, s43, 0x4000
    s_mov_b64 exec, -1
zf_123:
    s_setprio 0
    v_and_b32 v4, 15, v1
    v_cvt_f32_u32 v4, v4
    v_lshrrev_b32 v5, 4, v1
    v_cvt_f32_u32 v5, v5
    v_mul_f32 v7, 0x3d800000, v4
    v_add_f32 v6, v5, v5
    v_mul_f32 v6, v6, v7
    v_cos_f32 v8, v6
    v_sin_f32 v9, v6
    s_nop 0
    v_cvt_pk_bf16_f32 v16, v8, -v9
    v_cvt_pk_bf16_f32 v18, v9, v8
    v_add_f32 v6, v6, v7
    v_cos_f32 v8, v6
    v_sin_f32 v9, v6
    s_nop 0
    v_cvt_pk_bf16_f32 v17, v8, -v9
    v_cvt_pk_bf16_f32 v19, v9, v8
    v_fma_f32 v5, 4.0, v5, 1.0
    v_mul_f32 v7, 0x3b000000, v4
    v_mul_f32 v6, v5, v7
    v_mul_f32 v8, 0x41500000, v7
    v_cos_f32 v20, v6
    v_sin_f32 v28, v6
    v_add_f32 v6, v6, v7
    v_cos_f32 v21, v6
    v_sin_f32 v29, v6
    v_add_f32 v6, v6, v7
    v_cos_f32 v22, v6
    v_sin_f32 v30, v6
    v_add_f32 v6, v6, v7
    v_cos_f32 v23, v6
    v_sin_f32 v31, v6
    v_add_f32 v6, v6, v8
    v_cos_f32 v24, v6
    v_sin_f32 v32, v6
    v_add_f32 v6, v6, v7
    v_cos_f32 v25, v6
    v_sin_f32 v33, v6
    v_add_f32 v6, v6, v7
    v_cos_f32 v26, v6
    v_sin_f32 v34, v6
    v_add_f32 v6, v6, v7
    v_cos_f32 v27, v6
    v_sin_f32 v35, v6
    v_mul_f32 v7, 0x3d000000, v4
    v_mul_f32 v6, v5, v7
    v_cos_f32 v100, v6
    v_sin_f32 v104, v6
    v_add_f32 v6, v6, v7
    v_cos_f32 v101, v6
    v_sin_f32 v105, v6
    v_add_f32 v6, v6, v7
    v_cos_f32 v102, v6
    v_sin_f32 v106, v6
    v_add_f32 v6, v6, v7
    v_cos_f32 v103, v6
    v_sin_f32_e64 v107, v6
    v_cvt_pk_bf16_f32 v36, v100, v101
    v_cvt_pk_bf16_f32 v38, -v104, -v105
    v_cvt_pk_bf16_f32 v37, v102, v103
    v_cvt_pk_bf16_f32 v39, -v106, -v107
    s_lshl_b32 s40, s6, 15
    v_xor_b32 v36, s40, v36
    v_xor_b32 v37, s40, v37
    v_xor_b32 v38, s40, v38
    v_xor_b32 v39, s40, v39
    v_and_b32 v8, 1, v1
    v_mul_u32_u24 v8, 0x8000, v8
    v_lshl_or_b32 v8, v8, 16, v8
    v_xor_b32 v44, v8, v36
    v_xor_b32 v45, v8, v37
    v_xor_b32 v46, v8, v38
    v_xor_b32 v47, v8, v39
    v_xor_b32 v40, 0x8000, v36
    v_xor_b32 v41, 0x8000, v37
    v_xor_b32 v42, 0x8000, v38
    v_xor_b32 v43, 0x8000, v39
    v_xor_b32 v48, 0x8000, v44
    v_xor_b32 v49, 0x8000, v45
    v_xor_b32 v50, 0x8000, v46
    v_xor_b32 v51, 0x8000, v47
    s_lshr_b32 s40, s3, 2
    s_lshl_b32 s40, s40, 20
    s_lshr_b32 s41, s89, 3
    s_lshl_b32 s41, s41, 18
    s_add_u32 s40, s40, s41
    s_and_b32 s41, s89, 7
    s_lshl_b32 s41, s41, 12
    s_add_u32 s40, s40, s41
    s_and_b32 s41, s3, 3
    s_lshl_b32 s41, s41, 16
    s_add_u32 s40, s40, s41
    s_lshl_b32 s41, s90, 7
    s_add_u32 s91, s40, s41
    v_bfe_u32 v12, v1, 3, 2
    v_and_b32 v11, 7, v1
    v_lshlrev_b32 v11, 4, v11
    v_lshl_add_u32 v11, v12, 10, v11
    v_lshrrev_b32 v12, 5, v1
    v_lshl_add_u32 v11, v12, 15, v11
    buffer_load_dwordx4 v[12:15], v11, s[8:11], s91 offen
    v_and_b32 v4, 15, v1
    v_lshrrev_b32 v5, 4, v1
    v_lshl_add_u32 v6, v5, 6, v4
    v_lshlrev_b32 v6, 13, v6
    s_lshl_b32 s54, s6, 12
    s_lshl_b32 s40, s89, 7
    s_add_u32 s54, s54, s40
    s_lshl4_add_u32 s54, s90, s54
    s_add_u32 s54, s54, 4194304
    v_bfe_u32 v7, v1, 2, 2
    v_lshlrev_b32 v7, 8, v7
    v_lshl_add_u32 v7, v5, 6, v7
    v_and_b32 v8, 3, v1
    v_lshl_add_u32 v7, v8, 4, v7
    s_lshl3_add_u32 s55, s89, s90
    s_lshl1_add_u32 s55, s55, s6
    s_lshl_b32 s55, s55, 12
    s_add_u32 s55, s55, 13631488
    v_lshlrev_b32 v8, 4, v1
    s_lshl_b32 s40, s6, 11
    s_add_u32 s40, s40, 156672
    v_add_u32_e64 v8, s40, v8
    v_subrev_u32 v9, 156672, v8
    v_xor_b32 v9, 0x800, v9
    v_add_u32 v9, 156672, v9
    s_and_b32 s40, s2, 31
    s_lshl_b32 s40, s40, 8
    s_add_u32 s40, s40, 12648576
    s_add_u32 s58, s36, s40
    s_addc_u32 s59, s37, 0
    s_mul_i32 s57, s6, 0x80008000
    s_setprio 0
    s_mov_b32 s41, 262144
    s_add_u32 s42, s5, 1
    s_mov_b32 s43, s42
    s_and_b32 s40, s2, 255
    s_lshl_b32 s40, s40, 8
    s_add_u32 s40, s40, 65568
gp_124:
    s_load_dwordx8 s[44:51], s[80:81], s40 glc
    s_waitcnt lgkmcnt(0)
    s_xor_b64 s[44:45], s[44:45], s[42:43]
    s_xor_b64 s[46:47], s[46:47], s[42:43]
    s_xor_b64 s[48:49], s[48:49], s[42:43]
    s_xor_b64 s[50:51], s[50:51], s[42:43]
    s_or_b64 s[44:45], s[44:45], s[46:47]
    s_or_b64 s[48:49], s[48:49], s[50:51]
    s_or_b64 s[44:45], s[44:45], s[48:49]
    s_cbranch_scc0 gpd_125
    s_sleep 2
    s_sub_u32 s41, s41, 1
    s_cbranch_scc0 gp_124
gpd_125:
    buffer_load_dwordx4 v[52:55], v6, s[36:39], s54 offen sc1
    s_add_u32 s54, s54, 131072
    buffer_load_dwordx4 v[60:63], v6, s[36:39], s54 offen sc1
    s_add_u32 s54, s54, 131072
    buffer_load_dwordx4 v[56:59], v6, s[36:39], s54 offen sc1
    s_add_u32 s54, s54, 131072
    buffer_load_dwordx4 v[64:67], v6, s[36:39], s54 offen sc1
    s_waitcnt vmcnt(0)
    v_mov_b32 v68, v52
    v_mov_b32 v69, v56
    v_mov_b32 v70, v53
    v_mov_b32 v71, v57
    v_mov_b32 v72, v54
    v_mov_b32 v73, v58
    v_mov_b32 v74, v55
    v_mov_b32 v75, v59
    v_mov_b32 v76, v60
    v_mov_b32 v77, v64
    v_mov_b32 v78, v61
    v_mov_b32 v79, v65
    v_mov_b32 v80, v62
    v_mov_b32 v81, v66
    v_mov_b32 v82, v63
    v_mov_b32_e64 v83, v67
    v_mfma_f32_16x16x16_bf16 v[128:131], v[68:69], v[16:17], 0
    v_mfma_f32_16x16x16_bf16 v[132:135], v[68:69], v[18:19], 0
    v_mfma_f32_16x16x16_bf16 v[136:139], v[76:77], v[16:17], 0
    v_mfma_f32_16x16x16_bf16 v[140:143], v[76:77], v[18:19], 0
    v_mfma_f32_16x16x16_bf16 v[144:147], v[70:71], v[16:17], 0
    v_mfma_f32_16x16x16_bf16 v[148:151], v[70:71], v[18:19], 0
    v_mfma_f32_16x16x16_bf16 v[152:155], v[78:79], v[16:17], 0
    v_mfma_f32_16x16x16_bf16 v[156:159], v[78:79], v[18:19], 0
    v_mfma_f32_16x16x16_bf16 v[160:163], v[72:73], v[16:17], 0
    v_mfma_f32_16x16x16_bf16 v[164:167], v[72:73], v[18:19], 0
    v_mfma_f32_16x16x16_bf16 v[168:171], v[80:81], v[16:17], 0
    v_mfma_f32_16x16x16_bf16 v[172:175], v[80:81], v[18:19], 0
    v_mfma_f32_16x16x16_bf16 v[176:179], v[74:75], v[16:17], 0
    v_mfma_f32_16x16x16_bf16 v[180:183], v[74:75], v[18:19], 0
    v_mfma_f32_16x16x16_bf16 v[184:187], v[82:83], v[16:17], 0
    v_mfma_f32_16x16x16_bf16 v[188:191], v[82:83], v[18:19], 0
    v_mul_f32 v116, v128, v20
    v_mul_f32 v120, v132, v20
    v_mul_f32 v117, v129, v21
    v_mul_f32 v121, v133, v21
    v_mul_f32 v118, v130, v22
    v_mul_f32 v122, v134, v22
    v_mul_f32 v119, v131, v23
    v_mul_f32 v123, v135, v23
    v_fma_f32 v116, -v132, v28, v116
    v_fma_f32 v120, v128, v28, v120
    v_fma_f32 v117, -v133, v29, v117
    v_fma_f32 v121, v129, v29, v121
    v_fma_f32 v118, -v134, v30, v118
    v_fma_f32 v122, v130, v30, v122
    v_fma_f32 v119, -v135, v31, v119
    v_fma_f32 v123, v131, v31, v123
    v_cvt_pk_bf16_f32 v84, v116, v117
    v_cvt_pk_bf16_f32 v85, v118, v119
    v_cvt_pk_bf16_f32 v86, v120, v121
    v_cvt_pk_bf16_f32 v87, v122, v123
    v_mul_f32 v116, v136, v24
    v_mul_f32 v120, v140, v24
    v_mul_f32 v117, v137, v25
    v_mul_f32 v121, v141, v25
    v_mul_f32 v118, v138, v26
    v_mul_f32 v122, v142, v26
    v_mul_f32 v119, v139, v27
    v_mul_f32 v123, v143, v27
    v_fma_f32 v116, -v140, v32, v116
    v_fma_f32 v120, v136, v32, v120
    v_fma_f32 v117, -v141, v33, v117
    v_fma_f32 v121, v137, v33, v121
    v_fma_f32 v118, -v142, v34, v118
    v_fma_f32 v122, v138, v34, v122
    v_fma_f32 v119, -v143, v35, v119
    v_fma_f32 v123, v139, v35, v123
    v_cvt_pk_bf16_f32 v88, v116, v117
    v_cvt_pk_bf16_f32 v89, v118, v119
    v_cvt_pk_bf16_f32 v90, v120, v121
    v_cvt_pk_bf16_f32 v91, v122, v123
    v_mfma_f32_16x16x32_bf16 v[192:195], v[84:87], v[36:39], 0
    s_nop 0
    v_mfma_f32_16x16x32_bf16 v[192:195], v[88:91], v[44:47], v[192:195]
    v_mfma_f32_16x16x32_bf16 v[196:199], v[84:87], v[40:43], 0
    v_mfma_f32_16x16x32_bf16 v[196:199], v[88:91], v[48:51], v[196:199]
    v_mul_f32 v116, v144, v20
    v_mul_f32 v120, v148, v20
    v_mul_f32 v117, v145, v21
    v_mul_f32 v121, v149, v21
    v_mul_f32 v118, v146, v22
    v_mul_f32 v122, v150, v22
    v_mul_f32 v119, v147, v23
    v_mul_f32_e64 v123, v151, v23
    v_fma_f32 v116, -v148, v28, v116
    v_fma_f32 v120, v144, v28, v120
    v_fma_f32 v117, -v149, v29, v117
    v_fma_f32 v121, v145, v29, v121
    v_fma_f32 v118, -v150, v30, v118
    v_fma_f32 v122, v146, v30, v122
    v_fma_f32 v119, -v151, v31, v119
    v_fma_f32 v123, v147, v31, v123
    v_cvt_pk_bf16_f32 v92, v116, v117
    v_cvt_pk_bf16_f32 v93, v118, v119
    v_cvt_pk_bf16_f32 v94, v120, v121
    v_cvt_pk_bf16_f32 v95, v122, v123
    v_mul_f32 v116, v152, v24
    v_mul_f32 v120, v156, v24
    v_mul_f32 v117, v153, v25
    v_mul_f32 v121, v157, v25
    v_mul_f32 v118, v154, v26
    v_mul_f32 v122, v158, v26
    v_mul_f32 v119, v155, v27
    v_mul_f32 v123, v159, v27
    v_fma_f32 v116, -v156, v32, v116
    v_fma_f32 v120, v152, v32, v120
    v_fma_f32 v117, -v157, v33, v117
    v_fma_f32 v121, v153, v33, v121
    v_fma_f32 v118, -v158, v34, v118
    v_fma_f32 v122, v154, v34, v122
    v_fma_f32 v119, -v159, v35, v119
    v_fma_f32 v123, v155, v35, v123
    v_cvt_pk_bf16_f32 v96, v116, v117
    v_cvt_pk_bf16_f32 v97, v118, v119
    v_cvt_pk_bf16_f32 v98, v120, v121
    v_cvt_pk_bf16_f32 v99, v122, v123
    v_mfma_f32_16x16x32_bf16 v[200:203], v[92:95], v[36:39], 0
    s_nop 0
    v_mfma_f32_16x16x32_bf16 v[200:203], v[96:99], v[44:47], v[200:203]
    v_mfma_f32_16x16x32_bf16 v[204:207], v[92:95], v[40:43], 0
    v_mfma_f32_16x16x32_bf16 v[204:207], v[96:99], v[48:51], v[204:207]
    v_mul_f32 v116, v160, v20
    v_mul_f32 v120, v164, v20
    v_mul_f32 v117, v161, v21
    v_mul_f32 v121, v165, v21
    v_mul_f32 v118, v162, v22
    v_mul_f32 v122, v166, v22
    v_mul_f32 v119, v163, v23
    v_mul_f32_e64 v123, v167, v23
    v_fma_f32 v116, -v164, v28, v116
    v_fma_f32 v120, v160, v28, v120
    v_fma_f32 v117, -v165, v29, v117
    v_fma_f32 v121, v161, v29, v121
    v_fma_f32 v118, -v166, v30, v118
    v_fma_f32 v122, v162, v30, v122
    v_fma_f32 v119, -v167, v31, v119
    v_fma_f32 v123, v163, v31, v123
    v_cvt_pk_bf16_f32 v100, v116, v117
    v_cvt_pk_bf16_f32 v101, v118, v119
    v_cvt_pk_bf16_f32 v102, v120, v121
    v_cvt_pk_bf16_f32 v103, v122, v123
    v_mul_f32 v116, v168, v24
    v_mul_f32 v120, v172, v24
    v_mul_f32 v117, v169, v25
    v_mul_f32 v121, v173, v25
    v_mul_f32 v118, v170, v26
    v_mul_f32 v122, v174, v26
    v_mul_f32 v119, v171, v27
    v_mul_f32 v123, v175, v27
    v_fma_f32 v116, -v172, v32, v116
    v_fma_f32 v120, v168, v32, v120
    v_fma_f32 v117, -v173, v33, v117
    v_fma_f32 v121, v169, v33, v121
    v_fma_f32 v118, -v174, v34, v118
    v_fma_f32 v122, v170, v34, v122
    v_fma_f32 v119, -v175, v35, v119
    v_fma_f32 v123, v171, v35, v123
    v_cvt_pk_bf16_f32 v104, v116, v117
    v_cvt_pk_bf16_f32 v105, v118, v119
    v_cvt_pk_bf16_f32 v106, v120, v121
    v_cvt_pk_bf16_f32 v107, v122, v123
    v_mfma_f32_16x16x32_bf16 v[208:211], v[100:103], v[36:39], 0
    s_nop 0
    v_mfma_f32_16x16x32_bf16 v[208:211], v[104:107], v[44:47], v[208:211]
    v_mfma_f32_16x16x32_bf16 v[212:215], v[100:103], v[40:43], 0
    v_mfma_f32_16x16x32_bf16 v[212:215], v[104:107], v[48:51], v[212:215]
    v_mul_f32 v116, v176, v20
    v_mul_f32 v120, v180, v20
    v_mul_f32 v117, v177, v21
    v_mul_f32 v121, v181, v21
    v_mul_f32 v118, v178, v22
    v_mul_f32 v122, v182, v22
    v_mul_f32 v119, v179, v23
    v_mul_f32_e64 v123, v183, v23
    v_fma_f32 v116, -v180, v28, v116
    v_fma_f32 v120, v176, v28, v120
    v_fma_f32 v117, -v181, v29, v117
    v_fma_f32 v121, v177, v29, v121
    v_fma_f32 v118, -v182, v30, v118
    v_fma_f32 v122, v178, v30, v122
    v_fma_f32 v119, -v183, v31, v119
    v_fma_f32 v123, v179, v31, v123
    v_cvt_pk_bf16_f32 v108, v116, v117
    v_cvt_pk_bf16_f32 v109, v118, v119
    v_cvt_pk_bf16_f32 v110, v120, v121
    v_cvt_pk_bf16_f32 v111, v122, v123
    v_mul_f32 v116, v184, v24
    v_mul_f32 v120, v188, v24
    v_mul_f32 v117, v185, v25
    v_mul_f32 v121, v189, v25
    v_mul_f32 v118, v186, v26
    v_mul_f32 v122, v190, v26
    v_mul_f32 v119, v187, v27
    v_mul_f32 v123, v191, v27
    v_fma_f32 v116, -v188, v32, v116
    v_fma_f32 v120, v184, v32, v120
    v_fma_f32 v117, -v189, v33, v117
    v_fma_f32 v121, v185, v33, v121
    v_fma_f32 v118, -v190, v34, v118
    v_fma_f32 v122, v186, v34, v122
    v_fma_f32 v119, -v191, v35, v119
    v_fma_f32 v123, v187, v35, v123
    v_cvt_pk_bf16_f32 v112, v116, v117
    v_cvt_pk_bf16_f32 v113, v118, v119
    v_cvt_pk_bf16_f32 v114, v120, v121
    v_cvt_pk_bf16_f32 v115, v122, v123
    v_mfma_f32_16x16x32_bf16 v[216:219], v[108:111], v[36:39], 0
    s_nop 0
    s_nop 0
    v_mfma_f32_16x16x32_bf16 v[216:219], v[112:115], v[44:47], v[216:219]
    v_mfma_f32_16x16x32_bf16 v[220:223], v[108:111], v[40:43], 0
    v_mfma_f32_16x16x32_bf16 v[220:223], v[112:115], v[48:51], v[220:223]
    v_cvt_pk_bf16_f32 v84, v196, v197
    v_cvt_pk_bf16_f32 v85, v198, v199
    v_cvt_pk_bf16_f32 v86, v204, v205
    v_cvt_pk_bf16_f32 v87, v206, v207
    v_cvt_pk_bf16_f32 v88, v212, v213
    v_cvt_pk_bf16_f32 v89, v214, v215
    s_nop 1
    v_cvt_pk_bf16_f32 v90, v220, v221
    v_cvt_pk_bf16_f32 v91, v222, v223
    ds_write_b128 v8, v[84:87]
    ds_write_b128 v8, v[88:91] offset:1024
    s_mov_b64 exec, 1
    ds_add_u32 v2, v3 offset:160
    s_mov_b64 exec, -1
    s_mov_b32 s41, 2097152
lw_126:
    ds_read_b32 v10, v2 offset:160
    s_waitcnt lgkmcnt(0)
    v_readfirstlane_b32 s40, v10
    s_nop 0
    s_cmp_ge_u32 s40, 2
    s_cbranch_scc1 lwd_127
    s_sub_u32 s41, s41, 1
    s_cbranch_scc0 lw_126
lwd_127:
    ds_read_b128 v[84:87], v9
    ds_read_b128 v[88:91], v9 offset:1024
    s_waitcnt lgkmcnt(0)
    v_lshlrev_b32 v68, 16, v84
    v_and_b32 v69, 0xffff0000, v84
    v_lshlrev_b32 v70, 16, v85
    v_and_b32 v71, 0xffff0000, v85
    v_lshlrev_b32 v72, 16, v86
    v_and_b32 v73, 0xffff0000, v86
    v_lshlrev_b32 v74, 16, v87
    v_and_b32 v75, 0xffff0000, v87
    v_lshlrev_b32 v76, 16, v88
    v_and_b32 v77, 0xffff0000, v88
    v_lshlrev_b32 v78, 16, v89
    v_and_b32 v79, 0xffff0000, v89
    v_lshlrev_b32 v80, 16, v90
    v_and_b32 v81, 0xffff0000, v90
    v_lshlrev_b32 v82, 16, v91
    v_and_b32 v83, 0xffff0000, v91
    v_sub_f32 v196, v192, v68
    v_add_f32 v192, v192, v68
    v_sub_f32 v197, v193, v69
    v_add_f32 v193, v193, v69
    v_sub_f32 v198, v194, v70
    v_add_f32 v194, v194, v70
    v_sub_f32 v199, v195, v71
    v_add_f32 v195, v195, v71
    v_sub_f32 v204, v200, v72
    v_add_f32 v200, v200, v72
    v_sub_f32 v205, v201, v73
    v_add_f32 v201, v201, v73
    v_sub_f32 v206, v202, v74
    v_add_f32 v202, v202, v74
    v_sub_f32 v207, v203, v75
    v_add_f32 v203, v203, v75
    v_sub_f32 v212, v208, v76
    v_add_f32 v208, v208, v76
    v_sub_f32 v213, v209, v77
    v_add_f32 v209, v209, v77
    v_sub_f32 v214, v210, v78
    v_add_f32 v210, v210, v78
    v_sub_f32 v215, v211, v79
    v_add_f32 v211, v211, v79
    v_sub_f32 v220, v216, v80
    v_add_f32 v216, v216, v80
    v_sub_f32 v221, v217, v81
    v_add_f32 v217, v217, v81
    v_sub_f32 v222, v218, v82
    v_add_f32 v218, v218, v82
    v_sub_f32 v223, v219, v83
    v_add_f32_e64 v219, v219, v83
    v_cvt_pk_bf16_f32 v84, v192, v193
    v_cvt_pk_bf16_f32 v85, v194, v195
    v_cvt_pk_bf16_f32 v86, v196, v197
    v_cvt_pk_bf16_f32 v87, v198, v199
    v_xor_b32 v86, s57, v86
    v_xor_b32 v87, s57, v87
    v_cvt_pk_bf16_f32 v88, v200, v201
    v_cvt_pk_bf16_f32 v89, v202, v203
    v_cvt_pk_bf16_f32 v90, v204, v205
    v_cvt_pk_bf16_f32 v91, v206, v207
    v_xor_b32 v90, s57, v90
    v_xor_b32 v91, s57, v91
    v_cvt_pk_bf16_f32 v92, v208, v209
    v_cvt_pk_bf16_f32 v93, v210, v211
    v_cvt_pk_bf16_f32 v94, v212, v213
    v_cvt_pk_bf16_f32 v95, v214, v215
    v_xor_b32 v94, s57, v94
    v_xor_b32 v95, s57, v95
    v_cvt_pk_bf16_f32 v96, v216, v217
    v_cvt_pk_bf16_f32 v97, v218, v219
    v_cvt_pk_bf16_f32 v98, v220, v221
    v_cvt_pk_bf16_f32 v99, v222, v223
    v_xor_b32 v98, s57, v98
    v_xor_b32 v99, s57, v99
    v_permlane16_swap_b32 v84, v86
    v_permlane16_swap_b32 v85, v87
    buffer_store_dwordx4 v[84:87], v7, s[36:39], s55 offen offset:0 sc0 sc1
    v_permlane16_swap_b32 v88, v90
    v_permlane16_swap_b32 v89, v91
    buffer_store_dwordx4 v[88:91], v7, s[36:39], s55 offen offset:1024 sc0 sc1
    v_permlane16_swap_b32 v92, v94
    v_permlane16_swap_b32 v93, v95
    buffer_store_dwordx4 v[92:95], v7, s[36:39], s55 offen offset:2048 sc0 sc1
    v_permlane16_swap_b32 v96, v98
    v_permlane16_swap_b32 v97, v99
    buffer_store_dwordx4 v[96:99], v7, s[36:39], s55 offen offset:3072 sc0 sc1
    v_lshrrev_b32 v4, 5, v1
    v_lshlrev_b32 v4, 13, v4
    v_bfe_u32 v5, v1, 3, 2
    v_lshl_add_u32 v4, v5, 10, v4
    v_and_b32_e64 v5, 1, v1
    v_lshl_add_u32 v4, v5, 7, v4
    v_bfe_u32 v5, v1, 1, 2
    v_lshl_add_u32 v4, v5, 4, v4
    s_lshl_b32 s55, s89, 16
    s_lshr_b32 s40, s90, 2
    s_lshl_b32 s40, s40, 12
    s_add_u32 s55, s55, s40
    s_and_b32 s40, s90, 3
    s_lshl_b32 s40, s40, 8
    s_add_u32 s55, s55, s40
    s_lshl_b32 s40, s6, 6
    s_add_u32 s55, s55, s40
    s_add_u32 s55, s55, 13631488
    s_lshl_b32 s54, s6, 12
    s_add_u32 s54, s54, 57344
    s_waitcnt vmcnt(0)
    s_mov_b64 exec, 1
    ds_add_rtn_u32 v10, v2, v3 offset:164
    s_mov_b64 exec, -1
    s_waitcnt lgkmcnt(0)
    v_readfirstlane_b32 s40, v10
    s_nop 0
    s_cmp_eq_u32 s40, 0
    s_cbranch_scc1 k_ynp
    s_mov_b32 s56, 0x1000000
    s_atomic_add s56, s[58:59], 0
    s_atomic_add s56, s[58:59], 8192
    s_atomic_add s56, s[58:59], 16384
    s_atomic_add s56, s[58:59], 24576
    s_atomic_add s56, s[58:59], 32768
    s_atomic_add s56, s[58:59], 40960
    s_atomic_add s56, s[58:59], 49152
    s_atomic_add s56, s[58:59], 57344
k_ynp:
    s_mov_b32 s41, 2097152
lw_128:
    ds_read_b128 v[16:19], v2 offset:16
    s_waitcnt lgkmcnt(0)
    v_min_u32 v16, v16, v17
    v_min3_u32 v16, v16, v18, v19
    s_nop 0
    v_readfirstlane_b32 s40, v16
    s_nop 0
    s_cmp_ge_u32 s40, 21
    s_cbranch_scc1 lwd_129
    s_sleep 1
    s_sub_u32 s41, s41, 1
    s_cbranch_scc0 lw_128
lwd_129:
    s_mov_b32 s41, 262144
k_yp:
    s_load_dword s53, s[64:65], 128 glc
    s_waitcnt lgkmcnt(0)
    s_bitcmp1_b32 s53, 27
    s_cbranch_scc1 k_yd
    s_sleep 1
    s_sub_u32 s41, s41, 1
    s_cbranch_scc0 k_yp
k_yd:
    s_add_u32 m0, s54, 0
    s_nop 0
    buffer_load_dwordx4 v4, s[36:39], s55 offen sc1 lds
    s_add_u32 m0, s54, 1024
    s_add_u32 s55, s55, 0x4000
    buffer_load_dwordx4 v4, s[36:39], s55 offen sc1 lds
    s_add_u32 m0, s54, 2048
    s_add_u32 s55, s55, 0x4000
    buffer_load_dwordx4 v4, s[36:39], s55 offen sc1 lds
    s_add_u32 m0, s54, 3072
    s_add_u32 s55, s55, 0x4000
    buffer_load_dwordx4 v4, s[36:39], s55 offen sc1 lds
    s_branch k_fin
k_h3:
    s_mov_b32 s7, 32
    s_mov_b32 s41, 262144
    s_add_u32 s42, s5, 1
    s_mov_b32 s43, s42
    s_and_b32 s40, s2, 255
    s_lshl_b32 s40, s40, 8
    s_add_u32 s40, s40, 65536
gp_130:
    s_load_dwordx2 s[44:45], s[80:81], s40 glc
    s_waitcnt lgkmcnt(0)
    s_xor_b64 s[44:45], s[44:45], s[42:43]
    s_cbranch_scc0 gpd_131
    s_sleep 2
    s_sub_u32 s41, s41, 1
    s_cbranch_scc0 gp_130
gpd_131:
    v_mov_b32 v2, 155648
    v_lshlrev_b32 v26, 4, v1
    v_add_u32 v24, 147456, v26
    v_and_b32 v25, 3, v1
    v_lshl_add_u32 v25, v25, 2, v2
    s_lshl_b32 s49, s84, 1
    s_mul_i32 s44, s49, 86
    s_lshl1_add_u32 s44, s86, s44
    s_lshl_b32 s44, s44, 10
    s_add_u32 s44, s44, 6291456
    s_add_u32 s45, s44, 88064
    s_add_u32 s46, s44, 2818048
    s_add_u32 s47, s46, 88064
    s_bfe_u32 s40, s49, 0x20003
    s_and_b32 s41, s49, 4
    s_add_u32 s40, s40, s41
    s_and_b32 s41, s49, 3
    s_lshl3_add_u32 s48, s41, s40
    s_lshl_b32 s48, s48, 8
    s_lshr_b32 s40, s49, 5
    s_lshl2_add_u32 s48, s40, s48
    s_add_u32 s48, s48, 12648576
    s_add_u32 s58, s36, s48
    s_addc_u32 s59, s37, 0
    v_and_b32 v27, 7, v1
    v_lshlrev_b32_e64 v27, 13, v27
    v_bfe_u32 v16, v1, 3, 1
    v_lshl_add_u32 v27, v16, 11, v27
    v_bfe_u32 v16, v1, 4, 1
    v_lshl_add_u32 v27, v16, 2, v27
    v_lshrrev_b32 v8, 3, v1
    v_and_b32 v9, 7, v1
    v_bfe_u32 v10, v1, 4, 1
    v_lshlrev_b32 v10, 2, v10
    v_xor_b32 v10, v10, v9
    v_lshlrev_b32 v10, 4, v10
    v_lshl_add_u32 v28, v8, 10, v10
    s_and_b32 s40, s89, 3
    s_lshl1_add_u32 s40, s40, s90
    s_lshl_b32 s40, s40, 1
    s_and_b32 s40, s40, 15
    s_mul_i32 s41, s40, 11
    s_lshr_b32 s41, s41, 4
    s_sub_u32 s41, s41, 32
    v_add_u32 v8, s41, v1
    v_subrev_u32 v9, 11, v8
    v_min_u32 v8, v8, v9
    v_lshrrev_b32 v9, 1, v8
    v_add3_u32 v8, v8, v9, 1
    v_min_u32 v8, 15, v8
    v_add_u32 v9, s40, v1
    v_and_b32 v9, 15, v9
    v_cmp_gt_u32 vcc, 32, v1
    s_nop 1
    v_cndmask_b32 v8, v8, v9, vcc
    v_mul_u32_u24 v8, 43, v8
    v_cndmask_b32 v9, 16, 27, vcc
    v_cmp_gt_u32 vcc, 16, v1
    s_nop 1
    v_cndmask_b32 v9, v9, 0, vcc
    v_add_u32 v8, v8, v9
    v_lshrrev_b32 v29, 4, v8
    s_lshl_b32 s40, s90, 7
    v_lshlrev_b32 v29, 15, v29
    v_add_u32 v29, s40, v29
    s_lshr_b32 s40, s3, 2
    s_lshl_b32 s40, s40, 20
    s_lshr_b32 s41, s89, 3
    s_lshl_b32 s41, s41, 18
    s_add_u32 s40, s40, s41
    s_and_b32 s41, s89, 7
    s_lshl_b32 s41, s41, 12
    s_add_u32 s40, s40, s41
    s_and_b32 s41, s3, 3
    s_lshl_b32 s41, s41, 16
    s_add_u32 s40, s40, s41
    s_lshl_b32 s41, s90, 7
    s_add_u32 s91, s40, s41
    v_bfe_u32 v12, v1, 3, 2
    v_and_b32 v11, 7, v1
    v_lshlrev_b32 v11, 4, v11
    v_lshl_add_u32 v11, v12, 10, v11
    v_lshrrev_b32 v12, 5, v1
    v_lshl_add_u32 v11, v12, 15, v11
    buffer_load_dwordx4 v[12:15], v11, s[8:11], s91 offen
    s_setprio 3
    s_mov_b32 s41, 2097152
lw_132:
    ds_read_b128 v[16:19], v2 offset:112
    s_waitcnt lgkmcnt(0)
    v_min_u32 v16, v16, v17
    v_min3_u32 v16, v16, v18, v19
    s_nop 0
    v_readfirstlane_b32 s40, v16
    s_nop 0
    s_cmp_ge_u32 s40, 1
    s_cbranch_scc1 lwd_133
    s_sleep 1
    s_sub_u32 s41, s41, 1
    s_cbranch_scc0 lw_132
lwd_133:
    s_nop 0
    ds_read_b128 v[32:35], v24 offset:0
    ds_read_b128 v[36:39], v24 offset:1024
    ds_read_b128 v[40:43], v24 offset:2048
    ds_read_b128 v[44:47], v24 offset:3072
    ds_read_b128 v[48:51], v24 offset:4096
    ds_read_b128 v[52:55], v24 offset:5120
    ds_read_b128 v[56:59], v24 offset:6144
    ds_read_b128 v[60:63], v24 offset:7168
    v_mov_b32 v16, 1
    ds_write_b32 v25, v16 offset:128
    s_waitcnt lgkmcnt(7)
    buffer_store_dwordx4 v[32:35], v26, s[36:39], s44 offen offset:0 sc0 sc1
    s_waitcnt lgkmcnt(6)
    buffer_store_dwordx4 v[36:39], v26, s[36:39], s44 offen offset:1024 sc0 sc1
    s_waitcnt lgkmcnt(5)
    buffer_store_dwordx4 v[40:43], v26, s[36:39], s45 offen offset:0 sc0 sc1
    s_waitcnt lgkmcnt(4)
    buffer_store_dwordx4 v[44:47], v26, s[36:39], s45 offen offset:1024 sc0 sc1
    s_waitcnt lgkmcnt(3)
    buffer_store_dwordx4 v[48:51], v26, s[36:39], s46 offen offset:0 sc0 sc1
    s_waitcnt lgkmcnt(2)
    buffer_store_dwordx4 v[52:55], v26, s[36:39], s46 offen offset:1024 sc0 sc1
    s_waitcnt lgkmcnt(1)
    buffer_store_dwordx4 v[56:59], v26, s[36:39], s47 offen offset:0 sc0 sc1
    s_waitcnt lgkmcnt(0)
    buffer_store_dwordx4 v[60:63], v26, s[36:39], s47 offen offset:1024 sc0 sc1
    s_mov_b32 s56, 1
    s_waitcnt vmcnt(0)
    s_nop 0
    s_atomic_add s56, s[58:59], 0
    s_atomic_add s56, s[58:59], 8192
    s_atomic_add s56, s[58:59], 16384
    s_atomic_add s56, s[58:59], 24576
    s_atomic_add s56, s[58:59], 32768
    s_atomic_add s56, s[58:59], 40960
    s_atomic_add s56, s[58:59], 49152
    s_atomic_add s56, s[58:59], 57344
    s_atomic_add s56, s[58:59], 2048
    s_atomic_add s56, s[58:59], 10240
    s_atomic_add s56, s[58:59], 18432
    s_atomic_add s56, s[58:59], 26624
    s_atomic_add s56, s[58:59], 34816
    s_atomic_add s56, s[58:59], 43008
    s_atomic_add s56, s[58:59], 51200
    s_atomic_add s56, s[58:59], 59392
    s_sub_u32 s49, s87, 1
    s_lshl_b32 s49, s49, 11
    s_cmp_eq_u32 s87, 2
    s_mov_b32 s50, 0x100
    s_cmov_b32 s50, 0x20100
    s_add_u32 s44, s44, s49
    s_add_u32 s45, s45, s49
    s_add_u32 s46, s46, s49
    s_add_u32 s47, s47, s49
    s_mov_b32 s41, 2097152
lw_134:
    ds_read_b128 v[16:19], v2 offset:112
    s_waitcnt lgkmcnt(0)
    v_min_u32 v16, v16, v17
    v_min3_u32 v16, v16, v18, v19
    s_nop 0
    v_readfirstlane_b32 s40, v16
    s_nop 0
    s_cmp_ge_u32 s40, 2
    s_cbranch_scc1 lwd_135
    s_sleep 1
    s_sub_u32 s41, s41, 1
    s_cbranch_scc0 lw_134
lwd_135:
    s_nop 0
    ds_read_b128 v[32:35], v24 offset:0
    ds_read_b128 v[36:39], v24 offset:1024
    ds_read_b128 v[40:43], v24 offset:2048
    ds_read_b128 v[44:47], v24 offset:3072
    ds_read_b128 v[48:51], v24 offset:4096
    ds_read_b128 v[52:55], v24 offset:5120
    ds_read_b128 v[56:59], v24 offset:6144
    ds_read_b128 v[60:63], v24 offset:7168
    v_mov_b32 v16, 2
    ds_write_b32 v25, v16 offset:128
    s_waitcnt lgkmcnt(7)
    buffer_store_dwordx4 v[32:35], v26, s[36:39], s44 offen offset:0 sc0 sc1
    s_waitcnt lgkmcnt(6)
    buffer_store_dwordx4 v[36:39], v26, s[36:39], s44 offen offset:1024 sc0 sc1
    s_waitcnt lgkmcnt(5)
    buffer_store_dwordx4 v[40:43], v26, s[36:39], s45 offen offset:0 sc0 sc1
    s_waitcnt lgkmcnt(4)
    buffer_store_dwordx4 v[44:47], v26, s[36:39], s45 offen offset:1024 sc0 sc1
    s_waitcnt lgkmcnt(3)
    buffer_store_dwordx4 v[48:51], v26, s[36:39], s46 offen offset:0 sc0 sc1
    s_waitcnt lgkmcnt(2)
    buffer_store_dwordx4 v[52:55], v26, s[36:39], s46 offen offset:1024 sc0 sc1
    s_waitcnt lgkmcnt(1)
    buffer_store_dwordx4 v[56:59], v26, s[36:39], s47 offen offset:0 sc0 sc1
    s_waitcnt lgkmcnt(0)
    buffer_store_dwordx4 v[60:63], v26, s[36:39], s47 offen offset:1024 sc0 sc1
    s_mov_b32 s56, s50
    s_waitcnt vmcnt(0)
    s_nop 0
    s_atomic_add s56, s[58:59], 0
    s_atomic_add s56, s[58:59], 8192
    s_atomic_add s56, s[58:59], 16384
    s_atomic_add s56, s[58:59], 24576
    s_atomic_add s56, s[58:59], 32768
    s_atomic_add s56, s[58:59], 40960
    s_atomic_add s56, s[58:59], 49152
    s_atomic_add s56, s[58:59], 57344
    s_atomic_add s56, s[58:59], 2048
    s_atomic_add s56, s[58:59], 10240
    s_atomic_add s56, s[58:59], 18432
    s_atomic_add s56, s[58:59], 26624
    s_atomic_add s56, s[58:59], 34816
    s_atomic_add s56, s[58:59], 43008
    s_atomic_add s56, s[58:59], 51200
    s_atomic_add s56, s[58:59], 59392
k_h3e:
    s_mov_b32 s41, 262144
lp_136:
    s_load_dword s52, s[64:65], 128 glc
    s_waitcnt lgkmcnt(0)
    v_mov_b32 v16, s52
    ds_write_b32 v25, v16 offset:176
    s_and_b32 s52, s52, 0xffffff
    s_cmp_eq_u32 s52, 0x201010
    s_cbranch_scc1 lpd_137
    s_sub_u32 s41, s41, 1
    s_cbranch_scc0 lp_136
lpd_137:
    s_branch k_fin
k_loader:
    v_mov_b32 v2, 155648
    v_and_b32 v16, 3, v1
    v_lshl_add_u32 v16, v16, 2, v2
    v_lshrrev_b32 v8, 2, v1
    v_and_b32 v9, 3, v1
    v_lshlrev_b32 v9, 4, v9
    v_xor_b32_e64 v10, 2, v8
    v_mul_u32_u24 v8, 5504, v8
    v_mul_u32_u24 v10, 5504, v10
    v_xor_b32 v11, 32, v9
    v_add_u32 v4, v8, v9
    v_add_u32 v5, v8, v11
    v_add_u32 v6, v10, v9
    v_add_u32 v7, v10, v11
    v_lshrrev_b32 v8, 3, v1
    v_and_b32 v9, 7, v1
    v_bfe_u32 v10, v1, 4, 1
    v_lshlrev_b32 v10, 2, v10
    v_xor_b32 v10, v10, v9
    v_lshlrev_b32 v10, 4, v10
    v_lshl_add_u32 v17, v8, 10, v10
    s_add_u32 s40, s88, 0
    s_and_b32 s40, s40, 3
    s_mul_i32 s44, s40, 352256
    s_add_u32 s40, s88, 1
    s_and_b32 s40, s40, 3
    s_mul_i32 s45, s40, 352256
    s_add_u32 s40, s88, 2
    s_and_b32 s40, s40, 3
    s_mul_i32 s46, s40, 352256
    s_add_u32 s40, s88, 3
    s_and_b32 s40, s40, 3
    s_mul_i32 s47, s40, 352256
    s_and_b32 s40, s86, 1
    s_mul_i32 s48, s40, 2752
    s_sub_u32 s49, 2752, s48
    s_lshl_b32 s40, s86, 6
    s_add_u32 s48, s48, s40
    s_add_u32 s49, s49, s40
    s_lshl_b32 s50, s90, 7
    s_mov_b32 s52, 0
    s_and_b32 s40, s89, 3
    s_lshl1_add_u32 s40, s40, s90
    s_lshl_b32 s40, s40, 1
    s_and_b32 s40, s40, 15
    s_mul_i32 s41, s40, 11
    s_lshr_b32 s41, s41, 4
    s_sub_u32 s41, s41, 32
    v_add_u32 v19, s41, v1
    v_subrev_u32 v20, 11, v19
    v_min_u32 v19, v19, v20
    v_lshrrev_b32 v20, 1, v19
    v_add3_u32 v19, v19, v20, 1
    v_min_u32 v19, 15, v19
    v_add_u32 v20, s40, v1
    v_and_b32 v20, 15, v20
    v_cmp_gt_u32 vcc, 32, v1
    s_nop 1
    v_cndmask_b32 v19, v19, v20, vcc
    v_mul_u32_u24 v19, 43, v19
    v_cndmask_b32 v20, 16, 27, vcc
    v_cmp_gt_u32 vcc, 16, v1
    s_nop 1
    v_cndmask_b32 v20, v20, 0, vcc
    v_add_u32 v19, v19, v20
    v_lshrrev_b32 v18, 4, v19
    v_lshlrev_b32 v18, 15, v18
    v_add_u32 v18, s50, v18
    v_lshlrev_b32 v19, 4, v1
    s_cmp_eq_u32 s87, 2
    s_cbranch_scc1 ld2_138
    s_cmp_ge_u32 s52, 2
    s_cbranch_scc1 ldok_140
    s_mov_b32 s41, 2097152
lw_141:
    ds_read_b128 v[12:15], v2 offset:16
    s_waitcnt lgkmcnt(0)
    v_min_u32 v12, v12, v13
    v_min3_u32 v12, v12, v14, v15
    s_nop 0
    v_readfirstlane_b32 s52, v12
    s_nop 0
    s_cmp_ge_u32 s52, 2
    s_cbranch_scc1 lwd_142
    s_sleep 2
    s_sub_u32 s41, s41, 1
    s_cbranch_scc0 lw_141
lwd_142:
ldok_140:
    s_mov_b32 m0, 131072
    s_add_u32 s42, s44, s48
    buffer_load_dwordx4 v4, s[20:23], s42 offen offset:0 lds
    s_mov_b32 m0, 0
    s_add_u32 s43, s42, 64
    buffer_load_dwordx4 v4, s[20:23], s43 offen lds
    s_mov_b32 m0, 135168
    s_nop 0
    buffer_load_dwordx4 v5, s[24:27], s42 offen offset:0 lds
    s_mov_b32 m0, 4032
    s_nop 0
    buffer_load_dwordx4 v5, s[24:27], s42 offen offset:64 lds
    s_mov_b32 m0, 132096
    s_add_u32 s42, s42, 88064
    buffer_load_dwordx4 v4, s[20:23], s42 offen offset:0 lds
    s_mov_b32 m0, 960
    s_nop 0
    buffer_load_dwordx4 v4, s[20:23], s42 offen offset:64 lds
    s_mov_b32 m0, 136192
    s_nop 0
    buffer_load_dwordx4 v5, s[24:27], s42 offen offset:0 lds
    s_mov_b32 m0, 5056
    s_nop 0
    buffer_load_dwordx4 v5, s[24:27], s42 offen offset:64 lds
    s_mov_b32 m0, 133120
    s_add_u32 s42, s42, 88064
    buffer_load_dwordx4 v4, s[20:23], s42 offen offset:0 lds
    s_mov_b32 m0, 1984
    s_nop 0
    buffer_load_dwordx4 v4, s[20:23], s42 offen offset:64 lds
    s_mov_b32 m0, 137216
    s_nop 0
    buffer_load_dwordx4 v5, s[24:27], s42 offen offset:0 lds
    s_mov_b32 m0, 6080
    s_nop 0
    buffer_load_dwordx4 v5, s[24:27], s42 offen offset:64 lds
    s_mov_b32 m0, 134144
    s_add_u32 s42, s42, 88064
    buffer_load_dwordx4 v4, s[20:23], s42 offen offset:0 lds
    s_mov_b32 m0, 3008
    s_nop 0
    buffer_load_dwordx4 v4, s[20:23], s42 offen offset:64 lds
    s_mov_b32 m0, 138240
    s_nop 0
    buffer_load_dwordx4 v5, s[24:27], s42 offen offset:0 lds
    s_mov_b32 m0, 7104
    s_nop 0
    buffer_load_dwordx4 v5, s[24:27], s42 offen offset:64 lds
    s_mov_b32 m0, 32768
    s_add_u32 s42, s44, s49
    buffer_load_dwordx4 v6, s[20:23], s42 offen offset:0 lds
    s_mov_b32 m0, 36864
    s_nop 0
    buffer_load_dwordx4 v7, s[24:27], s42 offen offset:0 lds
    s_mov_b32 m0, 33792
    s_add_u32 s42, s42, 88064
    buffer_load_dwordx4 v6, s[20:23], s42 offen offset:0 lds
    s_mov_b32 m0, 37888
    s_nop 0
    buffer_load_dwordx4 v7, s[24:27], s42 offen offset:0 lds
    s_mov_b32 m0, 34816
    s_add_u32 s42, s42, 88064
    buffer_load_dwordx4 v6, s[20:23], s42 offen offset:0 lds
    s_mov_b32 m0, 38912
    s_nop 0
    buffer_load_dwordx4 v7, s[24:27], s42 offen offset:0 lds
    s_mov_b32 m0, 35840
    s_add_u32 s42, s42, 88064
    buffer_load_dwordx4 v6, s[20:23], s42 offen offset:0 lds
    s_mov_b32 m0, 39936
    s_nop 0
    buffer_load_dwordx4 v7, s[24:27], s42 offen offset:0 lds
    s_mov_b32 m0, 65536
    s_add_u32 s42, s45, s48
    buffer_load_dwordx4 v4, s[20:23], s42 offen offset:0 lds
    s_mov_b32 m0, 98240
    s_nop 0
    buffer_load_dwordx4 v4, s[20:23], s42 offen offset:64 lds
    s_mov_b32 m0, 69632
    s_nop 0
    buffer_load_dwordx4 v5, s[24:27], s42 offen offset:0 lds
    s_mov_b32 m0, 102336
    s_nop 0
    buffer_load_dwordx4 v5, s[24:27], s42 offen offset:64 lds
    s_mov_b32 m0, 66560
    s_add_u32 s42, s42, 88064
    buffer_load_dwordx4 v4, s[20:23], s42 offen offset:0 lds
    s_mov_b32 m0, 99264
    s_nop 0
    buffer_load_dwordx4 v4, s[20:23], s42 offen offset:64 lds
    s_mov_b32 m0, 70656
    s_nop 0
    buffer_load_dwordx4 v5, s[24:27], s42 offen offset:0 lds
    s_mov_b32 m0, 103360
    s_nop 0
    buffer_load_dwordx4 v5, s[24:27], s42 offen offset:64 lds
    s_mov_b32 m0, 67584
    s_add_u32 s42, s42, 88064
    buffer_load_dwordx4 v4, s[20:23], s42 offen offset:0 lds
    s_mov_b32 m0, 100288
    s_nop 0
    buffer_load_dwordx4 v4, s[20:23], s42 offen offset:64 lds
    s_mov_b32 m0, 71680
    s_nop 0
    buffer_load_dwordx4 v5, s[24:27], s42 offen offset:0 lds
    s_mov_b32 m0, 104384
    s_nop 0
    buffer_load_dwordx4 v5, s[24:27], s42 offen offset:64 lds
    s_mov_b32 m0, 68608
    s_add_u32 s42, s42, 88064
    buffer_load_dwordx4 v4, s[20:23], s42 offen offset:0 lds
    s_mov_b32 m0, 101312
    s_nop 0
    buffer_load_dwordx4 v4, s[20:23], s42 offen offset:64 lds
    s_mov_b32 m0, 72704
    s_nop 0
    buffer_load_dwordx4 v5, s[24:27], s42 offen offset:0 lds
    s_mov_b32 m0, 105408
    s_nop 0
    buffer_load_dwordx4 v5, s[24:27], s42 offen offset:64 lds
    s_waitcnt vmcnt(24)
    s_mov_b32 m0, 8192
    s_add_u32 s42, s45, s49
    buffer_load_dwordx4 v6, s[20:23], s42 offen offset:0 lds
    s_mov_b32 m0, 12288
    s_nop 0
    buffer_load_dwordx4 v7, s[24:27], s42 offen offset:0 lds
    s_mov_b32 m0, 9216
    s_add_u32 s42, s42, 88064
    buffer_load_dwordx4 v6, s[20:23], s42 offen offset:0 lds
    s_mov_b32 m0, 13312
    s_nop 0
    buffer_load_dwordx4 v7, s[24:27], s42 offen offset:0 lds
    s_mov_b32 m0, 10240
    s_add_u32 s42, s42, 88064
    buffer_load_dwordx4 v6, s[20:23], s42 offen offset:0 lds
    s_mov_b32 m0, 14336
    s_nop 0
    buffer_load_dwordx4 v7, s[24:27], s42 offen offset:0 lds
    s_mov_b32 m0, 11264
    s_add_u32 s42, s42, 88064
    buffer_load_dwordx4 v6, s[20:23], s42 offen offset:0 lds
    s_mov_b32 m0, 15360
    s_nop 0
    buffer_load_dwordx4 v7, s[24:27], s42 offen offset:0 lds
    s_waitcnt vmcnt(24)
    v_mov_b32 v3, 1
    s_mov_b64 exec, 15
    ds_max_u32 v16, v3 offset:0
    s_mov_b64 exec, -1
    s_setprio 3
    s_mov_b32 m0, 40960
    s_add_u32 s42, s46, s48
    buffer_load_dwordx4 v4, s[20:23], s42 offen offset:0 lds
    s_mov_b32 m0, 73664
    s_nop 0
    buffer_load_dwordx4 v4, s[20:23], s42 offen offset:64 lds
    s_mov_b32 m0, 45056
    s_nop 0
    buffer_load_dwordx4 v5, s[24:27], s42 offen offset:0 lds
    s_mov_b32 m0, 77760
    s_nop 0
    buffer_load_dwordx4 v5, s[24:27], s42 offen offset:64 lds
    s_mov_b32 m0, 41984
    s_add_u32 s42, s42, 88064
    buffer_load_dwordx4 v4, s[20:23], s42 offen offset:0 lds
    s_mov_b32 m0, 74688
    s_nop 0
    buffer_load_dwordx4 v4, s[20:23], s42 offen offset:64 lds
    s_mov_b32 m0, 46080
    s_nop 0
    buffer_load_dwordx4 v5, s[24:27], s42 offen offset:0 lds
    s_mov_b32 m0, 78784
    s_nop 0
    buffer_load_dwordx4 v5, s[24:27], s42 offen offset:64 lds
    s_mov_b32 m0, 43008
    s_add_u32 s42, s42, 88064
    buffer_load_dwordx4 v4, s[20:23], s42 offen offset:0 lds
    s_mov_b32 m0, 75712
    s_nop 0
    buffer_load_dwordx4 v4, s[20:23], s42 offen offset:64 lds
    s_mov_b32 m0, 47104
    s_nop 0
    buffer_load_dwordx4 v5, s[24:27], s42 offen offset:0 lds
    s_mov_b32 m0, 79808
    s_nop 0
    buffer_load_dwordx4 v5, s[24:27], s42 offen offset:64 lds
    s_mov_b32 m0, 44032
    s_add_u32 s42, s42, 88064
    buffer_load_dwordx4 v4, s[20:23], s42 offen offset:0 lds
    s_mov_b32 m0, 76736
    s_nop 0
    buffer_load_dwordx4 v4, s[20:23], s42 offen offset:64 lds
    s_mov_b32 m0, 48128
    s_nop 0
    buffer_load_dwordx4 v5, s[24:27], s42 offen offset:0 lds
    s_mov_b32 m0, 80832
    s_nop 0
    buffer_load_dwordx4 v5, s[24:27], s42 offen offset:64 lds
    s_waitcnt vmcnt(24)
    s_mov_b32 m0, 106496
    s_add_u32 s42, s46, s49
    buffer_load_dwordx4 v6, s[20:23], s42 offen offset:0 lds
    s_mov_b32 m0, 110592
    s_nop 0
    buffer_load_dwordx4 v7, s[24:27], s42 offen offset:0 lds
    s_mov_b32 m0, 107520
    s_add_u32 s42, s42, 88064
    buffer_load_dwordx4 v6, s[20:23], s42 offen offset:0 lds
    s_mov_b32 m0, 111616
    s_nop 0
    buffer_load_dwordx4 v7, s[24:27], s42 offen offset:0 lds
    s_mov_b32 m0, 108544
    s_add_u32 s42, s42, 88064
    buffer_load_dwordx4 v6, s[20:23], s42 offen offset:0 lds
    s_mov_b32 m0, 112640
    s_nop 0
    buffer_load_dwordx4 v7, s[24:27], s42 offen offset:0 lds
    s_mov_b32 m0, 109568
    s_add_u32 s42, s42, 88064
    buffer_load_dwordx4 v6, s[20:23], s42 offen offset:0 lds
    s_mov_b32 m0, 113664
    s_nop 0
    buffer_load_dwordx4 v7, s[24:27], s42 offen offset:0 lds
    s_waitcnt vmcnt(24)
    v_mov_b32 v3, 2
    s_mov_b64 exec, 15
    ds_max_u32 v16, v3 offset:0
    s_mov_b64 exec, -1
    s_cmp_ge_u32 s52, 3
    s_cbranch_scc1 ldok_143
    s_call_b64 s[54:55], k_ldprobe
    s_cmp_ge_u32 s52, 3
    s_cbranch_scc1 ldok_143
    s_waitcnt vmcnt(0)
    v_mov_b32 v3, 3
    s_mov_b64 exec, 15
    ds_max_u32 v16, v3 offset:0
    s_mov_b64 exec, -1
    s_mov_b32 s41, 2097152
lw_144:
    ds_read_b128 v[12:15], v2 offset:16
    s_waitcnt lgkmcnt(0)
    v_min_u32 v12, v12, v13
    v_min3_u32 v12, v12, v14, v15
    s_nop 0
    v_readfirstlane_b32 s52, v12
    s_nop 0
    s_cmp_ge_u32 s52, 3
    s_cbranch_scc1 lwd_145
    s_sleep 2
    s_sub_u32 s41, s41, 1
    s_cbranch_scc0 lw_144
lwd_145:
ldok_143:
    s_mov_b32 m0, 16384
    s_add_u32 s42, s47, s48
    buffer_load_dwordx4 v4, s[20:23], s42 offen offset:0 lds
    s_mov_b32 m0, 49088
    s_nop 0
    buffer_load_dwordx4 v4, s[20:23], s42 offen offset:64 lds
    s_mov_b32 m0, 20480
    s_nop 0
    buffer_load_dwordx4 v5, s[24:27], s42 offen offset:0 lds
    s_mov_b32 m0, 53184
    s_nop 0
    buffer_load_dwordx4 v5, s[24:27], s42 offen offset:64 lds
    s_mov_b32 m0, 17408
    s_add_u32 s42, s42, 88064
    buffer_load_dwordx4 v4, s[20:23], s42 offen offset:0 lds
    s_mov_b32 m0, 50112
    s_nop 0
    buffer_load_dwordx4 v4, s[20:23], s42 offen offset:64 lds
    s_mov_b32 m0, 21504
    s_nop 0
    buffer_load_dwordx4 v5, s[24:27], s42 offen offset:0 lds
    s_mov_b32 m0, 54208
    s_nop 0
    buffer_load_dwordx4 v5, s[24:27], s42 offen offset:64 lds
    s_mov_b32 m0, 18432
    s_add_u32 s42, s42, 88064
    buffer_load_dwordx4 v4, s[20:23], s42 offen offset:0 lds
    s_mov_b32 m0, 51136
    s_nop 0
    buffer_load_dwordx4 v4, s[20:23], s42 offen offset:64 lds
    s_mov_b32 m0, 22528
    s_nop 0
    buffer_load_dwordx4 v5, s[24:27], s42 offen offset:0 lds
    s_mov_b32 m0, 55232
    s_nop 0
    buffer_load_dwordx4 v5, s[24:27], s42 offen offset:64 lds
    s_mov_b32 m0, 19456
    s_add_u32 s42, s42, 88064
    buffer_load_dwordx4 v4, s[20:23], s42 offen offset:0 lds
    s_mov_b32 m0, 52160
    s_nop 0
    buffer_load_dwordx4 v4, s[20:23], s42 offen offset:64 lds
    s_mov_b32 m0, 23552
    s_nop 0
    buffer_load_dwordx4 v5, s[24:27], s42 offen offset:0 lds
    s_mov_b32 m0, 56256
    s_nop 0
    buffer_load_dwordx4 v5, s[24:27], s42 offen offset:64 lds
    s_waitcnt vmcnt(24)
    s_mov_b32 m0, 81920
    s_add_u32 s42, s47, s49
    buffer_load_dwordx4 v6, s[20:23], s42 offen offset:0 lds
    s_mov_b32 m0, 86016
    s_nop 0
    buffer_load_dwordx4 v7, s[24:27], s42 offen offset:0 lds
    s_mov_b32 m0, 82944
    s_add_u32 s42, s42, 88064
    buffer_load_dwordx4 v6, s[20:23], s42 offen offset:0 lds
    s_mov_b32 m0, 87040
    s_nop 0
    buffer_load_dwordx4 v7, s[24:27], s42 offen offset:0 lds
    s_mov_b32 m0, 83968
    s_add_u32 s42, s42, 88064
    buffer_load_dwordx4 v6, s[20:23], s42 offen offset:0 lds
    s_mov_b32 m0, 88064
    s_nop 0
    buffer_load_dwordx4 v7, s[24:27], s42 offen offset:0 lds
    s_mov_b32 m0, 84992
    s_add_u32 s42, s42, 88064
    buffer_load_dwordx4 v6, s[20:23], s42 offen offset:0 lds
    s_mov_b32 m0, 89088
    s_nop 0
    buffer_load_dwordx4 v7, s[24:27], s42 offen offset:0 lds
    s_waitcnt vmcnt(24)
    v_mov_b32 v3, 3
    s_mov_b64 exec, 15
    ds_max_u32 v16, v3 offset:0
    s_mov_b64 exec, -1
    s_cmp_ge_u32 s52, 4
    s_cbranch_scc1 ldok_146
    s_call_b64 s[54:55], k_ldprobe
    s_cmp_ge_u32 s52, 4
    s_cbranch_scc1 ldok_146
    s_waitcnt vmcnt(0)
    v_mov_b32 v3, 4
    s_mov_b64 exec, 15
    ds_max_u32 v16, v3 offset:0
    s_mov_b64 exec, -1
    s_mov_b32 s41, 2097152
lw_147:
    ds_read_b128 v[12:15], v2 offset:16
    s_waitcnt lgkmcnt(0)
    v_min_u32 v12, v12, v13
    v_min3_u32 v12, v12, v14, v15
    s_nop 0
    v_readfirstlane_b32 s52, v12
    s_nop 0
    s_cmp_ge_u32 s52, 4
    s_cbranch_scc1 lwd_148
    s_sleep 2
    s_sub_u32 s41, s41, 1
    s_cbranch_scc0 lw_147
lwd_148:
ldok_146:
    s_mov_b32 s41, 2097152
lw_149:
    ds_read_b32 v12, v2 offset:36
    s_waitcnt lgkmcnt(0)
    v_readfirstlane_b32 s40, v12
    s_nop 0
    s_cmp_ge_u32 s40, 2
    s_cbranch_scc1 lwd_150
    s_sub_u32 s41, s41, 1
    s_cbranch_scc0 lw_149
lwd_150:
    s_mov_b32 m0, 139200
    s_add_u32 s42, s44, s49
    buffer_load_dwordx4 v6, s[20:23], s42 offen offset:64 lds
    s_mov_b32 m0, 114560
    s_nop 0
    buffer_load_dwordx4 v6, s[20:23], s42 offen offset:128 lds
    s_mov_b32 m0, 143296
    s_nop 0
    buffer_load_dwordx4 v7, s[24:27], s42 offen offset:64 lds
    s_mov_b32 m0, 118656
    s_nop 0
    buffer_load_dwordx4 v7, s[24:27], s42 offen offset:128 lds
    s_mov_b32 m0, 140224
    s_add_u32 s42, s42, 88064
    buffer_load_dwordx4 v6, s[20:23], s42 offen offset:64 lds
    s_mov_b32 m0, 115584
    s_nop 0
    buffer_load_dwordx4 v6, s[20:23], s42 offen offset:128 lds
    s_mov_b32 m0, 144320
    s_nop 0
    buffer_load_dwordx4 v7, s[24:27], s42 offen offset:64 lds
    s_mov_b32 m0, 119680
    s_nop 0
    buffer_load_dwordx4 v7, s[24:27], s42 offen offset:128 lds
    s_mov_b32 m0, 141248
    s_add_u32 s42, s42, 88064
    buffer_load_dwordx4 v6, s[20:23], s42 offen offset:64 lds
    s_mov_b32 m0, 116608
    s_nop 0
    buffer_load_dwordx4 v6, s[20:23], s42 offen offset:128 lds
    s_mov_b32 m0, 145344
    s_nop 0
    buffer_load_dwordx4 v7, s[24:27], s42 offen offset:64 lds
    s_mov_b32 m0, 120704
    s_nop 0
    buffer_load_dwordx4 v7, s[24:27], s42 offen offset:128 lds
    s_mov_b32 m0, 142272
    s_add_u32 s42, s42, 88064
    buffer_load_dwordx4 v6, s[20:23], s42 offen offset:64 lds
    s_mov_b32 m0, 117632
    s_nop 0
    buffer_load_dwordx4 v6, s[20:23], s42 offen offset:128 lds
    s_mov_b32 m0, 146368
    s_nop 0
    buffer_load_dwordx4 v7, s[24:27], s42 offen offset:64 lds
    s_mov_b32 m0, 121728
    s_nop 0
    buffer_load_dwordx4 v7, s[24:27], s42 offen offset:128 lds
    s_waitcnt vmcnt(24)
    s_mov_b32 m0, 24448
    s_add_u32 s42, s44, s48
    buffer_load_dwordx4 v4, s[20:23], s42 offen offset:128 lds
    s_mov_b32 m0, 28544
    s_nop 0
    buffer_load_dwordx4 v5, s[24:27], s42 offen offset:128 lds
    s_mov_b32 m0, 25472
    s_add_u32 s42, s42, 88064
    buffer_load_dwordx4 v4, s[20:23], s42 offen offset:128 lds
    s_mov_b32 m0, 29568
    s_nop 0
    buffer_load_dwordx4 v5, s[24:27], s42 offen offset:128 lds
    s_mov_b32 m0, 26496
    s_add_u32 s42, s42, 88064
    buffer_load_dwordx4 v4, s[20:23], s42 offen offset:128 lds
    s_mov_b32 m0, 30592
    s_nop 0
    buffer_load_dwordx4 v5, s[24:27], s42 offen offset:128 lds
    s_mov_b32 m0, 27520
    s_add_u32 s42, s42, 88064
    buffer_load_dwordx4 v4, s[20:23], s42 offen offset:128 lds
    s_mov_b32 m0, 31616
    s_nop 0
    buffer_load_dwordx4 v5, s[24:27], s42 offen offset:128 lds
    s_waitcnt vmcnt(24)
    v_mov_b32 v3, 4
    s_mov_b64 exec, 15
    ds_max_u32 v16, v3 offset:0
    s_mov_b64 exec, -1
    s_mov_b32 m0, 90048
    s_add_u32 s42, s45, s49
    buffer_load_dwordx4 v6, s[20:23], s42 offen offset:64 lds
    s_mov_b32 m0, 57216
    s_nop 0
    buffer_load_dwordx4 v6, s[20:23], s42 offen offset:128 lds
    s_mov_b32 m0, 94144
    s_nop 0
    buffer_load_dwordx4 v7, s[24:27], s42 offen offset:64 lds
    s_mov_b32 m0, 61312
    s_nop 0
    buffer_load_dwordx4 v7, s[24:27], s42 offen offset:128 lds
    s_mov_b32 m0, 91072
    s_add_u32 s42, s42, 88064
    buffer_load_dwordx4 v6, s[20:23], s42 offen offset:64 lds
    s_mov_b32 m0, 58240
    s_nop 0
    buffer_load_dwordx4 v6, s[20:23], s42 offen offset:128 lds
    s_mov_b32 m0, 95168
    s_nop 0
    buffer_load_dwordx4 v7, s[24:27], s42 offen offset:64 lds
    s_mov_b32 m0, 62336
    s_nop 0
    buffer_load_dwordx4 v7, s[24:27], s42 offen offset:128 lds
    s_mov_b32 m0, 92096
    s_add_u32 s42, s42, 88064
    buffer_load_dwordx4 v6, s[20:23], s42 offen offset:64 lds
    s_mov_b32 m0, 59264
    s_nop 0
    buffer_load_dwordx4 v6, s[20:23], s42 offen offset:128 lds
    s_mov_b32 m0, 96192
    s_nop 0
    buffer_load_dwordx4 v7, s[24:27], s42 offen offset:64 lds
    s_mov_b32 m0, 63360
    s_nop 0
    buffer_load_dwordx4 v7, s[24:27], s42 offen offset:128 lds
    s_mov_b32 m0, 93120
    s_add_u32 s42, s42, 88064
    buffer_load_dwordx4 v6, s[20:23], s42 offen offset:64 lds
    s_mov_b32 m0, 60288
    s_nop 0
    buffer_load_dwordx4 v6, s[20:23], s42 offen offset:128 lds
    s_mov_b32 m0, 97216
    s_nop 0
    buffer_load_dwordx4 v7, s[24:27], s42 offen offset:64 lds
    s_mov_b32 m0, 64384
    s_nop 0
    buffer_load_dwordx4 v7, s[24:27], s42 offen offset:128 lds
    s_waitcnt vmcnt(24)
    s_mov_b32 m0, 122752
    s_add_u32 s42, s45, s48
    buffer_load_dwordx4 v4, s[20:23], s42 offen offset:128 lds
    s_mov_b32 m0, 126848
    s_nop 0
    buffer_load_dwordx4 v5, s[24:27], s42 offen offset:128 lds
    s_mov_b32 m0, 123776
    s_add_u32 s42, s42, 88064
    buffer_load_dwordx4 v4, s[20:23], s42 offen offset:128 lds
    s_mov_b32 m0, 127872
    s_nop 0
    buffer_load_dwordx4 v5, s[24:27], s42 offen offset:128 lds
    s_mov_b32 m0, 124800
    s_add_u32 s42, s42, 88064
    buffer_load_dwordx4 v4, s[20:23], s42 offen offset:128 lds
    s_mov_b32 m0, 128896
    s_nop 0
    buffer_load_dwordx4 v5, s[24:27], s42 offen offset:128 lds
    s_mov_b32 m0, 125824
    s_add_u32 s42, s42, 88064
    buffer_load_dwordx4 v4, s[20:23], s42 offen offset:128 lds
    s_mov_b32 m0, 129920
    s_nop 0
    buffer_load_dwordx4 v5, s[24:27], s42 offen offset:128 lds
    s_waitcnt vmcnt(24)
    v_mov_b32 v3, 5
    s_mov_b64 exec, 15
    ds_max_u32 v16, v3 offset:0
    s_mov_b64 exec, -1
    s_cmp_ge_u32 s52, 5
    s_cbranch_scc1 ldok_151
    s_call_b64 s[54:55], k_ldprobe
    s_cmp_ge_u32 s52, 5
    s_cbranch_scc1 ldok_151
    s_waitcnt vmcnt(0)
    v_mov_b32 v3, 6
    s_mov_b64 exec, 15
    ds_max_u32 v16, v3 offset:0
    s_mov_b64 exec, -1
    s_mov_b32 s41, 2097152
lw_152:
    ds_read_b128 v[12:15], v2 offset:16
    s_waitcnt lgkmcnt(0)
    v_min_u32 v12, v12, v13
    v_min3_u32 v12, v12, v14, v15
    s_nop 0
    v_readfirstlane_b32 s52, v12
    s_nop 0
    s_cmp_ge_u32 s52, 5
    s_cbranch_scc1 lwd_153
    s_sleep 2
    s_sub_u32 s41, s41, 1
    s_cbranch_scc0 lw_152
lwd_153:
ldok_151:
    s_mov_b32 m0, 32704
    s_add_u32 s42, s46, s49
    buffer_load_dwordx4 v6, s[20:23], s42 offen offset:64 lds
    s_mov_b32 m0, 130944
    s_nop 0
    buffer_load_dwordx4 v6, s[20:23], s42 offen offset:128 lds
    s_mov_b32 m0, 36800
    s_nop 0
    buffer_load_dwordx4 v7, s[24:27], s42 offen offset:64 lds
    s_mov_b32 m0, 135040
    s_nop 0
    buffer_load_dwordx4 v7, s[24:27], s42 offen offset:128 lds
    s_mov_b32 m0, 33728
    s_add_u32 s42, s42, 88064
    buffer_load_dwordx4 v6, s[20:23], s42 offen offset:64 lds
    s_mov_b32 m0, 131968
    s_nop 0
    buffer_load_dwordx4 v6, s[20:23], s42 offen offset:128 lds
    s_mov_b32 m0, 37824
    s_nop 0
    buffer_load_dwordx4 v7, s[24:27], s42 offen offset:64 lds
    s_mov_b32 m0, 136064
    s_nop 0
    buffer_load_dwordx4 v7, s[24:27], s42 offen offset:128 lds
    s_mov_b32 m0, 34752
    s_add_u32 s42, s42, 88064
    buffer_load_dwordx4 v6, s[20:23], s42 offen offset:64 lds
    s_mov_b32 m0, 132992
    s_nop 0
    buffer_load_dwordx4 v6, s[20:23], s42 offen offset:128 lds
    s_mov_b32 m0, 38848
    s_nop 0
    buffer_load_dwordx4 v7, s[24:27], s42 offen offset:64 lds
    s_mov_b32 m0, 137088
    s_nop 0
    buffer_load_dwordx4 v7, s[24:27], s42 offen offset:128 lds
    s_mov_b32 m0, 35776
    s_add_u32 s42, s42, 88064
    buffer_load_dwordx4 v6, s[20:23], s42 offen offset:64 lds
    s_mov_b32 m0, 134016
    s_nop 0
    buffer_load_dwordx4 v6, s[20:23], s42 offen offset:128 lds
    s_mov_b32 m0, 39872
    s_nop 0
    buffer_load_dwordx4 v7, s[24:27], s42 offen offset:64 lds
    s_mov_b32 m0, 138112
    s_nop 0
    buffer_load_dwordx4 v7, s[24:27], s42 offen offset:128 lds
    s_waitcnt vmcnt(24)
    s_cmp_ge_u32 s52, 6
    s_cbranch_scc1 ldok_154
    s_call_b64 s[54:55], k_ldprobe
    s_cmp_ge_u32 s52, 6
    s_cbranch_scc1 ldok_154
    s_waitcnt vmcnt(16)
    v_mov_b32 v3, 6
    s_mov_b64 exec, 15
    ds_max_u32 v16, v3 offset:0
    s_mov_b64 exec, -1
    s_mov_b32 s41, 2097152
lw_155:
    ds_read_b128 v[12:15], v2 offset:16
    s_waitcnt lgkmcnt(0)
    v_min_u32 v12, v12, v13
    v_min3_u32 v12, v12, v14, v15
    s_nop 0
    v_readfirstlane_b32 s52, v12
    s_nop 0
    s_cmp_ge_u32 s52, 6
    s_cbranch_scc1 lwd_156
    s_sleep 2
    s_sub_u32 s41, s41, 1
    s_cbranch_scc0 lw_155
lwd_156:
ldok_154:
    s_mov_b32 m0, 65408
    s_add_u32 s42, s46, s48
    buffer_load_dwordx4 v4, s[20:23], s42 offen offset:128 lds
    s_mov_b32 m0, 69504
    s_nop 0
    buffer_load_dwordx4 v5, s[24:27], s42 offen offset:128 lds
    s_mov_b32 m0, 66432
    s_add_u32 s42, s42, 88064
    buffer_load_dwordx4 v4, s[20:23], s42 offen offset:128 lds
    s_mov_b32 m0, 70528
    s_nop 0
    buffer_load_dwordx4 v5, s[24:27], s42 offen offset:128 lds
    s_mov_b32 m0, 67456
    s_add_u32 s42, s42, 88064
    buffer_load_dwordx4 v4, s[20:23], s42 offen offset:128 lds
    s_mov_b32 m0, 71552
    s_nop 0
    buffer_load_dwordx4 v5, s[24:27], s42 offen offset:128 lds
    s_mov_b32 m0, 68480
    s_add_u32 s42, s42, 88064
    buffer_load_dwordx4 v4, s[20:23], s42 offen offset:128 lds
    s_mov_b32 m0, 72576
    s_nop 0
    buffer_load_dwordx4 v5, s[24:27], s42 offen offset:128 lds
    s_waitcnt vmcnt(24)
    v_mov_b32 v3, 6
    s_mov_b64 exec, 15
    ds_max_u32 v16, v3 offset:0
    s_mov_b64 exec, -1
    s_cmp_ge_u32 s52, 7
    s_cbranch_scc1 ldok_157
    s_call_b64 s[54:55], k_ldprobe
    s_cmp_ge_u32 s52, 7
    s_cbranch_scc1 ldok_157
    s_waitcnt vmcnt(0)
    v_mov_b32 v3, 7
    s_mov_b64 exec, 15
    ds_max_u32 v16, v3 offset:0
    s_mov_b64 exec, -1
    s_mov_b32 s41, 2097152
lw_158:
    ds_read_b128 v[12:15], v2 offset:16
    s_waitcnt lgkmcnt(0)
    v_min_u32 v12, v12, v13
    v_min3_u32 v12, v12, v14, v15
    s_nop 0
    v_readfirstlane_b32 s52, v12
    s_nop 0
    s_cmp_ge_u32 s52, 7
    s_cbranch_scc1 lwd_159
    s_sleep 2
    s_sub_u32 s41, s41, 1
    s_cbranch_scc0 lw_158
lwd_159:
ldok_157:
    s_mov_b32 m0, 40896
    s_add_u32 s42, s47, s49
    buffer_load_dwordx4 v6, s[20:23], s42 offen offset:64 lds
    s_mov_b32 m0, 8064
    s_nop 0
    buffer_load_dwordx4 v6, s[20:23], s42 offen offset:128 lds
    s_mov_b32 m0, 44992
    s_nop 0
    buffer_load_dwordx4 v7, s[24:27], s42 offen offset:64 lds
    s_mov_b32 m0, 12160
    s_nop 0
    buffer_load_dwordx4 v7, s[24:27], s42 offen offset:128 lds
    s_mov_b32 m0, 41920
    s_add_u32 s42, s42, 88064
    buffer_load_dwordx4 v6, s[20:23], s42 offen offset:64 lds
    s_mov_b32 m0, 9088
    s_nop 0
    buffer_load_dwordx4 v6, s[20:23], s42 offen offset:128 lds
    s_mov_b32 m0, 46016
    s_nop 0
    buffer_load_dwordx4 v7, s[24:27], s42 offen offset:64 lds
    s_mov_b32 m0, 13184
    s_nop 0
    buffer_load_dwordx4 v7, s[24:27], s42 offen offset:128 lds
    s_mov_b32 m0, 42944
    s_add_u32 s42, s42, 88064
    buffer_load_dwordx4 v6, s[20:23], s42 offen offset:64 lds
    s_mov_b32 m0, 10112
    s_nop 0
    buffer_load_dwordx4 v6, s[20:23], s42 offen offset:128 lds
    s_mov_b32 m0, 47040
    s_nop 0
    buffer_load_dwordx4 v7, s[24:27], s42 offen offset:64 lds
    s_mov_b32 m0, 14208
    s_nop 0
    buffer_load_dwordx4 v7, s[24:27], s42 offen offset:128 lds
    s_mov_b32 m0, 43968
    s_add_u32 s42, s42, 88064
    buffer_load_dwordx4 v6, s[20:23], s42 offen offset:64 lds
    s_mov_b32 m0, 11136
    s_nop 0
    buffer_load_dwordx4 v6, s[20:23], s42 offen offset:128 lds
    s_mov_b32 m0, 48064
    s_nop 0
    buffer_load_dwordx4 v7, s[24:27], s42 offen offset:64 lds
    s_mov_b32 m0, 15232
    s_nop 0
    buffer_load_dwordx4 v7, s[24:27], s42 offen offset:128 lds
    s_waitcnt vmcnt(24)
    s_mov_b32 m0, 106368
    s_add_u32 s42, s47, s48
    buffer_load_dwordx4 v4, s[20:23], s42 offen offset:128 lds
    s_mov_b32 m0, 110464
    s_nop 0
    buffer_load_dwordx4 v5, s[24:27], s42 offen offset:128 lds
    s_mov_b32 m0, 107392
    s_add_u32 s42, s42, 88064
    buffer_load_dwordx4 v4, s[20:23], s42 offen offset:128 lds
    s_mov_b32 m0, 111488
    s_nop 0
    buffer_load_dwordx4 v5, s[24:27], s42 offen offset:128 lds
    s_mov_b32 m0, 108416
    s_add_u32 s42, s42, 88064
    buffer_load_dwordx4 v4, s[20:23], s42 offen offset:128 lds
    s_mov_b32 m0, 112512
    s_nop 0
    buffer_load_dwordx4 v5, s[24:27], s42 offen offset:128 lds
    s_mov_b32 m0, 109440
    s_add_u32 s42, s42, 88064
    buffer_load_dwordx4 v4, s[20:23], s42 offen offset:128 lds
    s_mov_b32 m0, 113536
    s_nop 0
    buffer_load_dwordx4 v5, s[24:27], s42 offen offset:128 lds
    s_waitcnt vmcnt(24)
    v_mov_b32 v3, 7
    s_mov_b64 exec, 15
    ds_max_u32 v16, v3 offset:0
    s_mov_b64 exec, -1
    s_branch ldw2_139
k_ldprobe:
    ds_read_b128 v[12:15], v2 offset:16
    s_waitcnt lgkmcnt(0)
    v_min_u32 v12, v12, v13
    v_min3_u32 v12, v12, v14, v15
    s_nop 0
    v_readfirstlane_b32 s52, v12
    s_nop 0
    s_setpc_b64 s[54:55]
ld2_138:
    s_cmp_ge_u32 s52, 2
    s_cbranch_scc1 ldok_160
    s_mov_b32 s41, 2097152
lw_161:
    ds_read_b128 v[12:15], v2 offset:16
    s_waitcnt lgkmcnt(0)
    v_min_u32 v12, v12, v13
    v_min3_u32 v12, v12, v14, v15
    s_nop 0
    v_readfirstlane_b32 s52, v12
    s_nop 0
    s_cmp_ge_u32 s52, 2
    s_cbranch_scc1 lwd_162
    s_sleep 2
    s_sub_u32 s41, s41, 1
    s_cbranch_scc0 lw_161
lwd_162:
ldok_160:
    s_mov_b32 m0, 131072
    s_add_u32 s42, s44, s48
    buffer_load_dwordx4 v4, s[20:23], s42 offen offset:0 lds
    s_mov_b32 m0, 135168
    s_nop 0
    buffer_load_dwordx4 v5, s[24:27], s42 offen offset:0 lds
    s_mov_b32 m0, 132096
    s_add_u32 s42, s42, 88064
    buffer_load_dwordx4 v4, s[20:23], s42 offen offset:0 lds
    s_mov_b32 m0, 136192
    s_nop 0
    buffer_load_dwordx4 v5, s[24:27], s42 offen offset:0 lds
    s_mov_b32 m0, 133120
    s_add_u32 s42, s42, 88064
    buffer_load_dwordx4 v4, s[20:23], s42 offen offset:0 lds
    s_mov_b32 m0, 137216
    s_nop 0
    buffer_load_dwordx4 v5, s[24:27], s42 offen offset:0 lds
    s_mov_b32 m0, 134144
    s_add_u32 s42, s42, 88064
    buffer_load_dwordx4 v4, s[20:23], s42 offen offset:0 lds
    s_mov_b32 m0, 138240
    s_nop 0
    buffer_load_dwordx4 v5, s[24:27], s42 offen offset:0 lds
    s_mov_b32 m0, 32768
    s_add_u32 s42, s44, s49
    buffer_load_dwordx4 v6, s[20:23], s42 offen offset:0 lds
    s_mov_b32 m0, 36864
    s_nop 0
    buffer_load_dwordx4 v7, s[24:27], s42 offen offset:0 lds
    s_mov_b32 m0, 33792
    s_add_u32 s42, s42, 88064
    buffer_load_dwordx4 v6, s[20:23], s42 offen offset:0 lds
    s_mov_b32 m0, 37888
    s_nop 0
    buffer_load_dwordx4 v7, s[24:27], s42 offen offset:0 lds
    s_mov_b32 m0, 34816
    s_add_u32 s42, s42, 88064
    buffer_load_dwordx4 v6, s[20:23], s42 offen offset:0 lds
    s_mov_b32 m0, 38912
    s_nop 0
    buffer_load_dwordx4 v7, s[24:27], s42 offen offset:0 lds
    s_mov_b32 m0, 35840
    s_add_u32 s42, s42, 88064
    buffer_load_dwordx4 v6, s[20:23], s42 offen offset:0 lds
    s_mov_b32 m0, 39936
    s_nop 0
    buffer_load_dwordx4 v7, s[24:27], s42 offen offset:0 lds
    s_mov_b32 m0, 65536
    s_add_u32 s42, s45, s48
    buffer_load_dwordx4 v4, s[20:23], s42 offen offset:0 lds
    s_mov_b32 m0, 69632
    s_nop 0
    buffer_load_dwordx4 v5, s[24:27], s42 offen offset:0 lds
    s_mov_b32 m0, 66560
    s_add_u32 s42, s42, 88064
    buffer_load_dwordx4 v4, s[20:23], s42 offen offset:0 lds
    s_mov_b32 m0, 70656
    s_nop 0
    buffer_load_dwordx4 v5, s[24:27], s42 offen offset:0 lds
    s_mov_b32 m0, 67584
    s_add_u32 s42, s42, 88064
    buffer_load_dwordx4 v4, s[20:23], s42 offen offset:0 lds
    s_mov_b32 m0, 71680
    s_nop 0
    buffer_load_dwordx4 v5, s[24:27], s42 offen offset:0 lds
    s_mov_b32 m0, 68608
    s_add_u32 s42, s42, 88064
    buffer_load_dwordx4 v4, s[20:23], s42 offen offset:0 lds
    s_mov_b32 m0, 72704
    s_nop 0
    buffer_load_dwordx4 v5, s[24:27], s42 offen offset:0 lds
    s_mov_b32 m0, 8192
    s_add_u32 s42, s45, s49
    buffer_load_dwordx4 v6, s[20:23], s42 offen offset:0 lds
    s_mov_b32 m0, 12288
    s_nop 0
    buffer_load_dwordx4 v7, s[24:27], s42 offen offset:0 lds
    s_mov_b32 m0, 9216
    s_add_u32 s42, s42, 88064
    buffer_load_dwordx4 v6, s[20:23], s42 offen offset:0 lds
    s_mov_b32 m0, 13312
    s_nop 0
    buffer_load_dwordx4 v7, s[24:27], s42 offen offset:0 lds
    s_mov_b32 m0, 10240
    s_add_u32 s42, s42, 88064
    buffer_load_dwordx4 v6, s[20:23], s42 offen offset:0 lds
    s_mov_b32 m0, 14336
    s_nop 0
    buffer_load_dwordx4 v7, s[24:27], s42 offen offset:0 lds
    s_mov_b32 m0, 11264
    s_add_u32 s42, s42, 88064
    buffer_load_dwordx4 v6, s[20:23], s42 offen offset:0 lds
    s_mov_b32 m0, 15360
    s_nop 0
    buffer_load_dwordx4 v7, s[24:27], s42 offen offset:0 lds
    s_waitcnt vmcnt(24)
    s_setprio 3
    s_mov_b32 m0, 40960
    s_add_u32 s42, s46, s48
    buffer_load_dwordx4 v4, s[20:23], s42 offen offset:0 lds
    s_mov_b32 m0, 45056
    s_nop 0
    buffer_load_dwordx4 v5, s[24:27], s42 offen offset:0 lds
    s_mov_b32 m0, 41984
    s_add_u32 s42, s42, 88064
    buffer_load_dwordx4 v4, s[20:23], s42 offen offset:0 lds
    s_mov_b32 m0, 46080
    s_nop 0
    buffer_load_dwordx4 v5, s[24:27], s42 offen offset:0 lds
    s_mov_b32 m0, 43008
    s_add_u32 s42, s42, 88064
    buffer_load_dwordx4 v4, s[20:23], s42 offen offset:0 lds
    s_mov_b32 m0, 47104
    s_nop 0
    buffer_load_dwordx4 v5, s[24:27], s42 offen offset:0 lds
    s_mov_b32 m0, 44032
    s_add_u32 s42, s42, 88064
    buffer_load_dwordx4 v4, s[20:23], s42 offen offset:0 lds
    s_mov_b32 m0, 48128
    s_nop 0
    buffer_load_dwordx4 v5, s[24:27], s42 offen offset:0 lds
    s_waitcnt vmcnt(24)
    v_mov_b32 v3, 1
    s_mov_b64 exec, 15
    ds_max_u32 v16, v3 offset:0
    s_mov_b64 exec, -1
    s_mov_b32 m0, 106496
    s_add_u32 s42, s46, s49
    buffer_load_dwordx4 v6, s[20:23], s42 offen offset:0 lds
    s_mov_b32 m0, 110592
    s_nop 0
    buffer_load_dwordx4 v7, s[24:27], s42 offen offset:0 lds
    s_mov_b32 m0, 107520
    s_add_u32 s42, s42, 88064
    buffer_load_dwordx4 v6, s[20:23], s42 offen offset:0 lds
    s_mov_b32 m0, 111616
    s_nop 0
    buffer_load_dwordx4 v7, s[24:27], s42 offen offset:0 lds
    s_mov_b32 m0, 108544
    s_add_u32 s42, s42, 88064
    buffer_load_dwordx4 v6, s[20:23], s42 offen offset:0 lds
    s_mov_b32 m0, 112640
    s_nop 0
    buffer_load_dwordx4 v7, s[24:27], s42 offen offset:0 lds
    s_mov_b32 m0, 109568
    s_add_u32 s42, s42, 88064
    buffer_load_dwordx4 v6, s[20:23], s42 offen offset:0 lds
    s_mov_b32 m0, 113664
    s_nop 0
    buffer_load_dwordx4 v7, s[24:27], s42 offen offset:0 lds
    s_waitcnt vmcnt(24)
    s_cmp_ge_u32 s52, 3
    s_cbranch_scc1 ldok_163
    s_call_b64 s[54:55], k_ldprobe
    s_cmp_ge_u32 s52, 3
    s_cbranch_scc1 ldok_163
    s_waitcnt vmcnt(16)
    v_mov_b32 v3, 2
    s_mov_b64 exec, 15
    ds_max_u32 v16, v3 offset:0
    s_mov_b64 exec, -1
    s_call_b64 s[54:55], k_ldprobe
    s_cmp_ge_u32 s52, 3
    s_cbranch_scc1 ldok_163
    s_waitcnt vmcnt(0)
    v_mov_b32 v3, 3
    s_mov_b64 exec, 15
    ds_max_u32 v16, v3 offset:0
    s_mov_b64 exec, -1
    s_mov_b32 s41, 2097152
lw_164:
    ds_read_b128 v[12:15], v2 offset:16
    s_waitcnt lgkmcnt(0)
    v_min_u32 v12, v12, v13
    v_min3_u32 v12, v12, v14, v15
    s_nop 0
    v_readfirstlane_b32 s52, v12
    s_nop 0
    s_cmp_ge_u32 s52, 3
    s_cbranch_scc1 lwd_165
    s_sleep 2
    s_sub_u32 s41, s41, 1
    s_cbranch_scc0 lw_164
lwd_165:
ldok_163:
    s_mov_b32 m0, 16384
    s_add_u32 s42, s47, s48
    buffer_load_dwordx4 v4, s[20:23], s42 offen offset:0 lds
    s_mov_b32 m0, 20480
    s_nop 0
    buffer_load_dwordx4 v5, s[24:27], s42 offen offset:0 lds
    s_mov_b32 m0, 17408
    s_add_u32 s42, s42, 88064
    buffer_load_dwordx4 v4, s[20:23], s42 offen offset:0 lds
    s_mov_b32 m0, 21504
    s_nop 0
    buffer_load_dwordx4 v5, s[24:27], s42 offen offset:0 lds
    s_mov_b32 m0, 18432
    s_add_u32 s42, s42, 88064
    buffer_load_dwordx4 v4, s[20:23], s42 offen offset:0 lds
    s_mov_b32 m0, 22528
    s_nop 0
    buffer_load_dwordx4 v5, s[24:27], s42 offen offset:0 lds
    s_mov_b32 m0, 19456
    s_add_u32 s42, s42, 88064
    buffer_load_dwordx4 v4, s[20:23], s42 offen offset:0 lds
    s_mov_b32 m0, 23552
    s_nop 0
    buffer_load_dwordx4 v5, s[24:27], s42 offen offset:0 lds
    s_waitcnt vmcnt(24)
    v_mov_b32 v3, 2
    s_mov_b64 exec, 15
    ds_max_u32 v16, v3 offset:0
    s_mov_b64 exec, -1
    s_mov_b32 m0, 81920
    s_add_u32 s42, s47, s49
    buffer_load_dwordx4 v6, s[20:23], s42 offen offset:0 lds
    s_mov_b32 m0, 86016
    s_nop 0
    buffer_load_dwordx4 v7, s[24:27], s42 offen offset:0 lds
    s_mov_b32 m0, 82944
    s_add_u32 s42, s42, 88064
    buffer_load_dwordx4 v6, s[20:23], s42 offen offset:0 lds
    s_mov_b32 m0, 87040
    s_nop 0
    buffer_load_dwordx4 v7, s[24:27], s42 offen offset:0 lds
    s_mov_b32 m0, 83968
    s_add_u32 s42, s42, 88064
    buffer_load_dwordx4 v6, s[20:23], s42 offen offset:0 lds
    s_mov_b32 m0, 88064
    s_nop 0
    buffer_load_dwordx4 v7, s[24:27], s42 offen offset:0 lds
    s_mov_b32 m0, 84992
    s_add_u32 s42, s42, 88064
    buffer_load_dwordx4 v6, s[20:23], s42 offen offset:0 lds
    s_mov_b32 m0, 89088
    s_nop 0
    buffer_load_dwordx4 v7, s[24:27], s42 offen offset:0 lds
    s_waitcnt vmcnt(24)
    s_mov_b32 s41, 2097152
lw_166:
    ds_read_b32 v12, v2 offset:36
    s_waitcnt lgkmcnt(0)
    v_readfirstlane_b32 s40, v12
    s_nop 0
    s_cmp_ge_u32 s40, 2
    s_cbranch_scc1 lwd_167
    s_sub_u32 s41, s41, 1
    s_cbranch_scc0 lw_166
lwd_167:
    s_mov_b32 m0, 114624
    s_add_u32 s42, s44, s49
    buffer_load_dwordx4 v6, s[20:23], s42 offen offset:64 lds
    s_mov_b32 m0, 118720
    s_nop 0
    buffer_load_dwordx4 v7, s[24:27], s42 offen offset:64 lds
    s_mov_b32 m0, 115648
    s_add_u32 s42, s42, 88064
    buffer_load_dwordx4 v6, s[20:23], s42 offen offset:64 lds
    s_mov_b32 m0, 119744
    s_nop 0
    buffer_load_dwordx4 v7, s[24:27], s42 offen offset:64 lds
    s_mov_b32 m0, 116672
    s_add_u32 s42, s42, 88064
    buffer_load_dwordx4 v6, s[20:23], s42 offen offset:64 lds
    s_mov_b32 m0, 120768
    s_nop 0
    buffer_load_dwordx4 v7, s[24:27], s42 offen offset:64 lds
    s_mov_b32 m0, 117696
    s_add_u32 s42, s42, 88064
    buffer_load_dwordx4 v6, s[20:23], s42 offen offset:64 lds
    s_mov_b32 m0, 121792
    s_nop 0
    buffer_load_dwordx4 v7, s[24:27], s42 offen offset:64 lds
    s_waitcnt vmcnt(24)
    v_mov_b32 v3, 3
    s_mov_b64 exec, 15
    ds_max_u32 v16, v3 offset:0
    s_mov_b64 exec, -1
    s_cmp_ge_u32 s52, 4
    s_cbranch_scc1 ldok_168
    s_call_b64 s[54:55], k_ldprobe
    s_cmp_ge_u32 s52, 4
    s_cbranch_scc1 ldok_168
    s_waitcnt vmcnt(8)
    v_mov_b32 v3, 4
    s_mov_b64 exec, 15
    ds_max_u32 v16, v3 offset:0
    s_mov_b64 exec, -1
    s_mov_b32 s41, 2097152
lw_169:
    ds_read_b128 v[12:15], v2 offset:16
    s_waitcnt lgkmcnt(0)
    v_min_u32 v12, v12, v13
    v_min3_u32 v12, v12, v14, v15
    s_nop 0
    v_readfirstlane_b32 s52, v12
    s_nop 0
    s_cmp_ge_u32 s52, 4
    s_cbranch_scc1 lwd_170
    s_sleep 2
    s_sub_u32 s41, s41, 1
    s_cbranch_scc0 lw_169
lwd_170:
ldok_168:
    s_mov_b32 m0, 24512
    s_add_u32 s42, s44, s48
    buffer_load_dwordx4 v4, s[20:23], s42 offen offset:64 lds
    s_mov_b32 m0, 28608
    s_nop 0
    buffer_load_dwordx4 v5, s[24:27], s42 offen offset:64 lds
    s_mov_b32 m0, 25536
    s_add_u32 s42, s42, 88064
    buffer_load_dwordx4 v4, s[20:23], s42 offen offset:64 lds
    s_mov_b32 m0, 29632
    s_nop 0
    buffer_load_dwordx4 v5, s[24:27], s42 offen offset:64 lds
    s_mov_b32 m0, 26560
    s_add_u32 s42, s42, 88064
    buffer_load_dwordx4 v4, s[20:23], s42 offen offset:64 lds
    s_mov_b32 m0, 30656
    s_nop 0
    buffer_load_dwordx4 v5, s[24:27], s42 offen offset:64 lds
    s_mov_b32 m0, 27584
    s_add_u32 s42, s42, 88064
    buffer_load_dwordx4 v4, s[20:23], s42 offen offset:64 lds
    s_mov_b32 m0, 31680
    s_nop 0
    buffer_load_dwordx4 v5, s[24:27], s42 offen offset:64 lds
    s_waitcnt vmcnt(24)
    s_mov_b32 m0, 57280
    s_add_u32 s42, s45, s49
    buffer_load_dwordx4 v6, s[20:23], s42 offen offset:64 lds
    s_mov_b32 m0, 61376
    s_nop 0
    buffer_load_dwordx4 v7, s[24:27], s42 offen offset:64 lds
    s_mov_b32 m0, 58304
    s_add_u32 s42, s42, 88064
    buffer_load_dwordx4 v6, s[20:23], s42 offen offset:64 lds
    s_mov_b32 m0, 62400
    s_nop 0
    buffer_load_dwordx4 v7, s[24:27], s42 offen offset:64 lds
    s_mov_b32 m0, 59328
    s_add_u32 s42, s42, 88064
    buffer_load_dwordx4 v6, s[20:23], s42 offen offset:64 lds
    s_mov_b32 m0, 63424
    s_nop 0
    buffer_load_dwordx4 v7, s[24:27], s42 offen offset:64 lds
    s_mov_b32 m0, 60352
    s_add_u32 s42, s42, 88064
    buffer_load_dwordx4 v6, s[20:23], s42 offen offset:64 lds
    s_mov_b32 m0, 64448
    s_nop 0
    buffer_load_dwordx4 v7, s[24:27], s42 offen offset:64 lds
    s_waitcnt vmcnt(24)
    v_mov_b32 v3, 4
    s_mov_b64 exec, 15
    ds_max_u32 v16, v3 offset:0
    s_mov_b64 exec, -1
    s_mov_b32 m0, 122816
    s_add_u32 s42, s45, s48
    buffer_load_dwordx4 v4, s[20:23], s42 offen offset:64 lds
    s_mov_b32 m0, 126912
    s_nop 0
    buffer_load_dwordx4 v5, s[24:27], s42 offen offset:64 lds
    s_mov_b32 m0, 123840
    s_add_u32 s42, s42, 88064
    buffer_load_dwordx4 v4, s[20:23], s42 offen offset:64 lds
    s_mov_b32 m0, 127936
    s_nop 0
    buffer_load_dwordx4 v5, s[24:27], s42 offen offset:64 lds
    s_mov_b32 m0, 124864
    s_add_u32 s42, s42, 88064
    buffer_load_dwordx4 v4, s[20:23], s42 offen offset:64 lds
    s_mov_b32 m0, 128960
    s_nop 0
    buffer_load_dwordx4 v5, s[24:27], s42 offen offset:64 lds
    s_mov_b32 m0, 125888
    s_add_u32 s42, s42, 88064
    buffer_load_dwordx4 v4, s[20:23], s42 offen offset:64 lds
    s_mov_b32 m0, 129984
    s_nop 0
    buffer_load_dwordx4 v5, s[24:27], s42 offen offset:64 lds
    s_waitcnt vmcnt(24)
    s_cmp_ge_u32 s52, 5
    s_cbranch_scc1 ldok_171
    s_call_b64 s[54:55], k_ldprobe
    s_cmp_ge_u32 s52, 5
    s_cbranch_scc1 ldok_171
    s_waitcnt vmcnt(16)
    v_mov_b32 v3, 5
    s_mov_b64 exec, 15
    ds_max_u32 v16, v3 offset:0
    s_mov_b64 exec, -1
    s_call_b64 s[54:55], k_ldprobe
    s_cmp_ge_u32 s52, 5
    s_cbranch_scc1 ldok_171
    s_waitcnt vmcnt(0)
    v_mov_b32 v3, 6
    s_mov_b64 exec, 15
    ds_max_u32 v16, v3 offset:0
    s_mov_b64 exec, -1
    s_mov_b32 s41, 2097152
lw_172:
    ds_read_b128 v[12:15], v2 offset:16
    s_waitcnt lgkmcnt(0)
    v_min_u32 v12, v12, v13
    v_min3_u32 v12, v12, v14, v15
    s_nop 0
    v_readfirstlane_b32 s52, v12
    s_nop 0
    s_cmp_ge_u32 s52, 5
    s_cbranch_scc1 lwd_173
    s_sleep 2
    s_sub_u32 s41, s41, 1
    s_cbranch_scc0 lw_172
lwd_173:
ldok_171:
    s_mov_b32 m0, 131008
    s_add_u32 s42, s46, s49
    buffer_load_dwordx4 v6, s[20:23], s42 offen offset:64 lds
    s_mov_b32 m0, 135104
    s_nop 0
    buffer_load_dwordx4 v7, s[24:27], s42 offen offset:64 lds
    s_mov_b32 m0, 132032
    s_add_u32 s42, s42, 88064
    buffer_load_dwordx4 v6, s[20:23], s42 offen offset:64 lds
    s_mov_b32 m0, 136128
    s_nop 0
    buffer_load_dwordx4 v7, s[24:27], s42 offen offset:64 lds
    s_mov_b32 m0, 133056
    s_add_u32 s42, s42, 88064
    buffer_load_dwordx4 v6, s[20:23], s42 offen offset:64 lds
    s_mov_b32 m0, 137152
    s_nop 0
    buffer_load_dwordx4 v7, s[24:27], s42 offen offset:64 lds
    s_mov_b32 m0, 134080
    s_add_u32 s42, s42, 88064
    buffer_load_dwordx4 v6, s[20:23], s42 offen offset:64 lds
    s_mov_b32 m0, 138176
    s_nop 0
    buffer_load_dwordx4 v7, s[24:27], s42 offen offset:64 lds
    s_waitcnt vmcnt(24)
    v_mov_b32 v3, 5
    s_mov_b64 exec, 15
    ds_max_u32 v16, v3 offset:0
    s_mov_b64 exec, -1
    s_cmp_ge_u32 s52, 6
    s_cbranch_scc1 ldok_174
    s_call_b64 s[54:55], k_ldprobe
    s_cmp_ge_u32 s52, 6
    s_cbranch_scc1 ldok_174
    s_waitcnt vmcnt(8)
    v_mov_b32 v3, 6
    s_mov_b64 exec, 15
    ds_max_u32 v16, v3 offset:0
    s_mov_b64 exec, -1
    s_mov_b32 s41, 2097152
lw_175:
    ds_read_b128 v[12:15], v2 offset:16
    s_waitcnt lgkmcnt(0)
    v_min_u32 v12, v12, v13
    v_min3_u32 v12, v12, v14, v15
    s_nop 0
    v_readfirstlane_b32 s52, v12
    s_nop 0
    s_cmp_ge_u32 s52, 6
    s_cbranch_scc1 lwd_176
    s_sleep 2
    s_sub_u32 s41, s41, 1
    s_cbranch_scc0 lw_175
lwd_176:
ldok_174:
    s_mov_b32 m0, 65472
    s_add_u32 s42, s46, s48
    buffer_load_dwordx4 v4, s[20:23], s42 offen offset:64 lds
    s_mov_b32 m0, 69568
    s_nop 0
    buffer_load_dwordx4 v5, s[24:27], s42 offen offset:64 lds
    s_mov_b32 m0, 66496
    s_add_u32 s42, s42, 88064
    buffer_load_dwordx4 v4, s[20:23], s42 offen offset:64 lds
    s_mov_b32 m0, 70592
    s_nop 0
    buffer_load_dwordx4 v5, s[24:27], s42 offen offset:64 lds
    s_mov_b32 m0, 67520
    s_add_u32 s42, s42, 88064
    buffer_load_dwordx4 v4, s[20:23], s42 offen offset:64 lds
    s_mov_b32 m0, 71616
    s_nop 0
    buffer_load_dwordx4 v5, s[24:27], s42 offen offset:64 lds
    s_mov_b32 m0, 68544
    s_add_u32 s42, s42, 88064
    buffer_load_dwordx4 v4, s[20:23], s42 offen offset:64 lds
    s_mov_b32 m0, 72640
    s_nop 0
    buffer_load_dwordx4 v5, s[24:27], s42 offen offset:64 lds
    s_waitcnt vmcnt(24)
    s_mov_b32 m0, 8128
    s_add_u32 s42, s47, s49
    buffer_load_dwordx4 v6, s[20:23], s42 offen offset:64 lds
    s_mov_b32 m0, 12224
    s_nop 0
    buffer_load_dwordx4 v7, s[24:27], s42 offen offset:64 lds
    s_mov_b32 m0, 9152
    s_add_u32 s42, s42, 88064
    buffer_load_dwordx4 v6, s[20:23], s42 offen offset:64 lds
    s_mov_b32 m0, 13248
    s_nop 0
    buffer_load_dwordx4 v7, s[24:27], s42 offen offset:64 lds
    s_mov_b32 m0, 10176
    s_add_u32 s42, s42, 88064
    buffer_load_dwordx4 v6, s[20:23], s42 offen offset:64 lds
    s_mov_b32 m0, 14272
    s_nop 0
    buffer_load_dwordx4 v7, s[24:27], s42 offen offset:64 lds
    s_mov_b32 m0, 11200
    s_add_u32 s42, s42, 88064
    buffer_load_dwordx4 v6, s[20:23], s42 offen offset:64 lds
    s_mov_b32 m0, 15296
    s_nop 0
    buffer_load_dwordx4 v7, s[24:27], s42 offen offset:64 lds
    s_waitcnt vmcnt(24)
    v_mov_b32 v3, 6
    s_mov_b64 exec, 15
    ds_max_u32 v16, v3 offset:0
    s_mov_b64 exec, -1
    s_cmp_ge_u32 s52, 7
    s_cbranch_scc1 ldok_177
    s_call_b64 s[54:55], k_ldprobe
    s_cmp_ge_u32 s52, 7
    s_cbranch_scc1 ldok_177
    s_waitcnt vmcnt(8)
    v_mov_b32 v3, 7
    s_mov_b64 exec, 15
    ds_max_u32 v16, v3 offset:0
    s_mov_b64 exec, -1
    s_mov_b32 s41, 2097152
lw_178:
    ds_read_b128 v[12:15], v2 offset:16
    s_waitcnt lgkmcnt(0)
    v_min_u32 v12, v12, v13
    v_min3_u32 v12, v12, v14, v15
    s_nop 0
    v_readfirstlane_b32 s52, v12
    s_nop 0
    s_cmp_ge_u32 s52, 7
    s_cbranch_scc1 lwd_179
    s_sleep 2
    s_sub_u32 s41, s41, 1
    s_cbranch_scc0 lw_178
lwd_179:
ldok_177:
    s_mov_b32 m0, 106432
    s_add_u32 s42, s47, s48
    buffer_load_dwordx4 v4, s[20:23], s42 offen offset:64 lds
    s_mov_b32 m0, 110528
    s_nop 0
    buffer_load_dwordx4 v5, s[24:27], s42 offen offset:64 lds
    s_mov_b32 m0, 107456
    s_add_u32 s42, s42, 88064
    buffer_load_dwordx4 v4, s[20:23], s42 offen offset:64 lds
    s_mov_b32 m0, 111552
    s_nop 0
    buffer_load_dwordx4 v5, s[24:27], s42 offen offset:64 lds
    s_mov_b32 m0, 108480
    s_add_u32 s42, s42, 88064
    buffer_load_dwordx4 v4, s[20:23], s42 offen offset:64 lds
    s_mov_b32 m0, 112576
    s_nop 0
    buffer_load_dwordx4 v5, s[24:27], s42 offen offset:64 lds
    s_mov_b32 m0, 109504
    s_add_u32 s42, s42, 88064
    buffer_load_dwordx4 v4, s[20:23], s42 offen offset:64 lds
    s_mov_b32 m0, 113600
    s_nop 0
    buffer_load_dwordx4 v5, s[24:27], s42 offen offset:64 lds
    s_waitcnt vmcnt(24)
    s_waitcnt vmcnt(16)
    v_mov_b32 v3, 7
    s_mov_b64 exec, 15
    ds_max_u32 v16, v3 offset:0
    s_mov_b64 exec, -1
ldw2_139:
    v_lshlrev_b32 v19, 4, v1
    v_readlane_b32 s44, v18, 0
    v_readlane_b32 s45, v18, 1
    s_nop 1
    s_cmp_ge_u32 s52, 8
    s_cbranch_scc1 ldok_180
    s_call_b64 s[54:55], k_ldprobe
    s_cmp_ge_u32 s52, 8
    s_cbranch_scc1 ldok_180
    s_waitcnt vmcnt(0)
    v_mov_b32 v3, 8
    s_mov_b64 exec, 15
    ds_max_u32 v16, v3 offset:0
    s_mov_b64 exec, -1
    s_mov_b32 s41, 2097152
lw_181:
    ds_read_b128 v[12:15], v2 offset:16
    s_waitcnt lgkmcnt(0)
    v_min_u32 v12, v12, v13
    v_min3_u32 v12, v12, v14, v15
    s_nop 0
    v_readfirstlane_b32 s52, v12
    s_nop 0
    s_cmp_ge_u32 s52, 8
    s_cbranch_scc1 lwd_182
    s_sleep 2
    s_sub_u32 s41, s41, 1
    s_cbranch_scc0 lw_181
lwd_182:
ldok_180:
    s_mov_b32 m0, 16384
    s_nop 0
    s_nop 0
    buffer_load_dwordx4 v17, s[28:31], s44 offen lds
    s_mov_b32 m0, 17408
    s_add_u32 s44, s44, 8192
    buffer_load_dwordx4 v17, s[28:31], s44 offen lds
    s_mov_b32 m0, 18432
    s_add_u32 s44, s44, 8192
    buffer_load_dwordx4 v17, s[28:31], s44 offen lds
    s_mov_b32 m0, 19456
    s_add_u32 s44, s44, 8192
    buffer_load_dwordx4 v17, s[28:31], s44 offen lds
    s_mov_b32 m0, 20480
    s_nop 0
    s_nop 0
    buffer_load_dwordx4 v17, s[28:31], s45 offen lds
    s_mov_b32 m0, 21504
    s_add_u32 s45, s45, 8192
    buffer_load_dwordx4 v17, s[28:31], s45 offen lds
    s_mov_b32 m0, 22528
    s_add_u32 s45, s45, 8192
    buffer_load_dwordx4 v17, s[28:31], s45 offen lds
    s_mov_b32 m0, 23552
    s_add_u32 s45, s45, 8192
    buffer_load_dwordx4 v17, s[28:31], s45 offen lds
    s_waitcnt vmcnt(8)
    v_mov_b32 v3, 8
    s_mov_b64 exec, 15
    ds_max_u32 v16, v3 offset:0
    s_mov_b64 exec, -1
    v_readlane_b32 s44, v18, 2
    v_readlane_b32 s45, v18, 3
    s_nop 1
    s_mov_b32 m0, 81920
    s_nop 0
    buffer_load_dwordx4 v17, s[28:31], s44 offen lds
    s_mov_b32 m0, 82944
    s_add_u32 s44, s44, 8192
    buffer_load_dwordx4 v17, s[28:31], s44 offen lds
    s_mov_b32 m0, 83968
    s_add_u32 s44, s44, 8192
    buffer_load_dwordx4 v17, s[28:31], s44 offen lds
    s_mov_b32 m0, 84992
    s_add_u32 s44, s44, 8192
    buffer_load_dwordx4 v17, s[28:31], s44 offen lds
    s_mov_b32 m0, 86016
    s_nop 0
    s_nop 0
    buffer_load_dwordx4 v17, s[28:31], s45 offen lds
    s_mov_b32 m0, 87040
    s_add_u32 s45, s45, 8192
    buffer_load_dwordx4 v17, s[28:31], s45 offen lds
    s_mov_b32 m0, 88064
    s_add_u32 s45, s45, 8192
    buffer_load_dwordx4 v17, s[28:31], s45 offen lds
    s_mov_b32 m0, 89088
    s_add_u32 s45, s45, 8192
    buffer_load_dwordx4 v17, s[28:31], s45 offen lds
    v_readlane_b32 s44, v18, 4
    v_readlane_b32 s45, v18, 5
    s_nop 1
    s_cmp_ge_u32 s52, 9
    s_cbranch_scc1 ldok_183
    s_call_b64 s[54:55], k_ldprobe
    s_cmp_ge_u32 s52, 9
    s_cbranch_scc1 ldok_183
    s_waitcnt vmcnt(8)
    v_mov_b32 v3, 1
    s_mov_b64 exec, 15
    ds_max_u32 v16, v3 offset:64
    s_mov_b64 exec, -1
    s_call_b64 s[54:55], k_ldprobe
    s_cmp_ge_u32 s52, 9
    s_cbranch_scc1 ldok_183
    s_waitcnt vmcnt(0)
    v_mov_b32 v3, 2
    s_mov_b64 exec, 15
    ds_max_u32 v16, v3 offset:64
    s_mov_b64 exec, -1
    s_mov_b32 s41, 2097152
lw_184:
    ds_read_b128 v[12:15], v2 offset:16
    s_waitcnt lgkmcnt(0)
    v_min_u32 v12, v12, v13
    v_min3_u32 v12, v12, v14, v15
    s_nop 0
    v_readfirstlane_b32 s52, v12
    s_nop 0
    s_cmp_ge_u32 s52, 9
    s_cbranch_scc1 lwd_185
    s_sleep 2
    s_sub_u32 s41, s41, 1
    s_cbranch_scc0 lw_184
lwd_185:
ldok_183:
    s_mov_b32 m0, 114688
    s_nop 0
    buffer_load_dwordx4 v17, s[28:31], s44 offen lds
    s_mov_b32 m0, 115712
    s_add_u32 s44, s44, 8192
    buffer_load_dwordx4 v17, s[28:31], s44 offen lds
    s_mov_b32 m0, 116736
    s_add_u32 s44, s44, 8192
    buffer_load_dwordx4 v17, s[28:31], s44 offen lds
    s_mov_b32 m0, 117760
    s_add_u32 s44, s44, 8192
    buffer_load_dwordx4 v17, s[28:31], s44 offen lds
    s_mov_b32 m0, 118784
    s_nop 0
    s_nop 0
    buffer_load_dwordx4 v17, s[28:31], s45 offen lds
    s_mov_b32 m0, 119808
    s_add_u32 s45, s45, 8192
    buffer_load_dwordx4 v17, s[28:31], s45 offen lds
    s_mov_b32 m0, 120832
    s_add_u32 s45, s45, 8192
    buffer_load_dwordx4 v17, s[28:31], s45 offen lds
    s_mov_b32 m0, 121856
    s_add_u32 s45, s45, 8192
    buffer_load_dwordx4 v17, s[28:31], s45 offen lds
    s_waitcnt vmcnt(16)
    v_mov_b32 v3, 1
    s_mov_b64 exec, 15
    ds_max_u32 v16, v3 offset:64
    s_mov_b64 exec, -1
    v_readlane_b32 s44, v18, 6
    v_readlane_b32 s45, v18, 7
    s_nop 1
    s_mov_b32 m0, 24576
    s_nop 0
    buffer_load_dwordx4 v17, s[28:31], s44 offen lds
    s_mov_b32 m0, 25600
    s_add_u32 s44, s44, 8192
    buffer_load_dwordx4 v17, s[28:31], s44 offen lds
    s_mov_b32 m0, 26624
    s_add_u32 s44, s44, 8192
    buffer_load_dwordx4 v17, s[28:31], s44 offen lds
    s_mov_b32 m0, 27648
    s_add_u32 s44, s44, 8192
    buffer_load_dwordx4 v17, s[28:31], s44 offen lds
    s_mov_b32 m0, 28672
    s_nop 0
    s_nop 0
    buffer_load_dwordx4 v17, s[28:31], s45 offen lds
    s_mov_b32 m0, 29696
    s_add_u32 s45, s45, 8192
    buffer_load_dwordx4 v17, s[28:31], s45 offen lds
    s_mov_b32 m0, 30720
    s_add_u32 s45, s45, 8192
    buffer_load_dwordx4 v17, s[28:31], s45 offen lds
    s_mov_b32 m0, 31744
    s_add_u32 s45, s45, 8192
    buffer_load_dwordx4 v17, s[28:31], s45 offen lds
    s_waitcnt vmcnt(16)
    v_mov_b32 v3, 2
    s_mov_b64 exec, 15
    ds_max_u32 v16, v3 offset:64
    s_mov_b64 exec, -1
    v_readlane_b32 s44, v18, 8
    v_readlane_b32 s45, v18, 9
    s_nop 1
    s_cmp_ge_u32 s52, 10
    s_cbranch_scc1 ldok_186
    s_call_b64 s[54:55], k_ldprobe
    s_cmp_ge_u32 s52, 10
    s_cbranch_scc1 ldok_186
    s_waitcnt vmcnt(8)
    v_mov_b32 v3, 3
    s_mov_b64 exec, 15
    ds_max_u32 v16, v3 offset:64
    s_mov_b64 exec, -1
    s_call_b64 s[54:55], k_ldprobe
    s_cmp_ge_u32 s52, 10
    s_cbranch_scc1 ldok_186
    s_waitcnt vmcnt(0)
    v_mov_b32 v3, 4
    s_mov_b64 exec, 15
    ds_max_u32 v16, v3 offset:64
    s_mov_b64 exec, -1
    s_mov_b32 s41, 2097152
lw_187:
    ds_read_b128 v[12:15], v2 offset:16
    s_waitcnt lgkmcnt(0)
    v_min_u32 v12, v12, v13
    v_min3_u32 v12, v12, v14, v15
    s_nop 0
    v_readfirstlane_b32 s52, v12
    s_nop 0
    s_cmp_ge_u32 s52, 10
    s_cbranch_scc1 lwd_188
    s_sleep 2
    s_sub_u32 s41, s41, 1
    s_cbranch_scc0 lw_187
lwd_188:
ldok_186:
    s_mov_b32 m0, 57344
    s_nop 0
    buffer_load_dwordx4 v17, s[28:31], s44 offen lds
    s_mov_b32 m0, 58368
    s_add_u32 s44, s44, 8192
    buffer_load_dwordx4 v17, s[28:31], s44 offen lds
    s_mov_b32 m0, 59392
    s_add_u32 s44, s44, 8192
    buffer_load_dwordx4 v17, s[28:31], s44 offen lds
    s_mov_b32 m0, 60416
    s_add_u32 s44, s44, 8192
    buffer_load_dwordx4 v17, s[28:31], s44 offen lds
    s_mov_b32 m0, 61440
    s_nop 0
    s_nop 0
    buffer_load_dwordx4 v17, s[28:31], s45 offen lds
    s_mov_b32 m0, 62464
    s_add_u32 s45, s45, 8192
    buffer_load_dwordx4 v17, s[28:31], s45 offen lds
    s_mov_b32 m0, 63488
    s_add_u32 s45, s45, 8192
    buffer_load_dwordx4 v17, s[28:31], s45 offen lds
    s_mov_b32 m0, 64512
    s_add_u32 s45, s45, 8192
    buffer_load_dwordx4 v17, s[28:31], s45 offen lds
    s_waitcnt vmcnt(16)
    v_mov_b32 v3, 3
    s_mov_b64 exec, 15
    ds_max_u32 v16, v3 offset:64
    s_mov_b64 exec, -1
    v_readlane_b32 s44, v18, 10
    v_readlane_b32 s45, v18, 11
    s_nop 1
    s_mov_b32 m0, 122880
    s_nop 0
    buffer_load_dwordx4 v17, s[28:31], s44 offen lds
    s_mov_b32 m0, 123904
    s_add_u32 s44, s44, 8192
    buffer_load_dwordx4 v17, s[28:31], s44 offen lds
    s_mov_b32 m0, 124928
    s_add_u32 s44, s44, 8192
    buffer_load_dwordx4 v17, s[28:31], s44 offen lds
    s_mov_b32 m0, 125952
    s_add_u32 s44, s44, 8192
    buffer_load_dwordx4 v17, s[28:31], s44 offen lds
    s_mov_b32 m0, 126976
    s_nop 0
    s_nop 0
    buffer_load_dwordx4 v17, s[28:31], s45 offen lds
    s_mov_b32 m0, 128000
    s_add_u32 s45, s45, 8192
    buffer_load_dwordx4 v17, s[28:31], s45 offen lds
    s_mov_b32 m0, 129024
    s_add_u32 s45, s45, 8192
    buffer_load_dwordx4 v17, s[28:31], s45 offen lds
    s_mov_b32 m0, 130048
    s_add_u32 s45, s45, 8192
    buffer_load_dwordx4 v17, s[28:31], s45 offen lds
    s_waitcnt vmcnt(16)
    v_mov_b32 v3, 4
    s_mov_b64 exec, 15
    ds_max_u32 v16, v3 offset:64
    s_mov_b64 exec, -1
    v_readlane_b32 s44, v18, 12
    v_readlane_b32 s45, v18, 13
    s_nop 1
    s_cmp_ge_u32 s52, 11
    s_cbranch_scc1 ldok_189
    s_call_b64 s[54:55], k_ldprobe
    s_cmp_ge_u32 s52, 11
    s_cbranch_scc1 ldok_189
    s_waitcnt vmcnt(8)
    v_mov_b32 v3, 5
    s_mov_b64 exec, 15
    ds_max_u32 v16, v3 offset:64
    s_mov_b64 exec, -1
    s_call_b64 s[54:55], k_ldprobe
    s_cmp_ge_u32 s52, 11
    s_cbranch_scc1 ldok_189
    s_waitcnt vmcnt(0)
    v_mov_b32 v3, 6
    s_mov_b64 exec, 15
    ds_max_u32 v16, v3 offset:64
    s_mov_b64 exec, -1
    s_mov_b32 s41, 2097152
lw_190:
    ds_read_b128 v[12:15], v2 offset:16
    s_waitcnt lgkmcnt(0)
    v_min_u32 v12, v12, v13
    v_min3_u32 v12, v12, v14, v15
    s_nop 0
    v_readfirstlane_b32 s52, v12
    s_nop 0
    s_cmp_ge_u32 s52, 11
    s_cbranch_scc1 lwd_191
    s_sleep 2
    s_sub_u32 s41, s41, 1
    s_cbranch_scc0 lw_190
lwd_191:
ldok_189:
    s_mov_b32 m0, 131072
    s_nop 0
    buffer_load_dwordx4 v17, s[28:31], s44 offen lds
    s_mov_b32 m0, 132096
    s_add_u32 s44, s44, 8192
    buffer_load_dwordx4 v17, s[28:31], s44 offen lds
    s_mov_b32 m0, 133120
    s_add_u32 s44, s44, 8192
    buffer_load_dwordx4 v17, s[28:31], s44 offen lds
    s_mov_b32 m0, 134144
    s_add_u32 s44, s44, 8192
    buffer_load_dwordx4 v17, s[28:31], s44 offen lds
    s_mov_b32 m0, 135168
    s_nop 0
    s_nop 0
    buffer_load_dwordx4 v17, s[28:31], s45 offen lds
    s_mov_b32 m0, 136192
    s_add_u32 s45, s45, 8192
    buffer_load_dwordx4 v17, s[28:31], s45 offen lds
    s_mov_b32 m0, 137216
    s_add_u32 s45, s45, 8192
    buffer_load_dwordx4 v17, s[28:31], s45 offen lds
    s_mov_b32 m0, 138240
    s_add_u32 s45, s45, 8192
    buffer_load_dwordx4 v17, s[28:31], s45 offen lds
    s_waitcnt vmcnt(16)
    v_mov_b32 v3, 5
    s_mov_b64 exec, 15
    ds_max_u32 v16, v3 offset:64
    s_mov_b64 exec, -1
    v_readlane_b32 s44, v18, 14
    v_readlane_b32 s45, v18, 15
    s_nop 1
    s_mov_b32 m0, 65536
    s_nop 0
    buffer_load_dwordx4 v17, s[28:31], s44 offen lds
    s_mov_b32 m0, 66560
    s_add_u32 s44, s44, 8192
    buffer_load_dwordx4 v17, s[28:31], s44 offen lds
    s_mov_b32 m0, 67584
    s_add_u32 s44, s44, 8192
    buffer_load_dwordx4 v17, s[28:31], s44 offen lds
    s_mov_b32 m0, 68608
    s_add_u32 s44, s44, 8192
    buffer_load_dwordx4 v17, s[28:31], s44 offen lds
    s_mov_b32 m0, 69632
    s_nop 0
    s_nop 0
    buffer_load_dwordx4 v17, s[28:31], s45 offen lds
    s_mov_b32 m0, 70656
    s_add_u32 s45, s45, 8192
    buffer_load_dwordx4 v17, s[28:31], s45 offen lds
    s_mov_b32 m0, 71680
    s_add_u32 s45, s45, 8192
    buffer_load_dwordx4 v17, s[28:31], s45 offen lds
    s_mov_b32 m0, 72704
    s_add_u32 s45, s45, 8192
    buffer_load_dwordx4 v17, s[28:31], s45 offen lds
    s_waitcnt vmcnt(16)
    v_mov_b32 v3, 6
    s_mov_b64 exec, 15
    ds_max_u32 v16, v3 offset:64
    s_mov_b64 exec, -1
    v_readlane_b32 s44, v18, 16
    v_readlane_b32 s45, v18, 17
    s_nop 1
    s_cmp_ge_u32 s52, 12
    s_cbranch_scc1 ldok_192
    s_call_b64 s[54:55], k_ldprobe
    s_cmp_ge_u32 s52, 12
    s_cbranch_scc1 ldok_192
    s_waitcnt vmcnt(8)
    v_mov_b32 v3, 7
    s_mov_b64 exec, 15
    ds_max_u32 v16, v3 offset:64
    s_mov_b64 exec, -1
    s_call_b64 s[54:55], k_ldprobe
    s_cmp_ge_u32 s52, 12
    s_cbranch_scc1 ldok_192
    s_waitcnt vmcnt(0)
    v_mov_b32 v3, 8
    s_mov_b64 exec, 15
    ds_max_u32 v16, v3 offset:64
    s_mov_b64 exec, -1
    s_mov_b32 s41, 2097152
lw_193:
    ds_read_b128 v[12:15], v2 offset:16
    s_waitcnt lgkmcnt(0)
    v_min_u32 v12, v12, v13
    v_min3_u32 v12, v12, v14, v15
    s_nop 0
    v_readfirstlane_b32 s52, v12
    s_nop 0
    s_cmp_ge_u32 s52, 12
    s_cbranch_scc1 lwd_194
    s_sleep 2
    s_sub_u32 s41, s41, 1
    s_cbranch_scc0 lw_193
lwd_194:
ldok_192:
    s_mov_b32 m0, 8192
    s_nop 0
    buffer_load_dwordx4 v17, s[28:31], s44 offen lds
    s_mov_b32 m0, 9216
    s_add_u32 s44, s44, 8192
    buffer_load_dwordx4 v17, s[28:31], s44 offen lds
    s_mov_b32 m0, 10240
    s_add_u32 s44, s44, 8192
    buffer_load_dwordx4 v17, s[28:31], s44 offen lds
    s_mov_b32 m0, 11264
    s_add_u32 s44, s44, 8192
    buffer_load_dwordx4 v17, s[28:31], s44 offen lds
    s_mov_b32 m0, 12288
    s_nop 0
    s_nop 0
    buffer_load_dwordx4 v17, s[28:31], s45 offen lds
    s_mov_b32 m0, 13312
    s_add_u32 s45, s45, 8192
    buffer_load_dwordx4 v17, s[28:31], s45 offen lds
    s_mov_b32 m0, 14336
    s_add_u32 s45, s45, 8192
    buffer_load_dwordx4 v17, s[28:31], s45 offen lds
    s_mov_b32 m0, 15360
    s_add_u32 s45, s45, 8192
    buffer_load_dwordx4 v17, s[28:31], s45 offen lds
    s_waitcnt vmcnt(16)
    v_mov_b32 v3, 7
    s_mov_b64 exec, 15
    ds_max_u32 v16, v3 offset:64
    s_mov_b64 exec, -1
    v_readlane_b32 s44, v18, 18
    v_readlane_b32 s45, v18, 19
    s_nop 1
    s_mov_b32 m0, 106496
    s_nop 0
    buffer_load_dwordx4 v17, s[28:31], s44 offen lds
    s_mov_b32 m0, 107520
    s_add_u32 s44, s44, 8192
    buffer_load_dwordx4 v17, s[28:31], s44 offen lds
    s_mov_b32 m0, 108544
    s_add_u32 s44, s44, 8192
    buffer_load_dwordx4 v17, s[28:31], s44 offen lds
    s_mov_b32 m0, 109568
    s_add_u32 s44, s44, 8192
    buffer_load_dwordx4 v17, s[28:31], s44 offen lds
    s_mov_b32 m0, 110592
    s_nop 0
    s_nop 0
    buffer_load_dwordx4 v17, s[28:31], s45 offen lds
    s_mov_b32 m0, 111616
    s_add_u32 s45, s45, 8192
    buffer_load_dwordx4 v17, s[28:31], s45 offen lds
    s_mov_b32 m0, 112640
    s_add_u32 s45, s45, 8192
    buffer_load_dwordx4 v17, s[28:31], s45 offen lds
    s_mov_b32 m0, 113664
    s_add_u32 s45, s45, 8192
    buffer_load_dwordx4 v17, s[28:31], s45 offen lds
    s_waitcnt vmcnt(16)
    v_mov_b32 v3, 8
    s_mov_b64 exec, 15
    ds_max_u32 v16, v3 offset:64
    s_mov_b64 exec, -1
    v_readlane_b32 s44, v18, 20
    v_readlane_b32 s45, v18, 21
    s_nop 1
    s_cmp_ge_u32 s52, 13
    s_cbranch_scc1 ldok_195
    s_call_b64 s[54:55], k_ldprobe
    s_cmp_ge_u32 s52, 13
    s_cbranch_scc1 ldok_195
    s_waitcnt vmcnt(8)
    v_mov_b32 v3, 9
    s_mov_b64 exec, 15
    ds_max_u32 v16, v3 offset:64
    s_mov_b64 exec, -1
    s_call_b64 s[54:55], k_ldprobe
    s_cmp_ge_u32 s52, 13
    s_cbranch_scc1 ldok_195
    s_waitcnt vmcnt(0)
    v_mov_b32 v3, 10
    s_mov_b64 exec, 15
    ds_max_u32 v16, v3 offset:64
    s_mov_b64 exec, -1
    s_mov_b32 s41, 2097152
lw_196:
    ds_read_b128 v[12:15], v2 offset:16
    s_waitcnt lgkmcnt(0)
    v_min_u32 v12, v12, v13
    v_min3_u32 v12, v12, v14, v15
    s_nop 0
    v_readfirstlane_b32 s52, v12
    s_nop 0
    s_cmp_ge_u32 s52, 13
    s_cbranch_scc1 lwd_197
    s_sleep 2
    s_sub_u32 s41, s41, 1
    s_cbranch_scc0 lw_196
lwd_197:
ldok_195:
    s_mov_b32 m0, 0
    s_nop 0
    s_nop 0
    buffer_load_dwordx4 v17, s[28:31], s44 offen lds
    s_mov_b32 m0, 1024
    s_add_u32 s44, s44, 8192
    buffer_load_dwordx4 v17, s[28:31], s44 offen lds
    s_mov_b32 m0, 2048
    s_add_u32 s44, s44, 8192
    buffer_load_dwordx4 v17, s[28:31], s44 offen lds
    s_mov_b32 m0, 3072
    s_add_u32 s44, s44, 8192
    buffer_load_dwordx4 v17, s[28:31], s44 offen lds
    s_mov_b32 m0, 4096
    s_nop 0
    s_nop 0
    buffer_load_dwordx4 v17, s[28:31], s45 offen lds
    s_mov_b32 m0, 5120
    s_add_u32 s45, s45, 8192
    buffer_load_dwordx4 v17, s[28:31], s45 offen lds
    s_mov_b32 m0, 6144
    s_add_u32 s45, s45, 8192
    buffer_load_dwordx4 v17, s[28:31], s45 offen lds
    s_mov_b32 m0, 7168
    s_add_u32 s45, s45, 8192
    buffer_load_dwordx4 v17, s[28:31], s45 offen lds
    s_waitcnt vmcnt(16)
    v_mov_b32 v3, 9
    s_mov_b64 exec, 15
    ds_max_u32 v16, v3 offset:64
    s_mov_b64 exec, -1
    v_readlane_b32 s44, v18, 22
    v_readlane_b32 s45, v18, 23
    s_nop 1
    s_mov_b32 m0, 139264
    s_nop 0
    buffer_load_dwordx4 v17, s[28:31], s44 offen lds
    s_mov_b32 m0, 140288
    s_add_u32 s44, s44, 8192
    buffer_load_dwordx4 v17, s[28:31], s44 offen lds
    s_mov_b32 m0, 141312
    s_add_u32 s44, s44, 8192
    buffer_load_dwordx4 v17, s[28:31], s44 offen lds
    s_mov_b32 m0, 142336
    s_add_u32 s44, s44, 8192
    buffer_load_dwordx4 v17, s[28:31], s44 offen lds
    s_mov_b32 m0, 143360
    s_nop 0
    s_nop 0
    buffer_load_dwordx4 v17, s[28:31], s45 offen lds
    s_mov_b32 m0, 144384
    s_add_u32 s45, s45, 8192
    buffer_load_dwordx4 v17, s[28:31], s45 offen lds
    s_mov_b32 m0, 145408
    s_add_u32 s45, s45, 8192
    buffer_load_dwordx4 v17, s[28:31], s45 offen lds
    s_mov_b32 m0, 146432
    s_add_u32 s45, s45, 8192
    buffer_load_dwordx4 v17, s[28:31], s45 offen lds
    s_waitcnt vmcnt(16)
    v_mov_b32 v3, 10
    s_mov_b64 exec, 15
    ds_max_u32 v16, v3 offset:64
    s_mov_b64 exec, -1
    v_readlane_b32 s44, v18, 24
    v_readlane_b32 s45, v18, 25
    s_nop 1
    s_cmp_ge_u32 s52, 14
    s_cbranch_scc1 ldok_198
    s_call_b64 s[54:55], k_ldprobe
    s_cmp_ge_u32 s52, 14
    s_cbranch_scc1 ldok_198
    s_waitcnt vmcnt(8)
    v_mov_b32 v3, 11
    s_mov_b64 exec, 15
    ds_max_u32 v16, v3 offset:64
    s_mov_b64 exec, -1
    s_call_b64 s[54:55], k_ldprobe
    s_cmp_ge_u32 s52, 14
    s_cbranch_scc1 ldok_198
    s_waitcnt vmcnt(0)
    v_mov_b32 v3, 12
    s_mov_b64 exec, 15
    ds_max_u32 v16, v3 offset:64
    s_mov_b64 exec, -1
    s_mov_b32 s41, 2097152
lw_199:
    ds_read_b128 v[12:15], v2 offset:16
    s_waitcnt lgkmcnt(0)
    v_min_u32 v12, v12, v13
    v_min3_u32 v12, v12, v14, v15
    s_nop 0
    v_readfirstlane_b32 s52, v12
    s_nop 0
    s_cmp_ge_u32 s52, 14
    s_cbranch_scc1 lwd_200
    s_sleep 2
    s_sub_u32 s41, s41, 1
    s_cbranch_scc0 lw_199
lwd_200:
ldok_198:
    s_mov_b32 m0, 98304
    s_nop 0
    buffer_load_dwordx4 v17, s[28:31], s44 offen lds
    s_mov_b32 m0, 99328
    s_add_u32 s44, s44, 8192
    buffer_load_dwordx4 v17, s[28:31], s44 offen lds
    s_mov_b32 m0, 100352
    s_add_u32 s44, s44, 8192
    buffer_load_dwordx4 v17, s[28:31], s44 offen lds
    s_mov_b32 m0, 101376
    s_add_u32 s44, s44, 8192
    buffer_load_dwordx4 v17, s[28:31], s44 offen lds
    s_mov_b32 m0, 102400
    s_nop 0
    s_nop 0
    buffer_load_dwordx4 v17, s[28:31], s45 offen lds
    s_mov_b32 m0, 103424
    s_add_u32 s45, s45, 8192
    buffer_load_dwordx4 v17, s[28:31], s45 offen lds
    s_mov_b32 m0, 104448
    s_add_u32 s45, s45, 8192
    buffer_load_dwordx4 v17, s[28:31], s45 offen lds
    s_mov_b32 m0, 105472
    s_add_u32 s45, s45, 8192
    buffer_load_dwordx4 v17, s[28:31], s45 offen lds
    s_waitcnt vmcnt(16)
    v_mov_b32 v3, 11
    s_mov_b64 exec, 15
    ds_max_u32 v16, v3 offset:64
    s_mov_b64 exec, -1
    v_readlane_b32 s44, v18, 26
    v_readlane_b32 s45, v18, 27
    s_nop 1
    s_mov_b32 m0, 90112
    s_nop 0
    buffer_load_dwordx4 v17, s[28:31], s44 offen lds
    s_mov_b32 m0, 91136
    s_add_u32 s44, s44, 8192
    buffer_load_dwordx4 v17, s[28:31], s44 offen lds
    s_mov_b32 m0, 92160
    s_add_u32 s44, s44, 8192
    buffer_load_dwordx4 v17, s[28:31], s44 offen lds
    s_mov_b32 m0, 93184
    s_add_u32 s44, s44, 8192
    buffer_load_dwordx4 v17, s[28:31], s44 offen lds
    s_mov_b32 m0, 94208
    s_nop 0
    s_nop 0
    buffer_load_dwordx4 v17, s[28:31], s45 offen lds
    s_mov_b32 m0, 95232
    s_add_u32 s45, s45, 8192
    buffer_load_dwordx4 v17, s[28:31], s45 offen lds
    s_mov_b32 m0, 96256
    s_add_u32 s45, s45, 8192
    buffer_load_dwordx4 v17, s[28:31], s45 offen lds
    s_mov_b32 m0, 97280
    s_add_u32 s45, s45, 8192
    buffer_load_dwordx4 v17, s[28:31], s45 offen lds
    s_waitcnt vmcnt(16)
    v_mov_b32 v3, 12
    s_mov_b64 exec, 15
    ds_max_u32 v16, v3 offset:64
    s_mov_b64 exec, -1
    v_readlane_b32 s44, v18, 28
    v_readlane_b32 s45, v18, 29
    s_nop 1
    s_cmp_ge_u32 s52, 15
    s_cbranch_scc1 ldok_201
    s_call_b64 s[54:55], k_ldprobe
    s_cmp_ge_u32 s52, 15
    s_cbranch_scc1 ldok_201
    s_waitcnt vmcnt(8)
    v_mov_b32 v3, 13
    s_mov_b64 exec, 15
    ds_max_u32 v16, v3 offset:64
    s_mov_b64 exec, -1
    s_call_b64 s[54:55], k_ldprobe
    s_cmp_ge_u32 s52, 15
    s_cbranch_scc1 ldok_201
    s_waitcnt vmcnt(0)
    v_mov_b32 v3, 14
    s_mov_b64 exec, 15
    ds_max_u32 v16, v3 offset:64
    s_mov_b64 exec, -1
    s_mov_b32 s41, 2097152
lw_202:
    ds_read_b128 v[12:15], v2 offset:16
    s_waitcnt lgkmcnt(0)
    v_min_u32 v12, v12, v13
    v_min3_u32 v12, v12, v14, v15
    s_nop 0
    v_readfirstlane_b32 s52, v12
    s_nop 0
    s_cmp_ge_u32 s52, 15
    s_cbranch_scc1 lwd_203
    s_sleep 2
    s_sub_u32 s41, s41, 1
    s_cbranch_scc0 lw_202
lwd_203:
ldok_201:
    s_mov_b32 m0, 73728
    s_nop 0
    buffer_load_dwordx4 v17, s[28:31], s44 offen lds
    s_mov_b32 m0, 74752
    s_add_u32 s44, s44, 8192
    buffer_load_dwordx4 v17, s[28:31], s44 offen lds
    s_mov_b32 m0, 75776
    s_add_u32 s44, s44, 8192
    buffer_load_dwordx4 v17, s[28:31], s44 offen lds
    s_mov_b32 m0, 76800
    s_add_u32 s44, s44, 8192
    buffer_load_dwordx4 v17, s[28:31], s44 offen lds
    s_mov_b32 m0, 77824
    s_nop 0
    s_nop 0
    buffer_load_dwordx4 v17, s[28:31], s45 offen lds
    s_mov_b32 m0, 78848
    s_add_u32 s45, s45, 8192
    buffer_load_dwordx4 v17, s[28:31], s45 offen lds
    s_mov_b32 m0, 79872
    s_add_u32 s45, s45, 8192
    buffer_load_dwordx4 v17, s[28:31], s45 offen lds
    s_mov_b32 m0, 80896
    s_add_u32 s45, s45, 8192
    buffer_load_dwordx4 v17, s[28:31], s45 offen lds
    s_waitcnt vmcnt(16)
    v_mov_b32 v3, 13
    s_mov_b64 exec, 15
    ds_max_u32 v16, v3 offset:64
    s_mov_b64 exec, -1
    v_readlane_b32 s44, v18, 30
    v_readlane_b32 s45, v18, 31
    s_nop 1
    s_mov_b32 m0, 32768
    s_nop 0
    buffer_load_dwordx4 v17, s[28:31], s44 offen lds
    s_mov_b32 m0, 33792
    s_add_u32 s44, s44, 8192
    buffer_load_dwordx4 v17, s[28:31], s44 offen lds
    s_mov_b32 m0, 34816
    s_add_u32 s44, s44, 8192
    buffer_load_dwordx4 v17, s[28:31], s44 offen lds
    s_mov_b32 m0, 35840
    s_add_u32 s44, s44, 8192
    buffer_load_dwordx4 v17, s[28:31], s44 offen lds
    s_mov_b32 m0, 36864
    s_nop 0
    s_nop 0
    buffer_load_dwordx4 v17, s[28:31], s45 offen lds
    s_mov_b32 m0, 37888
    s_add_u32 s45, s45, 8192
    buffer_load_dwordx4 v17, s[28:31], s45 offen lds
    s_mov_b32 m0, 38912
    s_add_u32 s45, s45, 8192
    buffer_load_dwordx4 v17, s[28:31], s45 offen lds
    s_mov_b32 m0, 39936
    s_add_u32 s45, s45, 8192
    buffer_load_dwordx4 v17, s[28:31], s45 offen lds
    s_waitcnt vmcnt(16)
    v_mov_b32 v3, 14
    s_mov_b64 exec, 15
    ds_max_u32 v16, v3 offset:64
    s_mov_b64 exec, -1
    v_readlane_b32 s44, v18, 32
    v_readlane_b32 s45, v18, 33
    s_nop 1
    s_cmp_ge_u32 s52, 16
    s_cbranch_scc1 ldok_204
    s_call_b64 s[54:55], k_ldprobe
    s_cmp_ge_u32 s52, 16
    s_cbranch_scc1 ldok_204
    s_waitcnt vmcnt(8)
    v_mov_b32 v3, 15
    s_mov_b64 exec, 15
    ds_max_u32 v16, v3 offset:64
    s_mov_b64 exec, -1
    s_call_b64 s[54:55], k_ldprobe
    s_cmp_ge_u32 s52, 16
    s_cbranch_scc1 ldok_204
    s_waitcnt vmcnt(0)
    v_mov_b32 v3, 16
    s_mov_b64 exec, 15
    ds_max_u32 v16, v3 offset:64
    s_mov_b64 exec, -1
    s_mov_b32 s41, 2097152
lw_205:
    ds_read_b128 v[12:15], v2 offset:16
    s_waitcnt lgkmcnt(0)
    v_min_u32 v12, v12, v13
    v_min3_u32 v12, v12, v14, v15
    s_nop 0
    v_readfirstlane_b32 s52, v12
    s_nop 0
    s_cmp_ge_u32 s52, 16
    s_cbranch_scc1 lwd_206
    s_sleep 2
    s_sub_u32 s41, s41, 1
    s_cbranch_scc0 lw_205
lwd_206:
ldok_204:
    s_mov_b32 m0, 49152
    s_nop 0
    buffer_load_dwordx4 v17, s[28:31], s44 offen lds
    s_mov_b32 m0, 50176
    s_add_u32 s44, s44, 8192
    buffer_load_dwordx4 v17, s[28:31], s44 offen lds
    s_mov_b32 m0, 51200
    s_add_u32 s44, s44, 8192
    buffer_load_dwordx4 v17, s[28:31], s44 offen lds
    s_mov_b32 m0, 52224
    s_add_u32 s44, s44, 8192
    buffer_load_dwordx4 v17, s[28:31], s44 offen lds
    s_mov_b32 m0, 53248
    s_nop 0
    s_nop 0
    buffer_load_dwordx4 v17, s[28:31], s45 offen lds
    s_mov_b32 m0, 54272
    s_add_u32 s45, s45, 8192
    buffer_load_dwordx4 v17, s[28:31], s45 offen lds
    s_mov_b32 m0, 55296
    s_add_u32 s45, s45, 8192
    buffer_load_dwordx4 v17, s[28:31], s45 offen lds
    s_mov_b32 m0, 56320
    s_add_u32 s45, s45, 8192
    buffer_load_dwordx4 v17, s[28:31], s45 offen lds
    s_waitcnt vmcnt(16)
    v_mov_b32 v3, 15
    s_mov_b64 exec, 15
    ds_max_u32 v16, v3 offset:64
    s_mov_b64 exec, -1
    v_readlane_b32 s44, v18, 34
    v_readlane_b32 s45, v18, 35
    s_nop 1
    s_mov_b32 m0, 40960
    s_nop 0
    buffer_load_dwordx4 v17, s[28:31], s44 offen lds
    s_mov_b32 m0, 41984
    s_add_u32 s44, s44, 8192
    buffer_load_dwordx4 v17, s[28:31], s44 offen lds
    s_mov_b32 m0, 43008
    s_add_u32 s44, s44, 8192
    buffer_load_dwordx4 v17, s[28:31], s44 offen lds
    s_mov_b32 m0, 44032
    s_add_u32 s44, s44, 8192
    buffer_load_dwordx4 v17, s[28:31], s44 offen lds
    s_mov_b32 m0, 45056
    s_nop 0
    s_nop 0
    buffer_load_dwordx4 v17, s[28:31], s45 offen lds
    s_mov_b32 m0, 46080
    s_add_u32 s45, s45, 8192
    buffer_load_dwordx4 v17, s[28:31], s45 offen lds
    s_mov_b32 m0, 47104
    s_add_u32 s45, s45, 8192
    buffer_load_dwordx4 v17, s[28:31], s45 offen lds
    s_mov_b32 m0, 48128
    s_add_u32 s45, s45, 8192
    buffer_load_dwordx4 v17, s[28:31], s45 offen lds
    s_waitcnt vmcnt(16)
    v_mov_b32 v3, 16
    s_mov_b64 exec, 15
    ds_max_u32 v16, v3 offset:64
    s_mov_b64 exec, -1
    v_readlane_b32 s44, v18, 36
    v_readlane_b32 s45, v18, 37
    s_nop 1
    s_cmp_ge_u32 s52, 17
    s_cbranch_scc1 ldok_207
    s_call_b64 s[54:55], k_ldprobe
    s_cmp_ge_u32 s52, 17
    s_cbranch_scc1 ldok_207
    s_waitcnt vmcnt(8)
    v_mov_b32 v3, 17
    s_mov_b64 exec, 15
    ds_max_u32 v16, v3 offset:64
    s_mov_b64 exec, -1
    s_call_b64 s[54:55], k_ldprobe
    s_cmp_ge_u32 s52, 17
    s_cbranch_scc1 ldok_207
    s_waitcnt vmcnt(0)
    v_mov_b32 v3, 18
    s_mov_b64 exec, 15
    ds_max_u32 v16, v3 offset:64
    s_mov_b64 exec, -1
    s_mov_b32 s41, 2097152
lw_208:
    ds_read_b128 v[12:15], v2 offset:16
    s_waitcnt lgkmcnt(0)
    v_min_u32 v12, v12, v13
    v_min3_u32 v12, v12, v14, v15
    s_nop 0
    v_readfirstlane_b32 s52, v12
    s_nop 0
    s_cmp_ge_u32 s52, 17
    s_cbranch_scc1 lwd_209
    s_sleep 2
    s_sub_u32 s41, s41, 1
    s_cbranch_scc0 lw_208
lwd_209:
ldok_207:
    s_mov_b32 m0, 16384
    s_nop 0
    buffer_load_dwordx4 v17, s[28:31], s44 offen lds
    s_mov_b32 m0, 17408
    s_add_u32 s44, s44, 8192
    buffer_load_dwordx4 v17, s[28:31], s44 offen lds
    s_mov_b32 m0, 18432
    s_add_u32 s44, s44, 8192
    buffer_load_dwordx4 v17, s[28:31], s44 offen lds
    s_mov_b32 m0, 19456
    s_add_u32 s44, s44, 8192
    buffer_load_dwordx4 v17, s[28:31], s44 offen lds
    s_mov_b32 m0, 20480
    s_nop 0
    s_nop 0
    buffer_load_dwordx4 v17, s[28:31], s45 offen lds
    s_mov_b32 m0, 21504
    s_add_u32 s45, s45, 8192
    buffer_load_dwordx4 v17, s[28:31], s45 offen lds
    s_mov_b32 m0, 22528
    s_add_u32 s45, s45, 8192
    buffer_load_dwordx4 v17, s[28:31], s45 offen lds
    s_mov_b32 m0, 23552
    s_add_u32 s45, s45, 8192
    buffer_load_dwordx4 v17, s[28:31], s45 offen lds
    s_waitcnt vmcnt(16)
    v_mov_b32 v3, 17
    s_mov_b64 exec, 15
    ds_max_u32 v16, v3 offset:64
    s_mov_b64 exec, -1
    v_readlane_b32 s44, v18, 38
    v_readlane_b32 s45, v18, 39
    s_nop 1
    s_cmp_ge_u32 s52, 18
    s_cbranch_scc1 ldok_210
    s_call_b64 s[54:55], k_ldprobe
    s_cmp_ge_u32 s52, 18
    s_cbranch_scc1 ldok_210
    s_waitcnt vmcnt(8)
    v_mov_b32 v3, 18
    s_mov_b64 exec, 15
    ds_max_u32 v16, v3 offset:64
    s_mov_b64 exec, -1
    s_call_b64 s[54:55], k_ldprobe
    s_cmp_ge_u32 s52, 18
    s_cbranch_scc1 ldok_210
    s_waitcnt vmcnt(0)
    v_mov_b32 v3, 19
    s_mov_b64 exec, 15
    ds_max_u32 v16, v3 offset:64
    s_mov_b64 exec, -1
    s_mov_b32 s41, 2097152
lw_211:
    ds_read_b128 v[12:15], v2 offset:16
    s_waitcnt lgkmcnt(0)
    v_min_u32 v12, v12, v13
    v_min3_u32 v12, v12, v14, v15
    s_nop 0
    v_readfirstlane_b32 s52, v12
    s_nop 0
    s_cmp_ge_u32 s52, 18
    s_cbranch_scc1 lwd_212
    s_sleep 2
    s_sub_u32 s41, s41, 1
    s_cbranch_scc0 lw_211
lwd_212:
ldok_210:
    s_mov_b32 m0, 81920
    s_nop 0
    buffer_load_dwordx4 v17, s[28:31], s44 offen lds
    s_mov_b32 m0, 82944
    s_add_u32 s44, s44, 8192
    buffer_load_dwordx4 v17, s[28:31], s44 offen lds
    s_mov_b32 m0, 83968
    s_add_u32 s44, s44, 8192
    buffer_load_dwordx4 v17, s[28:31], s44 offen lds
    s_mov_b32 m0, 84992
    s_add_u32 s44, s44, 8192
    buffer_load_dwordx4 v17, s[28:31], s44 offen lds
    s_mov_b32 m0, 86016
    s_nop 0
    s_nop 0
    buffer_load_dwordx4 v17, s[28:31], s45 offen lds
    s_mov_b32 m0, 87040
    s_add_u32 s45, s45, 8192
    buffer_load_dwordx4 v17, s[28:31], s45 offen lds
    s_mov_b32 m0, 88064
    s_add_u32 s45, s45, 8192
    buffer_load_dwordx4 v17, s[28:31], s45 offen lds
    s_mov_b32 m0, 89088
    s_add_u32 s45, s45, 8192
    buffer_load_dwordx4 v17, s[28:31], s45 offen lds
    s_waitcnt vmcnt(16)
    v_mov_b32 v3, 18
    s_mov_b64 exec, 15
    ds_max_u32 v16, v3 offset:64
    s_mov_b64 exec, -1
    v_readlane_b32 s44, v18, 40
    v_readlane_b32 s45, v18, 41
    s_nop 1
    s_cmp_ge_u32 s52, 19
    s_cbranch_scc1 ldok_213
    s_call_b64 s[54:55], k_ldprobe
    s_cmp_ge_u32 s52, 19
    s_cbranch_scc1 ldok_213
    s_waitcnt vmcnt(8)
    v_mov_b32 v3, 19
    s_mov_b64 exec, 15
    ds_max_u32 v16, v3 offset:64
    s_mov_b64 exec, -1
    s_call_b64 s[54:55], k_ldprobe
    s_cmp_ge_u32 s52, 19
    s_cbranch_scc1 ldok_213
    s_waitcnt vmcnt(0)
    v_mov_b32 v3, 20
    s_mov_b64 exec, 15
    ds_max_u32 v16, v3 offset:64
    s_mov_b64 exec, -1
    s_mov_b32 s41, 2097152
lw_214:
    ds_read_b128 v[12:15], v2 offset:16
    s_waitcnt lgkmcnt(0)
    v_min_u32 v12, v12, v13
    v_min3_u32 v12, v12, v14, v15
    s_nop 0
    v_readfirstlane_b32 s52, v12
    s_nop 0
    s_cmp_ge_u32 s52, 19
    s_cbranch_scc1 lwd_215
    s_sleep 2
    s_sub_u32 s41, s41, 1
    s_cbranch_scc0 lw_214
lwd_215:
ldok_213:
    s_mov_b32 m0, 114688
    s_nop 0
    buffer_load_dwordx4 v17, s[28:31], s44 offen lds
    s_mov_b32 m0, 115712
    s_add_u32 s44, s44, 8192
    buffer_load_dwordx4 v17, s[28:31], s44 offen lds
    s_mov_b32 m0, 116736
    s_add_u32 s44, s44, 8192
    buffer_load_dwordx4 v17, s[28:31], s44 offen lds
    s_mov_b32 m0, 117760
    s_add_u32 s44, s44, 8192
    buffer_load_dwordx4 v17, s[28:31], s44 offen lds
    s_mov_b32 m0, 118784
    s_nop 0
    s_nop 0
    buffer_load_dwordx4 v17, s[28:31], s45 offen lds
    s_mov_b32 m0, 119808
    s_add_u32 s45, s45, 8192
    buffer_load_dwordx4 v17, s[28:31], s45 offen lds
    s_mov_b32 m0, 120832
    s_add_u32 s45, s45, 8192
    buffer_load_dwordx4 v17, s[28:31], s45 offen lds
    s_mov_b32 m0, 121856
    s_add_u32 s45, s45, 8192
    buffer_load_dwordx4 v17, s[28:31], s45 offen lds
    s_waitcnt vmcnt(16)
    v_mov_b32 v3, 19
    s_mov_b64 exec, 15
    ds_max_u32 v16, v3 offset:64
    s_mov_b64 exec, -1
    v_readlane_b32 s44, v18, 42
    s_nop 1
    s_cmp_ge_u32 s52, 20
    s_cbranch_scc1 ldok_216
    s_call_b64 s[54:55], k_ldprobe
    s_cmp_ge_u32 s52, 20
    s_cbranch_scc1 ldok_216
    s_waitcnt vmcnt(8)
    v_mov_b32 v3, 20
    s_mov_b64 exec, 15
    ds_max_u32 v16, v3 offset:64
    s_mov_b64 exec, -1
    s_call_b64 s[54:55], k_ldprobe
    s_cmp_ge_u32 s52, 20
    s_cbranch_scc1 ldok_216
    s_waitcnt vmcnt(0)
    v_mov_b32 v3, 21
    s_mov_b64 exec, 15
    ds_max_u32 v16, v3 offset:64
    s_mov_b64 exec, -1
    s_mov_b32 s41, 2097152
lw_217:
    ds_read_b128 v[12:15], v2 offset:16
    s_waitcnt lgkmcnt(0)
    v_min_u32 v12, v12, v13
    v_min3_u32 v12, v12, v14, v15
    s_nop 0
    v_readfirstlane_b32 s52, v12
    s_nop 0
    s_cmp_ge_u32 s52, 20
    s_cbranch_scc1 lwd_218
    s_sleep 2
    s_sub_u32 s41, s41, 1
    s_cbranch_scc0 lw_217
lwd_218:
ldok_216:
    s_mov_b32 m0, 24576
    s_nop 0
    buffer_load_dwordx4 v17, s[28:31], s44 offen lds
    s_mov_b32 m0, 25600
    s_add_u32 s44, s44, 8192
    buffer_load_dwordx4 v17, s[28:31], s44 offen lds
    s_mov_b32 m0, 26624
    s_add_u32 s44, s44, 8192
    buffer_load_dwordx4 v17, s[28:31], s44 offen lds
    s_mov_b32 m0, 27648
    s_add_u32 s44, s44, 8192
    buffer_load_dwordx4 v17, s[28:31], s44 offen lds
    s_waitcnt vmcnt(12)
    v_mov_b32 v3, 20
    s_mov_b64 exec, 15
    ds_max_u32 v16, v3 offset:64
    s_mov_b64 exec, -1
    s_waitcnt vmcnt(4)
    v_mov_b32 v3, 21
    s_mov_b64 exec, 15
    ds_max_u32 v16, v3 offset:64
    s_mov_b64 exec, -1
    s_waitcnt vmcnt(0)
    v_mov_b32 v3, 22
    s_mov_b64 exec, 15
    ds_max_u32 v16, v3 offset:64
    s_mov_b64 exec, -1
k_ldend:
    s_lshr_b32 s40, s3, 2
    s_lshl_b32 s40, s40, 20
    s_lshr_b32 s41, s89, 3
    s_lshl_b32 s41, s41, 18
    s_add_u32 s40, s40, s41
    s_and_b32 s41, s89, 7
    s_lshl_b32 s41, s41, 12
    s_add_u32 s40, s40, s41
    s_and_b32 s41, s3, 3
    s_lshl_b32 s41, s41, 16
    s_add_u32 s40, s40, s41
    s_lshl_b32 s41, s90, 7
    s_add_u32 s91, s40, s41
    v_bfe_u32 v12, v1, 3, 2
    v_and_b32 v11, 7, v1
    v_lshlrev_b32 v11, 4, v11
    v_lshl_add_u32 v11, v12, 10, v11
    v_lshrrev_b32 v12, 5, v1
    v_lshl_add_u32 v11, v12, 15, v11
    buffer_load_dwordx4 v[12:15], v11, s[8:11], s91 offen
k_fin:
    s_and_b32 s44, s3, 3
    s_lshl_b32 s44, s44, 11
    s_lshr_b32 s45, s3, 2
    s_mov_b32 s42, 122880
    s_cmp_eq_u32 s45, 1
    s_cmov_b32 s42, 131072
    s_mov_b32 s43, 65536
    s_cmp_eq_u32 s45, 1
    s_cmov_b32 s43, 8192
    v_lshrrev_b32 v128, 3, v1
    v_and_b32 v129, 7, v1
    v_lshlrev_b32 v129, 1, v129
    v_xor_b32 v129, v129, v128
    v_lshlrev_b32 v129, 4, v129
    v_lshl_add_u32 v128, v128, 8, v129
    v_add_u32 v128, s44, v128
    v_xor_b32 v129, 16, v128
    v_add_u32 v132, s42, v128
    v_add_u32 v133, s42, v129
    v_add_u32 v134, s43, v128
    v_add_u32 v135, s43, v129
    s_lshl_b32 s44, s3, 10
    s_add_u32 s44, s44, 57344
    v_lshl_add_u32 v128, v1, 4, s44
    s_waitcnt vmcnt(0)
    v_lshlrev_b32 v144, 16, v12
    v_and_b32 v145, 0xffff0000, v12
    v_lshlrev_b32 v146, 16, v13
    v_and_b32 v147, 0xffff0000, v13
    v_lshlrev_b32 v148, 16, v14
    v_and_b32 v149, 0xffff0000, v14
    v_lshlrev_b32 v150, 16, v15
    v_and_b32 v151, 0xffff0000, v15
k_fin2:
    s_waitcnt lgkmcnt(0)
    s_barrier
    ds_read_b128 v[28:31], v128
    ds_read_b128 v[36:39], v132
    ds_read_b128 v[44:47], v134
    ds_read_b128 v[40:43], v133
    ds_read_b128 v[48:51], v135
    s_waitcnt lgkmcnt(4)
    v_lshlrev_b32 v20, 16, v28
    v_and_b32 v21, 0xffff0000, v28
    v_lshlrev_b32 v22, 16, v29
    v_and_b32 v23, 0xffff0000, v29
    v_lshlrev_b32 v24, 16, v30
    v_and_b32 v25, 0xffff0000, v30
    v_lshlrev_b32_e64 v26, 16, v31
    v_and_b32 v27, 0xffff0000, v31
    v_pk_add_f32 v[20:21], v[20:21], v[144:145]
    v_pk_add_f32 v[22:23], v[22:23], v[146:147]
    v_pk_add_f32 v[24:25], v[24:25], v[148:149]
    v_pk_add_f32 v[26:27], v[26:27], v[150:151]
    s_waitcnt lgkmcnt(2)
    s_nop 0
    v_pk_add_f32 v[36:37], v[36:37], v[44:45]
    v_pk_add_f32 v[20:21], v[20:21], v[36:37]
    v_cvt_pk_bf16_f32 v12, v20, v21
    v_pk_add_f32 v[38:39], v[38:39], v[46:47]
    v_pk_add_f32 v[22:23], v[22:23], v[38:39]
    v_cvt_pk_bf16_f32 v13, v22, v23
    s_waitcnt lgkmcnt(0)
    s_nop 0
    v_pk_add_f32 v[40:41], v[40:41], v[48:49]
    v_pk_add_f32 v[24:25], v[24:25], v[40:41]
    v_cvt_pk_bf16_f32 v14, v24, v25
    v_pk_add_f32 v[42:43], v[42:43], v[50:51]
    v_pk_add_f32 v[26:27], v[26:27], v[42:43]
    v_cvt_pk_bf16_f32 v15, v26, v27
    buffer_store_dwordx4 v[12:15], v11, s[32:35], s91 offen
    s_xor_b32 s40, s3, 5
    s_or_b32 s40, s40, s2
    s_cmp_lg_u32 s40, 0
    s_cbranch_scc1 k_dump
    s_mov_b32 s42, 12582912
    s_add_u32 s40, s5, 0
    v_mov_b32 v4, s40
    s_mov_b64 exec, 1
    buffer_store_dword v4, off, s[36:39], s42 sc0 sc1
    s_mov_b64 exec, -1
k_dump:
k_end:
    s_endpgm
.section .rodata,"a"
.p2align 6
.amdhsa_kernel parallel_sum__spectral_gfnet__glu_gated_swiglu__prompt_kernel
  .amdhsa_next_free_vgpr 256
  .amdhsa_next_free_sgpr 102
  .amdhsa_accum_offset 256
  .amdhsa_group_segment_fixed_size 0
  .amdhsa_kernarg_size 80
  .amdhsa_user_sgpr_count 2
  .amdhsa_user_sgpr_kernarg_segment_ptr 1
  .amdhsa_system_sgpr_workgroup_id_x 1
.end_amdhsa_kernel
```
